```python
import torch

def _softmax(x, axis=-1):
    return torch.softmax(x, dim=axis)
def _gelu(x):
    return torch.nn.functional.gelu(x, approximate="tanh")
def _silu(x):
    return torch.nn.functional.silu(x)
def _sigmoid(x):
    return torch.sigmoid(x)
def _layernorm(x, axis=-1, eps=1e-5):
    m = x.mean(dim=axis, keepdim=True)
    v = x.var(dim=axis, keepdim=True, unbiased=False)
    return (x - m) / torch.sqrt(v + eps)
def _scatter_add(tgt, idx, src, axis=0):
    return tgt.clone().index_add_(axis, idx, src)
def _segment_sum(src, seg, n):
    out = torch.zeros((n,) + src.shape[1:], dtype=src.dtype)
    return out.index_add_(0, seg, src)
def _pad(x, pw):
    flat = tuple(v for pair in reversed(pw) for v in pair)
    return torch.nn.functional.pad(x, flat)

kernel_name = 'sequential_preLN__ssm_conv_s4__glu_gated_swiglu__prompt'

def setup_inputs():

    _w = (lambda a: (lambda t: t.to(torch.bfloat16) if t.is_floating_point() else t)(torch.as_tensor(a)))
    def _A_setup():
        B, L, D, N = 1, 2048, 576, 128
        A_re = -(lambda _x: torch.exp(torch.as_tensor(_x)))((lambda *s: torch.randn(*s, dtype=torch.bfloat16) * 6.4)(D, N))
        A_im = torch.pi * (lambda *s: torch.randn(*s, dtype=torch.bfloat16) * 0.05)(D, N)
        B_re = (lambda *s: torch.randn(*s, dtype=torch.bfloat16) * 0.05)(D, N)
        B_im = (lambda *s: torch.randn(*s, dtype=torch.bfloat16) * 0.05)(D, N)
        C_re = (lambda *s: torch.randn(*s, dtype=torch.bfloat16) * 0.05)(D, N)
        C_im = (lambda *s: torch.randn(*s, dtype=torch.bfloat16) * 0.05)(D, N)
        log_dt = (lambda *s: torch.randn(*s, dtype=torch.bfloat16) * 0.05)(D) * 0.5 - 4.0
        Dskip = (lambda *s: torch.randn(*s, dtype=torch.bfloat16) * 0.05)(D)
        return {
            "u": _w((lambda *s: torch.randn(*s, dtype=torch.bfloat16) * 0.05)(B, L, D)),
            "A_re": _w(A_re),
            "A_im": _w(A_im),
            "B_re": _w(B_re),
            "B_im": _w(B_im),
            "C_re": _w(C_re),
            "C_im": _w(C_im),
            "log_dt": _w(log_dt),
            "Dskip": _w(Dskip),
        }
    _A_in = _A_setup()

    def _B_setup():
        B, S, D, F = 1, 2048, 576, 4608
        return {
            "x": _w((lambda *s: torch.randn(*s, dtype=torch.bfloat16) * 0.05)(B, S, D)),
            "w1": _w((lambda *s: torch.randn(*s, dtype=torch.bfloat16) * 0.4)(D, F) * (2.0 / D) ** 0.5),
            "w3": _w((lambda *s: torch.randn(*s, dtype=torch.bfloat16) * 0.4)(D, F) * (2.0 / D) ** 0.5),
            "w2": _w((lambda *s: torch.randn(*s, dtype=torch.bfloat16) * 0.4)(F, D) * (2.0 / F) ** 0.5),
        }
    _B_in = _B_setup()

    return {
        "A_u": _A_in["u"],
        "A_A_re": _A_in["A_re"],
        "A_A_im": _A_in["A_im"],
        "A_B_re": _A_in["B_re"],
        "A_B_im": _A_in["B_im"],
        "A_C_re": _A_in["C_re"],
        "A_C_im": _A_in["C_im"],
        "A_log_dt": _A_in["log_dt"],
        "A_Dskip": _A_in["Dskip"],
        "B_x": _B_in["x"],
        "B_w1": _B_in["w1"],
        "B_w3": _B_in["w3"],
        "B_w2": _B_in["w2"],
    }

def reference(A_u, A_A_re, A_A_im, A_B_re, A_B_im, A_C_re, A_C_im, A_log_dt, A_Dskip, B_x, B_w1, B_w3, B_w2):
    def _A_ref(u, A_re, A_im, B_re, B_im, C_re, C_im, log_dt, Dskip):
        Bsz, L, D = u.shape
        dt = torch.exp(log_dt)[:, None]
        A = A_re + 1j * A_im
        Bc = B_re + 1j * B_im
        Cc = C_re + 1j * C_im
        logdA = dt * A
        dB = dt * Bc
        l = (lambda x, dt: x.to(dt))(torch.arange(L), A_re.dtype)
        P = torch.exp(logdA[:, :, None] * l[None, None, :])
        K = torch.einsum("dn,dnl,dn->dl", Cc, P, dB).real
        L2 = 2 * L
        Kp = _pad(K, ((0, 0), (0, L)))
        up = (lambda x, *d: x.permute(*d))(u, 0, 2, 1)
        up = _pad(up, ((0, 0), (0, 0), (0, L)))
        Kf = (lambda x, axes=(-2,-1): torch.fft.rfft2(x.float(), dim=axes))(Kp[:, None, :], axes=(-2, -1))
        Uf = (lambda x, axes=(-2,-1): torch.fft.rfft2(x.float(), dim=axes))(up[:, :, None, :], axes=(-2, -1))
        Yf = Uf * Kf[None, :, :, :]
        y = (lambda x, s, axes=(-2,-1): torch.fft.irfft2(x, s=s, dim=axes).to(torch.bfloat16))(Yf, (1, L2), axes=(-2, -1))[:, :, 0, :L]
        y = (lambda x, *d: x.permute(*d))(y, 0, 2, 1) + u * Dskip[None, None, :]
        return y

    def _B_ref(x, w1, w3, w2):
        gate = torch.einsum("bsd,df->bsf", x, w1)
        up = torch.einsum("bsd,df->bsf", x, w3)
        h = _silu(gate) * up
        out = torch.einsum("bsf,fd->bsd", h, w2)
        return out

    x = A_u
    h = x + _A_ref(_layernorm(x, axis=-1), A_A_re, A_A_im, A_B_re, A_B_im, A_C_re, A_C_im, A_log_dt, A_Dskip)
    h2 = h + _B_ref(_layernorm(h, axis=-1), B_w1, B_w3, B_w2)
    return h2
```

```asm
; @launch kernel=front_kernel grid=(848,1,1) block=(256,1,1) lds=32768
; @launch kernel=gemm1_kernel grid=(256,1,1) block=(512,1,1) lds=147968
.amdgcn_target "amdgcn-amd-amdhsa--gfx950"
.text
.globl front_kernel
.p2align 8
.type front_kernel,@function
front_kernel:
    s_cmp_ge_u32 s2, 848
    s_cbranch_scc1 KF_end
    s_cmp_ge_u32 s2, 704
    s_cbranch_scc1 KF_pref
    s_sub_u32 s3, s2, 128
    s_cmp_ge_u32 s3, 32
    s_cbranch_scc1 KF_nocpf
    s_getpc_b64 s[44:45]

KF_pc0:
    s_mov_b32 s46, gemm1_kernel-KF_pc0
    s_mov_b32 s47, 0x20000
    v_lshlrev_b32 v12, 4, v0
    s_movk_i32 s48, 0x1000
    buffer_load_dwordx4 v[140:143], v12, s[44:47], 0 offen
    buffer_load_dwordx4 v[140:143], v12, s[44:47], s48 offen
    s_movk_i32 s48, 0x2000
    buffer_load_dwordx4 v[140:143], v12, s[44:47], s48 offen
    s_movk_i32 s48, 0x3000
    buffer_load_dwordx4 v[140:143], v12, s[44:47], s48 offen

KF_nocpf:
    s_cmp_ge_u32 s2, 128
    s_cbranch_scc1 KF_kgen

    s_setprio 3
    s_load_dwordx2 s[4:5], s[0:1], 0
    s_load_dwordx4 s[16:19], s[0:1], 112
    v_lshrrev_b32 v2, 6, v0
    v_and_b32 v1, 63, v0

    s_lshl_b32 s3, s2, 4
    v_lshlrev_b32 v3, 2, v2
    v_add_u32 v3, s3, v3
    s_movk_i32 s20, 1152
    v_mul_lo_u32 v3, v3, s20
    v_lshl_add_u32 v3, v1, 1, v3
    s_waitcnt lgkmcnt(0)

    s_mov_b32 s8, s4
    s_mov_b32 s9, s5
    s_mov_b32 s10, 0x240000
    s_mov_b32 s11, 0x20000
    s_mov_b32 s12, s18
    s_mov_b32 s13, s19
    s_mov_b32 s14, 0x240000
    s_mov_b32 s15, 0x20000
    s_mov_b32 s28, s16
    s_mov_b32 s29, s17
    s_mov_b32 s30, 0x100
    s_mov_b32 s31, 0x20000
    buffer_load_short_d16_hi v10, v3, s[8:11], 0 offen offset:0
    buffer_load_short_d16_hi v11, v3, s[8:11], 0 offen offset:128
    buffer_load_short_d16_hi v12, v3, s[8:11], 0 offen offset:256
    buffer_load_short_d16_hi v13, v3, s[8:11], 0 offen offset:384
    buffer_load_short_d16_hi v14, v3, s[8:11], 0 offen offset:512
    buffer_load_short_d16_hi v15, v3, s[8:11], 0 offen offset:640
    buffer_load_short_d16_hi v16, v3, s[8:11], 0 offen offset:768
    buffer_load_short_d16_hi v17, v3, s[8:11], 0 offen offset:896
    buffer_load_short_d16_hi v18, v3, s[8:11], 0 offen offset:1024
    buffer_load_short_d16_hi v19, v3, s[8:11], 0 offen offset:1152
    buffer_load_short_d16_hi v20, v3, s[8:11], 0 offen offset:1280
    buffer_load_short_d16_hi v21, v3, s[8:11], 0 offen offset:1408
    buffer_load_short_d16_hi v22, v3, s[8:11], 0 offen offset:1536
    buffer_load_short_d16_hi v23, v3, s[8:11], 0 offen offset:1664
    buffer_load_short_d16_hi v24, v3, s[8:11], 0 offen offset:1792
    buffer_load_short_d16_hi v25, v3, s[8:11], 0 offen offset:1920
    buffer_load_short_d16_hi v26, v3, s[8:11], 0 offen offset:2048
    buffer_load_short_d16_hi v27, v3, s[8:11], 0 offen offset:2176
    buffer_load_short_d16_hi v28, v3, s[8:11], 0 offen offset:2304
    buffer_load_short_d16_hi v29, v3, s[8:11], 0 offen offset:2432
    buffer_load_short_d16_hi v30, v3, s[8:11], 0 offen offset:2560
    buffer_load_short_d16_hi v31, v3, s[8:11], 0 offen offset:2688
    buffer_load_short_d16_hi v32, v3, s[8:11], 0 offen offset:2816
    buffer_load_short_d16_hi v33, v3, s[8:11], 0 offen offset:2944
    buffer_load_short_d16_hi v34, v3, s[8:11], 0 offen offset:3072
    buffer_load_short_d16_hi v35, v3, s[8:11], 0 offen offset:3200
    buffer_load_short_d16_hi v36, v3, s[8:11], 0 offen offset:3328
    buffer_load_short_d16_hi v37, v3, s[8:11], 0 offen offset:3456
    buffer_load_short_d16_hi v38, v3, s[8:11], 0 offen offset:3584
    buffer_load_short_d16_hi v39, v3, s[8:11], 0 offen offset:3712
    buffer_load_short_d16_hi v40, v3, s[8:11], 0 offen offset:3840
    buffer_load_short_d16_hi v41, v3, s[8:11], 0 offen offset:3968
    buffer_load_short_d16_hi v42, v3, s[8:11], s20 offen offset:2944
    buffer_load_short_d16_hi v43, v3, s[8:11], s20 offen offset:3072
    buffer_load_short_d16_hi v44, v3, s[8:11], s20 offen offset:3200
    buffer_load_short_d16_hi v45, v3, s[8:11], s20 offen offset:3328
    s_movk_i32 s21, 4624
    v_mul_lo_u32 v4, v2, s21
    v_lshl_add_u32 v4, v1, 1, v4
    s_waitcnt vmcnt(0)

    v_add_f32 v50, v10, v11
    v_add_f32 v51, v19, v20
    v_add_f32 v52, v28, v29
    v_add_f32 v53, v37, v38
    v_add_f32 v50, v50, v12
    v_add_f32 v51, v51, v21
    v_add_f32 v52, v52, v30
    v_add_f32 v53, v53, v39
    v_add_f32 v50, v50, v13
    v_add_f32 v51, v51, v22
    v_add_f32 v52, v52, v31
    v_add_f32 v53, v53, v40
    v_add_f32 v50, v50, v14
    v_add_f32 v51, v51, v23
    v_add_f32 v52, v52, v32
    v_add_f32 v53, v53, v41
    v_add_f32 v50, v50, v15
    v_add_f32 v51, v51, v24
    v_add_f32 v52, v52, v33
    v_add_f32 v53, v53, v42
    v_add_f32 v50, v50, v16
    v_add_f32 v51, v51, v25
    v_add_f32 v52, v52, v34
    v_add_f32 v53, v53, v43
    v_add_f32 v50, v50, v17
    v_add_f32 v51, v51, v26
    v_add_f32 v52, v52, v35
    v_add_f32 v53, v53, v44
    v_add_f32 v50, v50, v18
    v_add_f32 v51, v51, v27
    v_add_f32 v52, v52, v36
    v_add_f32 v53, v53, v45
    s_nop 1
    v_add_f32_dpp v50, v50, v50 quad_perm:[1,0,3,2] row_mask:0xf bank_mask:0xf
    v_add_f32_dpp v51, v51, v51 quad_perm:[1,0,3,2] row_mask:0xf bank_mask:0xf
    v_add_f32_dpp v52, v52, v52 quad_perm:[1,0,3,2] row_mask:0xf bank_mask:0xf
    v_add_f32_dpp v53, v53, v53 quad_perm:[1,0,3,2] row_mask:0xf bank_mask:0xf
    v_add_f32_dpp v50, v50, v50 quad_perm:[2,3,0,1] row_mask:0xf bank_mask:0xf
    v_add_f32_dpp v51, v51, v51 quad_perm:[2,3,0,1] row_mask:0xf bank_mask:0xf
    v_add_f32_dpp v52, v52, v52 quad_perm:[2,3,0,1] row_mask:0xf bank_mask:0xf
    v_add_f32_dpp v53, v53, v53 quad_perm:[2,3,0,1] row_mask:0xf bank_mask:0xf
    v_add_f32_dpp v50, v50, v50 row_half_mirror row_mask:0xf bank_mask:0xf
    v_add_f32_dpp v51, v51, v51 row_half_mirror row_mask:0xf bank_mask:0xf
    v_add_f32_dpp v52, v52, v52 row_half_mirror row_mask:0xf bank_mask:0xf
    v_add_f32_dpp v53, v53, v53 row_half_mirror row_mask:0xf bank_mask:0xf
    v_add_f32_dpp v50, v50, v50 row_mirror row_mask:0xf bank_mask:0xf
    v_add_f32_dpp v51, v51, v51 row_mirror row_mask:0xf bank_mask:0xf
    v_add_f32_dpp v52, v52, v52 row_mirror row_mask:0xf bank_mask:0xf
    v_add_f32_dpp v53, v53, v53 row_mirror row_mask:0xf bank_mask:0xf
    v_add_f32_dpp v50, v50, v50 row_bcast:15 row_mask:0xa bank_mask:0xf
    v_add_f32_dpp v51, v51, v51 row_bcast:15 row_mask:0xa bank_mask:0xf
    v_add_f32_dpp v52, v52, v52 row_bcast:15 row_mask:0xa bank_mask:0xf
    v_add_f32_dpp v53, v53, v53 row_bcast:15 row_mask:0xa bank_mask:0xf
    v_add_f32_dpp v50, v50, v50 row_bcast:31 row_mask:0xc bank_mask:0xf
    v_add_f32_dpp v51, v51, v51 row_bcast:31 row_mask:0xc bank_mask:0xf
    v_add_f32_dpp v52, v52, v52 row_bcast:31 row_mask:0xc bank_mask:0xf
    v_add_f32_dpp v53, v53, v53 row_bcast:31 row_mask:0xc bank_mask:0xf
    s_nop 1
    v_readlane_b32 s24, v50, 63
    v_readlane_b32 s25, v51, 63
    v_readlane_b32 s26, v52, 63
    v_readlane_b32 s27, v53, 63
    s_nop 1
    v_mov_b32 v54, s24
    v_mov_b32 v55, s25
    v_mov_b32 v56, s26
    v_mov_b32 v57, s27
    v_mul_f32 v54, 0x3ae38e39, v54
    v_mul_f32 v55, 0x3ae38e39, v55
    v_mul_f32 v56, 0x3ae38e39, v56
    v_mul_f32 v57, 0x3ae38e39, v57
    v_mov_b32 v50, 0
    v_mov_b32 v51, 0
    v_mov_b32 v52, 0
    v_mov_b32 v53, 0
    v_sub_f32 v58, v10, v54
    v_sub_f32 v59, v19, v55
    v_sub_f32 v60, v28, v56
    v_sub_f32 v61, v37, v57
    v_fmac_f32 v50, v58, v58
    v_fmac_f32 v51, v59, v59
    v_fmac_f32 v52, v60, v60
    v_fmac_f32 v53, v61, v61
    v_sub_f32 v58, v11, v54
    v_sub_f32 v59, v20, v55
    v_sub_f32 v60, v29, v56
    v_sub_f32 v61, v38, v57
    v_fmac_f32 v50, v58, v58
    v_fmac_f32 v51, v59, v59
    v_fmac_f32 v52, v60, v60
    v_fmac_f32 v53, v61, v61
    v_sub_f32 v58, v12, v54
    v_sub_f32 v59, v21, v55
    v_sub_f32 v60, v30, v56
    v_sub_f32 v61, v39, v57
    v_fmac_f32 v50, v58, v58
    v_fmac_f32 v51, v59, v59
    v_fmac_f32 v52, v60, v60
    v_fmac_f32 v53, v61, v61
    v_sub_f32 v58, v13, v54
    v_sub_f32 v59, v22, v55
    v_sub_f32 v60, v31, v56
    v_sub_f32 v61, v40, v57
    v_fmac_f32 v50, v58, v58
    v_fmac_f32 v51, v59, v59
    v_fmac_f32 v52, v60, v60
    v_fmac_f32 v53, v61, v61
    v_sub_f32 v58, v14, v54
    v_sub_f32 v59, v23, v55
    v_sub_f32 v60, v32, v56
    v_sub_f32 v61, v41, v57
    v_fmac_f32 v50, v58, v58
    v_fmac_f32 v51, v59, v59
    v_fmac_f32 v52, v60, v60
    v_fmac_f32 v53, v61, v61
    v_sub_f32 v58, v15, v54
    v_sub_f32 v59, v24, v55
    v_sub_f32 v60, v33, v56
    v_sub_f32 v61, v42, v57
    v_fmac_f32 v50, v58, v58
    v_fmac_f32 v51, v59, v59
    v_fmac_f32 v52, v60, v60
    v_fmac_f32 v53, v61, v61
    v_sub_f32 v58, v16, v54
    v_sub_f32 v59, v25, v55
    v_sub_f32 v60, v34, v56
    v_sub_f32 v61, v43, v57
    v_fmac_f32 v50, v58, v58
    v_fmac_f32 v51, v59, v59
    v_fmac_f32 v52, v60, v60
    v_fmac_f32 v53, v61, v61
    v_sub_f32 v58, v17, v54
    v_sub_f32 v59, v26, v55
    v_sub_f32 v60, v35, v56
    v_sub_f32 v61, v44, v57
    v_fmac_f32 v50, v58, v58
    v_fmac_f32 v51, v59, v59
    v_fmac_f32 v52, v60, v60
    v_fmac_f32 v53, v61, v61
    v_sub_f32 v58, v18, v54
    v_sub_f32 v59, v27, v55
    v_sub_f32 v60, v36, v56
    v_sub_f32 v61, v45, v57
    v_fmac_f32 v50, v58, v58
    v_fmac_f32 v51, v59, v59
    v_fmac_f32 v52, v60, v60
    v_fmac_f32 v53, v61, v61
    s_nop 1
    v_add_f32_dpp v50, v50, v50 quad_perm:[1,0,3,2] row_mask:0xf bank_mask:0xf
    v_add_f32_dpp v51, v51, v51 quad_perm:[1,0,3,2] row_mask:0xf bank_mask:0xf
    v_add_f32_dpp v52, v52, v52 quad_perm:[1,0,3,2] row_mask:0xf bank_mask:0xf
    v_add_f32_dpp v53, v53, v53 quad_perm:[1,0,3,2] row_mask:0xf bank_mask:0xf
    v_add_f32_dpp v50, v50, v50 quad_perm:[2,3,0,1] row_mask:0xf bank_mask:0xf
    v_add_f32_dpp v51, v51, v51 quad_perm:[2,3,0,1] row_mask:0xf bank_mask:0xf
    v_add_f32_dpp v52, v52, v52 quad_perm:[2,3,0,1] row_mask:0xf bank_mask:0xf
    v_add_f32_dpp v53, v53, v53 quad_perm:[2,3,0,1] row_mask:0xf bank_mask:0xf
    v_add_f32_dpp v50, v50, v50 row_half_mirror row_mask:0xf bank_mask:0xf
    v_add_f32_dpp v51, v51, v51 row_half_mirror row_mask:0xf bank_mask:0xf
    v_add_f32_dpp v52, v52, v52 row_half_mirror row_mask:0xf bank_mask:0xf
    v_add_f32_dpp v53, v53, v53 row_half_mirror row_mask:0xf bank_mask:0xf
    v_add_f32_dpp v50, v50, v50 row_mirror row_mask:0xf bank_mask:0xf
    v_add_f32_dpp v51, v51, v51 row_mirror row_mask:0xf bank_mask:0xf
    v_add_f32_dpp v52, v52, v52 row_mirror row_mask:0xf bank_mask:0xf
    v_add_f32_dpp v53, v53, v53 row_mirror row_mask:0xf bank_mask:0xf
    v_add_f32_dpp v50, v50, v50 row_bcast:15 row_mask:0xa bank_mask:0xf
    v_add_f32_dpp v51, v51, v51 row_bcast:15 row_mask:0xa bank_mask:0xf
    v_add_f32_dpp v52, v52, v52 row_bcast:15 row_mask:0xa bank_mask:0xf
    v_add_f32_dpp v53, v53, v53 row_bcast:15 row_mask:0xa bank_mask:0xf
    v_add_f32_dpp v50, v50, v50 row_bcast:31 row_mask:0xc bank_mask:0xf
    v_add_f32_dpp v51, v51, v51 row_bcast:31 row_mask:0xc bank_mask:0xf
    v_add_f32_dpp v52, v52, v52 row_bcast:31 row_mask:0xc bank_mask:0xf
    v_add_f32_dpp v53, v53, v53 row_bcast:31 row_mask:0xc bank_mask:0xf
    s_nop 1
    v_readlane_b32 s24, v50, 63
    v_readlane_b32 s25, v51, 63
    v_readlane_b32 s26, v52, 63
    v_readlane_b32 s27, v53, 63
    s_nop 1
    v_mov_b32 v50, s24
    v_mov_b32 v51, s25
    v_mov_b32 v52, s26
    v_mov_b32 v53, s27
    v_mul_f32 v50, 0x3ae38e39, v50
    v_mul_f32 v51, 0x3ae38e39, v51
    v_mul_f32 v52, 0x3ae38e39, v52
    v_mul_f32 v53, 0x3ae38e39, v53
    v_cvt_pk_bf16_f32 v58, v54, v50
    v_cvt_pk_bf16_f32 v59, v55, v51
    v_cvt_pk_bf16_f32 v60, v56, v52
    v_cvt_pk_bf16_f32 v61, v57, v53
    v_lshlrev_b32 v54, 16, v58
    v_lshlrev_b32 v55, 16, v59
    v_lshlrev_b32 v56, 16, v60
    v_lshlrev_b32 v57, 16, v61
    v_and_b32 v50, 0xffff0000, v58
    v_and_b32 v51, 0xffff0000, v59
    v_and_b32 v52, 0xffff0000, v60
    v_and_b32 v53, 0xffff0000, v61
    v_add_f32 v50, 0x3727c5ac, v50
    v_add_f32 v51, 0x3727c5ac, v51
    v_add_f32 v52, 0x3727c5ac, v52
    v_add_f32 v53, 0x3727c5ac, v53
    v_cvt_pk_bf16_f32 v50, v50, v50
    v_cvt_pk_bf16_f32 v51, v51, v51
    v_cvt_pk_bf16_f32 v52, v52, v52
    v_cvt_pk_bf16_f32 v53, v53, v53
    v_and_b32 v50, 0xffff0000, v50
    v_and_b32 v51, 0xffff0000, v51
    v_and_b32 v52, 0xffff0000, v52
    v_and_b32 v53, 0xffff0000, v53
    v_sqrt_f32 v50, v50
    v_sqrt_f32 v51, v51
    v_sqrt_f32 v52, v52
    v_sqrt_f32 v53, v53
    s_nop 0
    v_cvt_pk_bf16_f32 v50, v50, v50
    v_cvt_pk_bf16_f32 v51, v51, v51
    v_cvt_pk_bf16_f32 v52, v52, v52
    v_cvt_pk_bf16_f32 v53, v53, v53
    v_and_b32 v50, 0xffff0000, v50
    v_and_b32 v51, 0xffff0000, v51
    v_and_b32 v52, 0xffff0000, v52
    v_and_b32 v53, 0xffff0000, v53
    s_add_u32 s32, s18, 0x2f80000
    s_addc_u32 s33, s19, 0
    s_mov_b32 s34, 0x4000
    s_mov_b32 s35, 0x20000
    s_add_u32 s36, s18, 0x2f40000
    s_addc_u32 s37, s19, 0
    s_mov_b32 s38, 0x20000
    s_mov_b32 s39, 0x20000
    v_mov_b32 v66, v50
    v_mov_b32 v67, v54

    v_cmp_eq_u32 vcc, 1, v1
    s_nop 1
    v_cndmask_b32 v66, v66, v51, vcc
    v_cndmask_b32 v67, v67, v55, vcc

    v_cmp_eq_u32 vcc, 2, v1
    s_nop 1
    v_cndmask_b32 v66, v66, v52, vcc
    v_cndmask_b32 v67, v67, v56, vcc

    v_cmp_eq_u32 vcc, 3, v1
    s_nop 1
    v_cndmask_b32 v66, v66, v53, vcc
    v_cndmask_b32 v67, v67, v57, vcc

    v_lshl_add_u32 v68, v2, 2, v1
    v_lshlrev_b32 v68, 3, v68
    s_lshl_b32 s21, s2, 7
    s_mov_b64 exec, 0xf
    buffer_store_dwordx2 v[66:67], v68, s[32:35], s21 offen
    s_mov_b64 exec, -1
    v_lshlrev_b32 v68, 2, v0
    v_mov_b32 v69, 0
    s_lshl_b32 s21, s2, 10
    buffer_store_dword v69, v68, s[36:39], s21 offen

    v_rcp_f32 v58, v50
    v_rcp_f32 v59, v51
    v_rcp_f32 v60, v52
    v_rcp_f32 v61, v53
    s_nop 0
    v_sub_f32 v10, v10, v54
    v_sub_f32 v11, v11, v54
    v_sub_f32 v19, v19, v55
    v_sub_f32 v20, v20, v55
    v_sub_f32 v28, v28, v56
    v_sub_f32 v29, v29, v56
    v_sub_f32 v37, v37, v57
    v_sub_f32 v38, v38, v57
    v_cvt_pk_bf16_f32 v62, v10, v11
    v_cvt_pk_bf16_f32 v63, v19, v20
    v_cvt_pk_bf16_f32 v64, v28, v29
    v_cvt_pk_bf16_f32 v65, v37, v38
    v_lshlrev_b32 v10, 16, v62
    v_and_b32 v11, 0xffff0000, v62
    v_lshlrev_b32 v19, 16, v63
    v_and_b32 v20, 0xffff0000, v63
    v_lshlrev_b32 v28, 16, v64
    v_and_b32 v29, 0xffff0000, v64
    v_lshlrev_b32 v37, 16, v65
    v_and_b32 v38, 0xffff0000, v65
    v_sub_f32 v12, v12, v54
    v_sub_f32 v13, v13, v54
    v_sub_f32 v21, v21, v55
    v_sub_f32 v22, v22, v55
    v_sub_f32 v30, v30, v56
    v_sub_f32 v31, v31, v56
    v_sub_f32 v39, v39, v57
    v_sub_f32 v40, v40, v57
    v_cvt_pk_bf16_f32 v62, v12, v13
    v_cvt_pk_bf16_f32 v63, v21, v22
    v_cvt_pk_bf16_f32 v64, v30, v31
    v_cvt_pk_bf16_f32 v65, v39, v40
    v_lshlrev_b32 v12, 16, v62
    v_and_b32 v13, 0xffff0000, v62
    v_lshlrev_b32 v21, 16, v63
    v_and_b32 v22, 0xffff0000, v63
    v_lshlrev_b32 v30, 16, v64
    v_and_b32 v31, 0xffff0000, v64
    v_lshlrev_b32 v39, 16, v65
    v_and_b32 v40, 0xffff0000, v65
    v_sub_f32 v14, v14, v54
    v_sub_f32 v15, v15, v54
    v_sub_f32 v23, v23, v55
    v_sub_f32 v24, v24, v55
    v_sub_f32 v32, v32, v56
    v_sub_f32 v33, v33, v56
    v_sub_f32 v41, v41, v57
    v_sub_f32 v42, v42, v57
    v_cvt_pk_bf16_f32 v62, v14, v15
    v_cvt_pk_bf16_f32 v63, v23, v24
    v_cvt_pk_bf16_f32 v64, v32, v33
    v_cvt_pk_bf16_f32 v65, v41, v42
    v_lshlrev_b32 v14, 16, v62
    v_and_b32 v15, 0xffff0000, v62
    v_lshlrev_b32 v23, 16, v63
    v_and_b32 v24, 0xffff0000, v63
    v_lshlrev_b32 v32, 16, v64
    v_and_b32 v33, 0xffff0000, v64
    v_lshlrev_b32 v41, 16, v65
    v_and_b32 v42, 0xffff0000, v65
    v_sub_f32 v16, v16, v54
    v_sub_f32 v17, v17, v54
    v_sub_f32 v25, v25, v55
    v_sub_f32 v26, v26, v55
    v_sub_f32 v34, v34, v56
    v_sub_f32 v35, v35, v56
    v_sub_f32 v43, v43, v57
    v_sub_f32 v44, v44, v57
    v_cvt_pk_bf16_f32 v62, v16, v17
    v_cvt_pk_bf16_f32 v63, v25, v26
    v_cvt_pk_bf16_f32 v64, v34, v35
    v_cvt_pk_bf16_f32 v65, v43, v44
    v_lshlrev_b32 v16, 16, v62
    v_and_b32 v17, 0xffff0000, v62
    v_lshlrev_b32 v25, 16, v63
    v_and_b32 v26, 0xffff0000, v63
    v_lshlrev_b32 v34, 16, v64
    v_and_b32 v35, 0xffff0000, v64
    v_lshlrev_b32 v43, 16, v65
    v_and_b32 v44, 0xffff0000, v65
    v_sub_f32 v18, v18, v54
    v_sub_f32 v27, v27, v55
    v_sub_f32 v36, v36, v56
    v_sub_f32 v45, v45, v57
    v_cvt_pk_bf16_f32 v62, v18, v18
    v_cvt_pk_bf16_f32 v63, v27, v27
    v_cvt_pk_bf16_f32 v64, v36, v36
    v_cvt_pk_bf16_f32 v65, v45, v45
    v_lshlrev_b32 v18, 16, v62
    v_lshlrev_b32 v27, 16, v63
    v_lshlrev_b32 v36, 16, v64
    v_lshlrev_b32 v45, 16, v65
    v_mul_f32 v62, v10, v58
    v_mul_f32 v63, v19, v59
    v_mul_f32 v64, v28, v60
    v_mul_f32 v65, v37, v61
    v_fma_f32 v10, -v62, v50, v10
    v_fma_f32 v19, -v63, v51, v19
    v_fma_f32 v28, -v64, v52, v28
    v_fma_f32 v37, -v65, v53, v37
    v_fma_f32 v10, v10, v58, v62
    v_fma_f32 v19, v19, v59, v63
    v_fma_f32 v28, v28, v60, v64
    v_fma_f32 v37, v37, v61, v65
    v_mul_f32 v62, v11, v58
    v_mul_f32 v63, v20, v59
    v_mul_f32 v64, v29, v60
    v_mul_f32 v65, v38, v61
    v_fma_f32 v11, -v62, v50, v11
    v_fma_f32 v20, -v63, v51, v20
    v_fma_f32 v29, -v64, v52, v29
    v_fma_f32 v38, -v65, v53, v38
    v_fma_f32 v11, v11, v58, v62
    v_fma_f32 v20, v20, v59, v63
    v_fma_f32 v29, v29, v60, v64
    v_fma_f32 v38, v38, v61, v65
    v_mul_f32 v62, v12, v58
    v_mul_f32 v63, v21, v59
    v_mul_f32 v64, v30, v60
    v_mul_f32 v65, v39, v61
    v_fma_f32 v12, -v62, v50, v12
    v_fma_f32 v21, -v63, v51, v21
    v_fma_f32 v30, -v64, v52, v30
    v_fma_f32 v39, -v65, v53, v39
    v_fma_f32 v12, v12, v58, v62
    v_fma_f32 v21, v21, v59, v63
    v_fma_f32 v30, v30, v60, v64
    v_fma_f32 v39, v39, v61, v65
    v_mul_f32 v62, v13, v58
    v_mul_f32 v63, v22, v59
    v_mul_f32 v64, v31, v60
    v_mul_f32 v65, v40, v61
    v_fma_f32 v13, -v62, v50, v13
    v_fma_f32 v22, -v63, v51, v22
    v_fma_f32 v31, -v64, v52, v31
    v_fma_f32 v40, -v65, v53, v40
    v_fma_f32 v13, v13, v58, v62
    v_fma_f32 v22, v22, v59, v63
    v_fma_f32 v31, v31, v60, v64
    v_fma_f32 v40, v40, v61, v65
    v_mul_f32 v62, v14, v58
    v_mul_f32 v63, v23, v59
    v_mul_f32 v64, v32, v60
    v_mul_f32 v65, v41, v61
    v_fma_f32 v14, -v62, v50, v14
    v_fma_f32 v23, -v63, v51, v23
    v_fma_f32 v32, -v64, v52, v32
    v_fma_f32 v41, -v65, v53, v41
    v_fma_f32 v14, v14, v58, v62
    v_fma_f32 v23, v23, v59, v63
    v_fma_f32 v32, v32, v60, v64
    v_fma_f32 v41, v41, v61, v65
    v_mul_f32 v62, v15, v58
    v_mul_f32 v63, v24, v59
    v_mul_f32 v64, v33, v60
    v_mul_f32 v65, v42, v61
    v_fma_f32 v15, -v62, v50, v15
    v_fma_f32 v24, -v63, v51, v24
    v_fma_f32 v33, -v64, v52, v33
    v_fma_f32 v42, -v65, v53, v42
    v_fma_f32 v15, v15, v58, v62
    v_fma_f32 v24, v24, v59, v63
    v_fma_f32 v33, v33, v60, v64
    v_fma_f32 v42, v42, v61, v65
    v_mul_f32 v62, v16, v58
    v_mul_f32 v63, v25, v59
    v_mul_f32 v64, v34, v60
    v_mul_f32 v65, v43, v61
    v_fma_f32 v16, -v62, v50, v16
    v_fma_f32 v25, -v63, v51, v25
    v_fma_f32 v34, -v64, v52, v34
    v_fma_f32 v43, -v65, v53, v43
    v_fma_f32 v16, v16, v58, v62
    v_fma_f32 v25, v25, v59, v63
    v_fma_f32 v34, v34, v60, v64
    v_fma_f32 v43, v43, v61, v65
    v_mul_f32 v62, v17, v58
    v_mul_f32 v63, v26, v59
    v_mul_f32 v64, v35, v60
    v_mul_f32 v65, v44, v61
    v_fma_f32 v17, -v62, v50, v17
    v_fma_f32 v26, -v63, v51, v26
    v_fma_f32 v35, -v64, v52, v35
    v_fma_f32 v44, -v65, v53, v44
    v_fma_f32 v17, v17, v58, v62
    v_fma_f32 v26, v26, v59, v63
    v_fma_f32 v35, v35, v60, v64
    v_fma_f32 v44, v44, v61, v65
    v_mul_f32 v62, v18, v58
    v_mul_f32 v63, v27, v59
    v_mul_f32 v64, v36, v60
    v_mul_f32 v65, v45, v61
    v_fma_f32 v18, -v62, v50, v18
    v_fma_f32 v27, -v63, v51, v27
    v_fma_f32 v36, -v64, v52, v36
    v_fma_f32 v45, -v65, v53, v45
    v_fma_f32 v18, v18, v58, v62
    v_fma_f32 v27, v27, v59, v63
    v_fma_f32 v36, v36, v60, v64
    v_fma_f32 v45, v45, v61, v65
    v_cvt_pk_bf16_f32 v10, v10, v11
    v_cvt_pk_bf16_f32 v12, v12, v13
    v_cvt_pk_bf16_f32 v14, v14, v15
    v_cvt_pk_bf16_f32 v16, v16, v17
    v_cvt_pk_bf16_f32 v18, v18, v18
    v_cvt_pk_bf16_f32 v19, v19, v20
    v_cvt_pk_bf16_f32 v21, v21, v22
    v_cvt_pk_bf16_f32 v23, v23, v24
    v_cvt_pk_bf16_f32 v25, v25, v26
    v_cvt_pk_bf16_f32 v27, v27, v27
    v_cvt_pk_bf16_f32 v28, v28, v29
    v_cvt_pk_bf16_f32 v30, v30, v31
    v_cvt_pk_bf16_f32 v32, v32, v33
    v_cvt_pk_bf16_f32 v34, v34, v35
    v_cvt_pk_bf16_f32 v36, v36, v36
    v_cvt_pk_bf16_f32 v37, v37, v38
    v_cvt_pk_bf16_f32 v39, v39, v40
    v_cvt_pk_bf16_f32 v41, v41, v42
    v_cvt_pk_bf16_f32 v43, v43, v44
    v_cvt_pk_bf16_f32 v45, v45, v45
    ds_write_b16 v4, v10 offset:0
    ds_write_b16_d16_hi v4, v10 offset:128
    ds_write_b16 v4, v12 offset:256
    ds_write_b16_d16_hi v4, v12 offset:384
    ds_write_b16 v4, v14 offset:512
    ds_write_b16_d16_hi v4, v14 offset:640
    ds_write_b16 v4, v16 offset:768
    ds_write_b16_d16_hi v4, v16 offset:896
    ds_write_b16 v4, v18 offset:1024
    ds_write_b16 v4, v19 offset:1156
    ds_write_b16_d16_hi v4, v19 offset:1284
    ds_write_b16 v4, v21 offset:1412
    ds_write_b16_d16_hi v4, v21 offset:1540
    ds_write_b16 v4, v23 offset:1668
    ds_write_b16_d16_hi v4, v23 offset:1796
    ds_write_b16 v4, v25 offset:1924
    ds_write_b16_d16_hi v4, v25 offset:2052
    ds_write_b16 v4, v27 offset:2180
    ds_write_b16 v4, v28 offset:2312
    ds_write_b16_d16_hi v4, v28 offset:2440
    ds_write_b16 v4, v30 offset:2568
    ds_write_b16_d16_hi v4, v30 offset:2696
    ds_write_b16 v4, v32 offset:2824
    ds_write_b16_d16_hi v4, v32 offset:2952
    ds_write_b16 v4, v34 offset:3080
    ds_write_b16_d16_hi v4, v34 offset:3208
    ds_write_b16 v4, v36 offset:3336
    ds_write_b16 v4, v37 offset:3468
    ds_write_b16_d16_hi v4, v37 offset:3596
    ds_write_b16 v4, v39 offset:3724
    ds_write_b16_d16_hi v4, v39 offset:3852
    ds_write_b16 v4, v41 offset:3980
    ds_write_b16_d16_hi v4, v41 offset:4108
    ds_write_b16 v4, v43 offset:4236
    ds_write_b16_d16_hi v4, v43 offset:4364
    ds_write_b16 v4, v45 offset:4492
    v_lshrrev_b32 v5, 1, v0
    v_and_b32 v6, 1, v0
    s_movk_i32 s21, 9248
    v_mul_lo_u32 v7, v6, s21
    v_lshl_add_u32 v7, v5, 1, v7
    v_lshlrev_b32 v8, 4, v0
    s_mul_i32 s3, s2, 18432
    v_add_u32 v8, s3, v8
    s_waitcnt lgkmcnt(0)
    s_barrier
    v_readfirstlane_b32 s22, v2

    ds_read_u16 v12, v7 offset:0
    ds_read_u16_d16_hi v16, v7 offset:1156
    ds_read_u16 v13, v7 offset:2312
    ds_read_u16_d16_hi v17, v7 offset:3468
    ds_read_u16 v14, v7 offset:4624
    ds_read_u16_d16_hi v18, v7 offset:5780
    ds_read_u16 v15, v7 offset:6936
    ds_read_u16_d16_hi v19, v7 offset:8092
    s_mov_b32 s23, 0
    s_waitcnt lgkmcnt(0)
    v_or_b32 v12, v12, v16
    v_or_b32 v13, v13, v17
    v_or_b32 v14, v14, v18
    v_or_b32 v15, v15, v19
    buffer_store_dwordx4 v[12:15], v8, s[12:15], s23 offen sc1
    ds_read_u16 v20, v7 offset:256
    ds_read_u16_d16_hi v24, v7 offset:1412
    ds_read_u16 v21, v7 offset:2568
    ds_read_u16_d16_hi v25, v7 offset:3724
    ds_read_u16 v22, v7 offset:4880
    ds_read_u16_d16_hi v26, v7 offset:6036
    ds_read_u16 v23, v7 offset:7192
    ds_read_u16_d16_hi v27, v7 offset:8348
    s_mov_b32 s23, 4096
    s_waitcnt lgkmcnt(0)
    v_or_b32 v20, v20, v24
    v_or_b32 v21, v21, v25
    v_or_b32 v22, v22, v26
    v_or_b32 v23, v23, v27
    buffer_store_dwordx4 v[20:23], v8, s[12:15], s23 offen sc1
    ds_read_u16 v28, v7 offset:512
    ds_read_u16_d16_hi v32, v7 offset:1668
    ds_read_u16 v29, v7 offset:2824
    ds_read_u16_d16_hi v33, v7 offset:3980
    ds_read_u16 v30, v7 offset:5136
    ds_read_u16_d16_hi v34, v7 offset:6292
    ds_read_u16 v31, v7 offset:7448
    ds_read_u16_d16_hi v35, v7 offset:8604
    s_mov_b32 s23, 8192
    s_waitcnt lgkmcnt(0)
    v_or_b32 v28, v28, v32
    v_or_b32 v29, v29, v33
    v_or_b32 v30, v30, v34
    v_or_b32 v31, v31, v35
    buffer_store_dwordx4 v[28:31], v8, s[12:15], s23 offen sc1
    ds_read_u16 v36, v7 offset:768
    ds_read_u16_d16_hi v40, v7 offset:1924
    ds_read_u16 v37, v7 offset:3080
    ds_read_u16_d16_hi v41, v7 offset:4236
    ds_read_u16 v38, v7 offset:5392
    ds_read_u16_d16_hi v42, v7 offset:6548
    ds_read_u16 v39, v7 offset:7704
    ds_read_u16_d16_hi v43, v7 offset:8860
    s_mov_b32 s23, 12288
    s_waitcnt lgkmcnt(0)
    v_or_b32 v36, v36, v40
    v_or_b32 v37, v37, v41
    v_or_b32 v38, v38, v42
    v_or_b32 v39, v39, v43
    buffer_store_dwordx4 v[36:39], v8, s[12:15], s23 offen sc1
    s_cmp_ge_u32 s22, 2
    s_cbranch_scc1 KF_ln_done
    ds_read_u16 v44, v7 offset:1024
    ds_read_u16_d16_hi v48, v7 offset:2180
    ds_read_u16 v45, v7 offset:3336
    ds_read_u16_d16_hi v49, v7 offset:4492
    ds_read_u16 v46, v7 offset:5648
    ds_read_u16_d16_hi v50, v7 offset:6804
    ds_read_u16 v47, v7 offset:7960
    ds_read_u16_d16_hi v51, v7 offset:9116
    s_mov_b32 s23, 16384
    s_waitcnt lgkmcnt(0)
    v_or_b32 v44, v44, v48
    v_or_b32 v45, v45, v49
    v_or_b32 v46, v46, v50
    v_or_b32 v47, v47, v51
    buffer_store_dwordx4 v[44:47], v8, s[12:15], s23 offen sc1
KF_ln_done:
    s_waitcnt vmcnt(0)
    s_barrier
    s_cmp_lg_u32 s22, 0
    s_cbranch_scc1 KF_ln_fin
    v_mov_b32 v4, 0
    v_mov_b32 v5, 1
    s_mov_b64 exec, 1
    buffer_atomic_add v5, v4, s[28:31], 0 offen sc0 sc1
    s_waitcnt vmcnt(0)
    v_readfirstlane_b32 s23, v5
    s_cmp_lg_u32 s23, 127
    s_cbranch_scc1 KF_ln_notlast
    v_mov_b32 v5, 1
    buffer_store_dword v5, v4, s[28:31], 0 offen offset:128 sc1

KF_ln_notlast:
    s_mov_b64 exec, -1
KF_ln_fin:
    s_endpgm
KF_kgen:
    s_sub_u32 s3, s2, 128
    s_lshr_b32 s20, s3, 6
    s_lshl_b32 s20, s20, 3
    s_and_b32 s21, s3, 7
    s_add_u32 s20, s20, s21
    s_lshr_b32 s21, s3, 3
    s_and_b32 s21, s21, 7
    s_lshl_b32 s3, s20, 3
    s_add_u32 s3, s3, s21
    s_load_dwordx4 s[4:7], s[0:1], 8
    s_load_dwordx4 s[8:11], s[0:1], 24
    s_load_dwordx4 s[12:15], s[0:1], 40
    s_load_dwordx2 s[16:17], s[0:1], 56
    s_load_dwordx4 s[56:59], s[0:1], 112
    v_lshrrev_b32 v2, 6, v0
    v_and_b32 v1, 63, v0
    v_and_b32 v3, 15, v0
    v_lshrrev_b32 v4, 4, v1
    s_lshl_b32 s20, s3, 8
    v_lshlrev_b32 v5, 6, v2
    v_lshl_add_u32 v5, v4, 4, v5
    v_add_u32 v5, s20, v5
    s_lshl_b32 s21, s3, 1
    v_mov_b32 v6, s21
    v_readfirstlane_b32 s22, v2
    s_waitcnt lgkmcnt(0)

    s_mov_b32 s24, s4
    s_mov_b32 s25, s5
    s_mov_b32 s26, 0x24000
    s_mov_b32 s27, 0x20000
    s_mov_b32 s28, s6
    s_mov_b32 s29, s7
    s_mov_b32 s30, 0x24000
    s_mov_b32 s31, 0x20000
    s_mov_b32 s32, s8
    s_mov_b32 s33, s9
    s_mov_b32 s34, 0x24000
    s_mov_b32 s35, 0x20000
    s_mov_b32 s36, s10
    s_mov_b32 s37, s11
    s_mov_b32 s38, 0x24000
    s_mov_b32 s39, 0x20000
    s_mov_b32 s40, s12
    s_mov_b32 s41, s13
    s_mov_b32 s42, 0x24000
    s_mov_b32 s43, 0x20000
    s_mov_b32 s44, s14
    s_mov_b32 s45, s15
    s_mov_b32 s46, 0x24000
    s_mov_b32 s47, 0x20000
    s_mov_b32 s48, s16
    s_mov_b32 s49, s17
    s_mov_b32 s50, 0x480
    s_mov_b32 s51, 0x20000
    buffer_load_short_d16_hi v9, v6, s[48:51], 0 offen
    buffer_load_dwordx4 v[12:15], v5, s[24:27], 0 offen
    buffer_load_dwordx4 v[16:19], v5, s[28:31], 0 offen
    buffer_load_dwordx4 v[20:23], v5, s[32:35], 0 offen
    buffer_load_dwordx4 v[24:27], v5, s[36:39], 0 offen
    buffer_load_dwordx4 v[28:31], v5, s[40:43], 0 offen
    buffer_load_dwordx4 v[32:35], v5, s[44:47], 0 offen
    s_mov_b32 s4, s58
    s_mov_b32 s5, s59
    s_mov_b32 s6, 0x240000
    s_mov_b32 s7, 0x20000
    s_add_u32 s8, s58, 0x240000
    s_addc_u32 s9, s59, 0
    s_mov_b32 s10, 0x240000
    s_mov_b32 s11, 0x20000
    s_mov_b32 s12, s56
    s_mov_b32 s13, s57
    s_mov_b32 s14, 0x100
    s_mov_b32 s15, 0x20000
    v_lshlrev_b32 v7, 3, v3
    v_cvt_f32_u32 v7, v7
    v_lshrrev_b32 v36, 3, v3
    v_lshlrev_b32 v36, 7, v36
    v_and_b32 v37, 7, v3
    v_add_u32 v36, v36, v37
    v_lshrrev_b32 v37, 2, v3
    v_lshlrev_b32 v37, 7, v37
    v_and_b32 v38, 3, v3
    v_lshl_add_u32 v37, v38, 1, v37
    v_add_u32 v37, 0x100, v37
    v_subrev_u32 v38, 8, v3
    v_lshrrev_b32 v38, 1, v38
    v_lshlrev_b32 v38, 7, v38
    v_and_b32 v39, 1, v3
    v_lshl_add_u32 v38, v39, 2, v38
    v_add_u32 v38, 0x200, v38
    v_cmp_gt_u32 vcc, 8, v3
    v_lshlrev_b32 v39, 7, v3
    v_add_u32 v39, 0x400, v39
    v_cndmask_b32 v37, v38, v37, vcc
    v_cmp_gt_u32 vcc, 9, v3
    v_mov_b32 v38, 0
    s_nop 0
    v_cndmask_b32 v38, v38, v39, vcc
    v_cvt_f32_u32 v36, v36
    v_cvt_f32_u32 v37, v37
    v_cvt_f32_u32 v38, v38

    v_mov_b32 v40, 0
    v_mov_b32 v41, 0
    v_mov_b32 v42, 0
    v_mov_b32 v43, 0
    v_mov_b32 v44, 0
    v_mov_b32 v45, 0
    v_mov_b32 v46, 0
    v_mov_b32 v47, 0
    v_mov_b32 v48, 0
    v_mov_b32 v49, 0
    v_mov_b32 v50, 0
    v_mov_b32 v51, 0
    v_lshlrev_b32 v99, 3, v0
    v_sub_u32 v99, 0x7ff, v99

    v_subrev_u32 v100, 0, v99
    v_cvt_f32_u32 v101, v100
    v_cvt_pk_bf16_f32 v102, v101, v101
    v_bfe_u32 v103, v102, 7, 8
    v_lshlrev_b32 v102, 16, v102
    v_cvt_u32_f32 v104, v102
    v_subrev_u32 v105, 134, v103
    v_max_i32 v105, 0, v105
    v_min_i32 v105, 3, v105
    v_lshrrev_b32 v103, 7, v104
    v_and_b32 v101, 7, v104
    v_lshl_add_u32 v103, v103, 3, v101
    v_lshrrev_b32 v103, v105, v103
    v_lshl_add_u32 v103, v105, 3, v103
    v_bfe_u32 v101, v104, 3, 4
    v_lshrrev_b32 v100, 2, v103
    v_lshl_add_u32 v101, v100, 4, v101
    v_and_b32 v103, 3, v103
    v_lshl_add_u32 v103, v101, 2, v103
    v_lshlrev_b32 v90, 2, v103

    v_subrev_u32 v100, 1, v99
    v_cvt_f32_u32 v101, v100
    v_cvt_pk_bf16_f32 v102, v101, v101
    v_bfe_u32 v103, v102, 7, 8
    v_lshlrev_b32 v102, 16, v102
    v_cvt_u32_f32 v104, v102
    v_subrev_u32 v105, 134, v103
    v_max_i32 v105, 0, v105
    v_min_i32 v105, 3, v105
    v_lshrrev_b32 v103, 7, v104
    v_and_b32 v101, 7, v104
    v_lshl_add_u32 v103, v103, 3, v101
    v_lshrrev_b32 v103, v105, v103
    v_lshl_add_u32 v103, v105, 3, v103
    v_bfe_u32 v101, v104, 3, 4
    v_lshrrev_b32 v100, 2, v103
    v_lshl_add_u32 v101, v100, 4, v101
    v_and_b32 v103, 3, v103
    v_lshl_add_u32 v103, v101, 2, v103
    v_lshlrev_b32 v91, 2, v103

    v_subrev_u32 v100, 2, v99
    v_cvt_f32_u32 v101, v100
    v_cvt_pk_bf16_f32 v102, v101, v101
    v_bfe_u32 v103, v102, 7, 8
    v_lshlrev_b32 v102, 16, v102
    v_cvt_u32_f32 v104, v102
    v_subrev_u32 v105, 134, v103
    v_max_i32 v105, 0, v105
    v_min_i32 v105, 3, v105
    v_lshrrev_b32 v103, 7, v104
    v_and_b32 v101, 7, v104
    v_lshl_add_u32 v103, v103, 3, v101
    v_lshrrev_b32 v103, v105, v103
    v_lshl_add_u32 v103, v105, 3, v103
    v_bfe_u32 v101, v104, 3, 4
    v_lshrrev_b32 v100, 2, v103
    v_lshl_add_u32 v101, v100, 4, v101
    v_and_b32 v103, 3, v103
    v_lshl_add_u32 v103, v101, 2, v103
    v_lshlrev_b32 v92, 2, v103

    v_subrev_u32 v100, 3, v99
    v_cvt_f32_u32 v101, v100
    v_cvt_pk_bf16_f32 v102, v101, v101
    v_bfe_u32 v103, v102, 7, 8
    v_lshlrev_b32 v102, 16, v102
    v_cvt_u32_f32 v104, v102
    v_subrev_u32 v105, 134, v103
    v_max_i32 v105, 0, v105
    v_min_i32 v105, 3, v105
    v_lshrrev_b32 v103, 7, v104
    v_and_b32 v101, 7, v104
    v_lshl_add_u32 v103, v103, 3, v101
    v_lshrrev_b32 v103, v105, v103
    v_lshl_add_u32 v103, v105, 3, v103
    v_bfe_u32 v101, v104, 3, 4
    v_lshrrev_b32 v100, 2, v103
    v_lshl_add_u32 v101, v100, 4, v101
    v_and_b32 v103, 3, v103
    v_lshl_add_u32 v103, v101, 2, v103
    v_lshlrev_b32 v93, 2, v103

    v_subrev_u32 v100, 4, v99
    v_cvt_f32_u32 v101, v100
    v_cvt_pk_bf16_f32 v102, v101, v101
    v_bfe_u32 v103, v102, 7, 8
    v_lshlrev_b32 v102, 16, v102
    v_cvt_u32_f32 v104, v102
    v_subrev_u32 v105, 134, v103
    v_max_i32 v105, 0, v105
    v_min_i32 v105, 3, v105
    v_lshrrev_b32 v103, 7, v104
    v_and_b32 v101, 7, v104
    v_lshl_add_u32 v103, v103, 3, v101
    v_lshrrev_b32 v103, v105, v103
    v_lshl_add_u32 v103, v105, 3, v103
    v_bfe_u32 v101, v104, 3, 4
    v_lshrrev_b32 v100, 2, v103
    v_lshl_add_u32 v101, v100, 4, v101
    v_and_b32 v103, 3, v103
    v_lshl_add_u32 v103, v101, 2, v103
    v_lshlrev_b32 v94, 2, v103

    v_subrev_u32 v100, 5, v99
    v_cvt_f32_u32 v101, v100
    v_cvt_pk_bf16_f32 v102, v101, v101
    v_bfe_u32 v103, v102, 7, 8
    v_lshlrev_b32 v102, 16, v102
    v_cvt_u32_f32 v104, v102
    v_subrev_u32 v105, 134, v103
    v_max_i32 v105, 0, v105
    v_min_i32 v105, 3, v105
    v_lshrrev_b32 v103, 7, v104
    v_and_b32 v101, 7, v104
    v_lshl_add_u32 v103, v103, 3, v101
    v_lshrrev_b32 v103, v105, v103
    v_lshl_add_u32 v103, v105, 3, v103
    v_bfe_u32 v101, v104, 3, 4
    v_lshrrev_b32 v100, 2, v103
    v_lshl_add_u32 v101, v100, 4, v101
    v_and_b32 v103, 3, v103
    v_lshl_add_u32 v103, v101, 2, v103
    v_lshlrev_b32 v95, 2, v103

    v_subrev_u32 v100, 6, v99
    v_cvt_f32_u32 v101, v100
    v_cvt_pk_bf16_f32 v102, v101, v101
    v_bfe_u32 v103, v102, 7, 8
    v_lshlrev_b32 v102, 16, v102
    v_cvt_u32_f32 v104, v102
    v_subrev_u32 v105, 134, v103
    v_max_i32 v105, 0, v105
    v_min_i32 v105, 3, v105
    v_lshrrev_b32 v103, 7, v104
    v_and_b32 v101, 7, v104
    v_lshl_add_u32 v103, v103, 3, v101
    v_lshrrev_b32 v103, v105, v103
    v_lshl_add_u32 v103, v105, 3, v103
    v_bfe_u32 v101, v104, 3, 4
    v_lshrrev_b32 v100, 2, v103
    v_lshl_add_u32 v101, v100, 4, v101
    v_and_b32 v103, 3, v103
    v_lshl_add_u32 v103, v101, 2, v103
    v_lshlrev_b32 v96, 2, v103

    v_subrev_u32 v100, 7, v99
    v_cvt_f32_u32 v101, v100
    v_cvt_pk_bf16_f32 v102, v101, v101
    v_bfe_u32 v103, v102, 7, 8
    v_lshlrev_b32 v102, 16, v102
    v_cvt_u32_f32 v104, v102
    v_subrev_u32 v105, 134, v103
    v_max_i32 v105, 0, v105
    v_min_i32 v105, 3, v105
    v_lshrrev_b32 v103, 7, v104
    v_and_b32 v101, 7, v104
    v_lshl_add_u32 v103, v103, 3, v101
    v_lshrrev_b32 v103, v105, v103
    v_lshl_add_u32 v103, v105, 3, v103
    v_bfe_u32 v101, v104, 3, 4
    v_lshrrev_b32 v100, 2, v103
    v_lshl_add_u32 v101, v100, 4, v101
    v_and_b32 v103, 3, v103
    v_lshl_add_u32 v103, v101, 2, v103
    v_lshlrev_b32 v97, 2, v103

    v_subrev_u32 v100, 8, v99
    v_cvt_f32_u32 v101, v100
    v_cvt_pk_bf16_f32 v102, v101, v101
    v_bfe_u32 v103, v102, 7, 8
    v_lshlrev_b32 v102, 16, v102
    v_cvt_u32_f32 v104, v102
    v_subrev_u32 v105, 134, v103
    v_max_i32 v105, 0, v105
    v_min_i32 v105, 3, v105
    v_lshrrev_b32 v103, 7, v104
    v_and_b32 v101, 7, v104
    v_lshl_add_u32 v103, v103, 3, v101
    v_lshrrev_b32 v103, v105, v103
    v_lshl_add_u32 v103, v105, 3, v103
    v_bfe_u32 v101, v104, 3, 4
    v_lshrrev_b32 v100, 2, v103
    v_lshl_add_u32 v101, v100, 4, v101
    v_and_b32 v103, 3, v103
    v_lshl_add_u32 v103, v101, 2, v103
    v_lshlrev_b32 v98, 2, v103

    v_and_b32 v98, 0xfff, v98
    v_lshrrev_b32 v106, 4, v1
    v_lshlrev_b32 v100, 4, v106
    v_lshrrev_b32 v101, 1, v3
    v_lshlrev_b32 v101, 3, v101
    v_lshlrev_b32 v102, 5, v106
    v_sub_u32 v102, v102, v101
    v_lshlrev_b32 v103, 8, v2
    v_sub_u32 v102, v102, v103
    v_and_b32 v101, 1, v3
    v_cmp_eq_u32 vcc, 0, v101
    v_mov_b32 v104, 9528
    v_mov_b32 v105, 17788
    v_cndmask_b32 v104, v104, v105, vcc
    v_add_u32 v155, v102, v104

    v_add_u32 v154, 0x400, v155
    v_add_u32 v153, 0x400, v154
    v_add_u32 v152, 0x400, v153
    v_add_u32 v151, 0x400, v152
    v_add_u32 v150, 0x400, v151
    v_add_u32 v149, 0x400, v150
    v_add_u32 v148, 0x400, v149
    v_lshlrev_b32 v103, 7, v2
    v_lshl_add_u32 v156, v3, 5, v100
    v_sub_u32 v156, v156, v103
    v_add_u32 v156, 416, v156
    v_lshlrev_b32 v157, 6, v2
    v_lshl_add_u32 v157, v3, 1, v157
    v_lshrrev_b32 v100, 1, v106
    v_add_u32 v157, v157, v100
    v_mul_u32_u24 v157, 9216, v157
    v_and_b32 v100, 1, v106
    v_lshl_add_u32 v157, v100, 3, v157
    v_lshlrev_b32 v158, 4, v0
    v_lshrrev_b32 v159, 1, v0
    v_mul_u32_u24 v159, 18432, v159
    v_and_b32 v100, 1, v0
    v_lshl_add_u32 v159, v100, 4, v159
    s_waitcnt vmcnt(0)
    v_mul_f32 v9, 0x3fb8aa3b, v9
    v_exp_f32 v9, v9
    s_nop 0
    v_cvt_pk_bf16_f32 v9, v9, v9
    v_and_b32 v9, 0xffff0000, v9

    v_lshlrev_b32 v56, 16, v12
    v_lshlrev_b32 v57, 16, v16
    v_lshlrev_b32 v58, 16, v20
    v_lshlrev_b32 v59, 16, v24
    v_lshlrev_b32 v60, 16, v28
    v_lshlrev_b32 v61, 16, v32
    v_mul_f32 v56, v9, v56
    v_mul_f32 v57, v9, v57
    v_mul_f32 v58, v9, v58
    v_mul_f32 v59, v9, v59
    v_mul_f32 v56, 0x3fb8aa3b, v56
    v_mul_f32 v57, 0x3e22f983, v57
    v_mul_f32 v74, v61, v59
    v_mul_f32 v75, v61, v58
    v_fma_f32 v62, v60, v58, -v74
    v_fma_f32 v63, v60, v59, v75

    v_mul_f32 v74, v56, v7
    v_mul_f32 v75, v56, v36
    v_mul_f32 v76, v56, v37
    v_mul_f32 v77, v56, v38
    v_mul_f32 v78, v57, v7
    v_mul_f32 v79, v57, v36
    v_mul_f32 v80, v57, v37
    v_mul_f32 v81, v57, v38
    v_exp_f32 v74, v74
    v_exp_f32 v75, v75
    v_exp_f32 v76, v76
    v_exp_f32 v77, v77
    v_fract_f32 v78, v78
    v_fract_f32 v79, v79
    v_fract_f32 v80, v80
    v_fract_f32 v81, v81
    v_cos_f32 v64, v78
    v_sin_f32 v65, v78
    v_cos_f32 v68, v79
    v_sin_f32 v69, v79
    v_cos_f32 v70, v80
    v_sin_f32 v71, v80
    v_cos_f32 v72, v81
    v_sin_f32 v73, v81
    v_mul_f32 v64, v74, v64
    v_mul_f32 v65, v74, v65
    v_mul_f32 v68, v75, v68
    v_mul_f32 v69, v75, v69
    v_mul_f32 v70, v76, v70
    v_mul_f32 v71, v76, v71
    v_mul_f32 v72, v77, v72
    v_mul_f32 v73, v77, v73
    v_mul_f32 v74, v63, v65
    v_mul_f32 v75, v63, v64
    v_fma_f32 v66, v62, v64, -v74
    v_fma_f32 v67, -v62, v65, -v75
    s_nop 1

    v_mfma_f32_16x16x4_f32 v[40:43], v68, v66, v[40:43]
    v_mfma_f32_16x16x4_f32 v[44:47], v70, v66, v[44:47]
    v_mfma_f32_16x16x4_f32 v[48:51], v72, v66, v[48:51]
    v_mfma_f32_16x16x4_f32 v[40:43], v69, v67, v[40:43]
    v_mfma_f32_16x16x4_f32 v[44:47], v71, v67, v[44:47]
    v_mfma_f32_16x16x4_f32 v[48:51], v73, v67, v[48:51]
    v_and_b32 v56, 0xffff0000, v12
    v_and_b32 v57, 0xffff0000, v16
    v_and_b32 v58, 0xffff0000, v20
    v_and_b32 v59, 0xffff0000, v24
    v_and_b32 v60, 0xffff0000, v28
    v_and_b32 v61, 0xffff0000, v32
    v_mul_f32 v56, v9, v56
    v_mul_f32 v57, v9, v57
    v_mul_f32 v58, v9, v58
    v_mul_f32 v59, v9, v59
    v_mul_f32 v56, 0x3fb8aa3b, v56
    v_mul_f32 v57, 0x3e22f983, v57
    v_mul_f32 v74, v61, v59
    v_mul_f32 v75, v61, v58
    v_fma_f32 v62, v60, v58, -v74
    v_fma_f32 v63, v60, v59, v75

    v_mul_f32 v74, v56, v7
    v_mul_f32 v75, v56, v36
    v_mul_f32 v76, v56, v37
    v_mul_f32 v77, v56, v38
    v_mul_f32 v78, v57, v7
    v_mul_f32 v79, v57, v36
    v_mul_f32 v80, v57, v37
    v_mul_f32 v81, v57, v38
    v_exp_f32 v74, v74
    v_exp_f32 v75, v75
    v_exp_f32 v76, v76
    v_exp_f32 v77, v77
    v_fract_f32 v78, v78
    v_fract_f32 v79, v79
    v_fract_f32 v80, v80
    v_fract_f32 v81, v81
    v_cos_f32 v64, v78
    v_sin_f32 v65, v78
    v_cos_f32 v68, v79
    v_sin_f32 v69, v79
    v_cos_f32 v70, v80
    v_sin_f32 v71, v80
    v_cos_f32 v72, v81
    v_sin_f32 v73, v81
    v_mul_f32 v64, v74, v64
    v_mul_f32 v65, v74, v65
    v_mul_f32 v68, v75, v68
    v_mul_f32 v69, v75, v69
    v_mul_f32 v70, v76, v70
    v_mul_f32 v71, v76, v71
    v_mul_f32 v72, v77, v72
    v_mul_f32 v73, v77, v73
    v_mul_f32 v74, v63, v65
    v_mul_f32 v75, v63, v64
    v_fma_f32 v66, v62, v64, -v74
    v_fma_f32 v67, -v62, v65, -v75
    s_nop 1

    v_mfma_f32_16x16x4_f32 v[40:43], v68, v66, v[40:43]
    v_mfma_f32_16x16x4_f32 v[44:47], v70, v66, v[44:47]
    v_mfma_f32_16x16x4_f32 v[48:51], v72, v66, v[48:51]
    v_mfma_f32_16x16x4_f32 v[40:43], v69, v67, v[40:43]
    v_mfma_f32_16x16x4_f32 v[44:47], v71, v67, v[44:47]
    v_mfma_f32_16x16x4_f32 v[48:51], v73, v67, v[48:51]
    v_lshlrev_b32 v56, 16, v13
    v_lshlrev_b32 v57, 16, v17
    v_lshlrev_b32 v58, 16, v21
    v_lshlrev_b32 v59, 16, v25
    v_lshlrev_b32 v60, 16, v29
    v_lshlrev_b32 v61, 16, v33
    v_mul_f32 v56, v9, v56
    v_mul_f32 v57, v9, v57
    v_mul_f32 v58, v9, v58
    v_mul_f32 v59, v9, v59
    v_mul_f32 v56, 0x3fb8aa3b, v56
    v_mul_f32 v57, 0x3e22f983, v57
    v_mul_f32 v74, v61, v59
    v_mul_f32 v75, v61, v58
    v_fma_f32 v62, v60, v58, -v74
    v_fma_f32 v63, v60, v59, v75

    v_mul_f32 v74, v56, v7
    v_mul_f32 v75, v56, v36
    v_mul_f32 v76, v56, v37
    v_mul_f32 v77, v56, v38
    v_mul_f32 v78, v57, v7
    v_mul_f32 v79, v57, v36
    v_mul_f32 v80, v57, v37
    v_mul_f32 v81, v57, v38
    v_exp_f32 v74, v74
    v_exp_f32 v75, v75
    v_exp_f32 v76, v76
    v_exp_f32 v77, v77
    v_fract_f32 v78, v78
    v_fract_f32 v79, v79
    v_fract_f32 v80, v80
    v_fract_f32 v81, v81
    v_cos_f32 v64, v78
    v_sin_f32 v65, v78
    v_cos_f32 v68, v79
    v_sin_f32 v69, v79
    v_cos_f32 v70, v80
    v_sin_f32 v71, v80
    v_cos_f32 v72, v81
    v_sin_f32 v73, v81
    v_mul_f32 v64, v74, v64
    v_mul_f32 v65, v74, v65
    v_mul_f32 v68, v75, v68
    v_mul_f32 v69, v75, v69
    v_mul_f32 v70, v76, v70
    v_mul_f32 v71, v76, v71
    v_mul_f32 v72, v77, v72
    v_mul_f32 v73, v77, v73
    v_mul_f32 v74, v63, v65
    v_mul_f32 v75, v63, v64
    v_fma_f32 v66, v62, v64, -v74
    v_fma_f32 v67, -v62, v65, -v75
    s_nop 1

    v_mfma_f32_16x16x4_f32 v[40:43], v68, v66, v[40:43]
    v_mfma_f32_16x16x4_f32 v[44:47], v70, v66, v[44:47]
    v_mfma_f32_16x16x4_f32 v[48:51], v72, v66, v[48:51]
    v_mfma_f32_16x16x4_f32 v[40:43], v69, v67, v[40:43]
    v_mfma_f32_16x16x4_f32 v[44:47], v71, v67, v[44:47]
    v_mfma_f32_16x16x4_f32 v[48:51], v73, v67, v[48:51]
    v_and_b32 v56, 0xffff0000, v13
    v_and_b32 v57, 0xffff0000, v17
    v_and_b32 v58, 0xffff0000, v21
    v_and_b32 v59, 0xffff0000, v25
    v_and_b32 v60, 0xffff0000, v29
    v_and_b32 v61, 0xffff0000, v33
    v_mul_f32 v56, v9, v56
    v_mul_f32 v57, v9, v57
    v_mul_f32 v58, v9, v58
    v_mul_f32 v59, v9, v59
    v_mul_f32 v56, 0x3fb8aa3b, v56
    v_mul_f32 v57, 0x3e22f983, v57
    v_mul_f32 v74, v61, v59
    v_mul_f32 v75, v61, v58
    v_fma_f32 v62, v60, v58, -v74
    v_fma_f32 v63, v60, v59, v75

    v_mul_f32 v74, v56, v7
    v_mul_f32 v75, v56, v36
    v_mul_f32 v76, v56, v37
    v_mul_f32 v77, v56, v38
    v_mul_f32 v78, v57, v7
    v_mul_f32 v79, v57, v36
    v_mul_f32 v80, v57, v37
    v_mul_f32 v81, v57, v38
    v_exp_f32 v74, v74
    v_exp_f32 v75, v75
    v_exp_f32 v76, v76
    v_exp_f32 v77, v77
    v_fract_f32 v78, v78
    v_fract_f32 v79, v79
    v_fract_f32 v80, v80
    v_fract_f32 v81, v81
    v_cos_f32 v64, v78
    v_sin_f32 v65, v78
    v_cos_f32 v68, v79
    v_sin_f32 v69, v79
    v_cos_f32 v70, v80
    v_sin_f32 v71, v80
    v_cos_f32 v72, v81
    v_sin_f32 v73, v81
    v_mul_f32 v64, v74, v64
    v_mul_f32 v65, v74, v65
    v_mul_f32 v68, v75, v68
    v_mul_f32 v69, v75, v69
    v_mul_f32 v70, v76, v70
    v_mul_f32 v71, v76, v71
    v_mul_f32 v72, v77, v72
    v_mul_f32 v73, v77, v73
    v_mul_f32 v74, v63, v65
    v_mul_f32 v75, v63, v64
    v_fma_f32 v66, v62, v64, -v74
    v_fma_f32 v67, -v62, v65, -v75
    s_nop 1

    v_mfma_f32_16x16x4_f32 v[40:43], v68, v66, v[40:43]
    v_mfma_f32_16x16x4_f32 v[44:47], v70, v66, v[44:47]
    v_mfma_f32_16x16x4_f32 v[48:51], v72, v66, v[48:51]
    v_mfma_f32_16x16x4_f32 v[40:43], v69, v67, v[40:43]
    v_mfma_f32_16x16x4_f32 v[44:47], v71, v67, v[44:47]
    v_mfma_f32_16x16x4_f32 v[48:51], v73, v67, v[48:51]
    v_lshlrev_b32 v56, 16, v14
    v_lshlrev_b32 v57, 16, v18
    v_lshlrev_b32 v58, 16, v22
    v_lshlrev_b32 v59, 16, v26
    v_lshlrev_b32 v60, 16, v30
    v_lshlrev_b32 v61, 16, v34
    v_mul_f32 v56, v9, v56
    v_mul_f32 v57, v9, v57
    v_mul_f32 v58, v9, v58
    v_mul_f32 v59, v9, v59
    v_mul_f32 v56, 0x3fb8aa3b, v56
    v_mul_f32 v57, 0x3e22f983, v57
    v_mul_f32 v74, v61, v59
    v_mul_f32 v75, v61, v58
    v_fma_f32 v62, v60, v58, -v74
    v_fma_f32 v63, v60, v59, v75

    v_mul_f32 v74, v56, v7
    v_mul_f32 v75, v56, v36
    v_mul_f32 v76, v56, v37
    v_mul_f32 v77, v56, v38
    v_mul_f32 v78, v57, v7
    v_mul_f32 v79, v57, v36
    v_mul_f32 v80, v57, v37
    v_mul_f32 v81, v57, v38
    v_exp_f32 v74, v74
    v_exp_f32 v75, v75
    v_exp_f32 v76, v76
    v_exp_f32 v77, v77
    v_fract_f32 v78, v78
    v_fract_f32 v79, v79
    v_fract_f32 v80, v80
    v_fract_f32 v81, v81
    v_cos_f32 v64, v78
    v_sin_f32 v65, v78
    v_cos_f32 v68, v79
    v_sin_f32 v69, v79
    v_cos_f32 v70, v80
    v_sin_f32 v71, v80
    v_cos_f32 v72, v81
    v_sin_f32 v73, v81
    v_mul_f32 v64, v74, v64
    v_mul_f32 v65, v74, v65
    v_mul_f32 v68, v75, v68
    v_mul_f32 v69, v75, v69
    v_mul_f32 v70, v76, v70
    v_mul_f32 v71, v76, v71
    v_mul_f32 v72, v77, v72
    v_mul_f32 v73, v77, v73
    v_mul_f32 v74, v63, v65
    v_mul_f32 v75, v63, v64
    v_fma_f32 v66, v62, v64, -v74
    v_fma_f32 v67, -v62, v65, -v75
    s_nop 1

    v_mfma_f32_16x16x4_f32 v[40:43], v68, v66, v[40:43]
    v_mfma_f32_16x16x4_f32 v[44:47], v70, v66, v[44:47]
    v_mfma_f32_16x16x4_f32 v[48:51], v72, v66, v[48:51]
    v_mfma_f32_16x16x4_f32 v[40:43], v69, v67, v[40:43]
    v_mfma_f32_16x16x4_f32 v[44:47], v71, v67, v[44:47]
    v_mfma_f32_16x16x4_f32 v[48:51], v73, v67, v[48:51]
    v_and_b32 v56, 0xffff0000, v14
    v_and_b32 v57, 0xffff0000, v18
    v_and_b32 v58, 0xffff0000, v22
    v_and_b32 v59, 0xffff0000, v26
    v_and_b32 v60, 0xffff0000, v30
    v_and_b32 v61, 0xffff0000, v34
    v_mul_f32 v56, v9, v56
    v_mul_f32 v57, v9, v57
    v_mul_f32 v58, v9, v58
    v_mul_f32 v59, v9, v59
    v_mul_f32 v56, 0x3fb8aa3b, v56
    v_mul_f32 v57, 0x3e22f983, v57
    v_mul_f32 v74, v61, v59
    v_mul_f32 v75, v61, v58
    v_fma_f32 v62, v60, v58, -v74
    v_fma_f32 v63, v60, v59, v75

    v_mul_f32 v74, v56, v7
    v_mul_f32 v75, v56, v36
    v_mul_f32 v76, v56, v37
    v_mul_f32 v77, v56, v38
    v_mul_f32 v78, v57, v7
    v_mul_f32 v79, v57, v36
    v_mul_f32 v80, v57, v37
    v_mul_f32 v81, v57, v38
    v_exp_f32 v74, v74
    v_exp_f32 v75, v75
    v_exp_f32 v76, v76
    v_exp_f32 v77, v77
    v_fract_f32 v78, v78
    v_fract_f32 v79, v79
    v_fract_f32 v80, v80
    v_fract_f32 v81, v81
    v_cos_f32 v64, v78
    v_sin_f32 v65, v78
    v_cos_f32 v68, v79
    v_sin_f32 v69, v79
    v_cos_f32 v70, v80
    v_sin_f32 v71, v80
    v_cos_f32 v72, v81
    v_sin_f32 v73, v81
    v_mul_f32 v64, v74, v64
    v_mul_f32 v65, v74, v65
    v_mul_f32 v68, v75, v68
    v_mul_f32 v69, v75, v69
    v_mul_f32 v70, v76, v70
    v_mul_f32 v71, v76, v71
    v_mul_f32 v72, v77, v72
    v_mul_f32 v73, v77, v73
    v_mul_f32 v74, v63, v65
    v_mul_f32 v75, v63, v64
    v_fma_f32 v66, v62, v64, -v74
    v_fma_f32 v67, -v62, v65, -v75
    s_nop 1

    v_mfma_f32_16x16x4_f32 v[40:43], v68, v66, v[40:43]
    v_mfma_f32_16x16x4_f32 v[44:47], v70, v66, v[44:47]
    v_mfma_f32_16x16x4_f32 v[48:51], v72, v66, v[48:51]
    v_mfma_f32_16x16x4_f32 v[40:43], v69, v67, v[40:43]
    v_mfma_f32_16x16x4_f32 v[44:47], v71, v67, v[44:47]
    v_mfma_f32_16x16x4_f32 v[48:51], v73, v67, v[48:51]
    v_lshlrev_b32 v56, 16, v15
    v_lshlrev_b32 v57, 16, v19
    v_lshlrev_b32 v58, 16, v23
    v_lshlrev_b32 v59, 16, v27
    v_lshlrev_b32 v60, 16, v31
    v_lshlrev_b32 v61, 16, v35
    v_mul_f32 v56, v9, v56
    v_mul_f32 v57, v9, v57
    v_mul_f32 v58, v9, v58
    v_mul_f32 v59, v9, v59
    v_mul_f32 v56, 0x3fb8aa3b, v56
    v_mul_f32 v57, 0x3e22f983, v57
    v_mul_f32 v74, v61, v59
    v_mul_f32 v75, v61, v58
    v_fma_f32 v62, v60, v58, -v74
    v_fma_f32 v63, v60, v59, v75

    v_mul_f32 v74, v56, v7
    v_mul_f32 v75, v56, v36
    v_mul_f32 v76, v56, v37
    v_mul_f32 v77, v56, v38
    v_mul_f32 v78, v57, v7
    v_mul_f32 v79, v57, v36
    v_mul_f32 v80, v57, v37
    v_mul_f32 v81, v57, v38
    v_exp_f32 v74, v74
    v_exp_f32 v75, v75
    v_exp_f32 v76, v76
    v_exp_f32 v77, v77
    v_fract_f32 v78, v78
    v_fract_f32 v79, v79
    v_fract_f32 v80, v80
    v_fract_f32 v81, v81
    v_cos_f32 v64, v78
    v_sin_f32 v65, v78
    v_cos_f32 v68, v79
    v_sin_f32 v69, v79
    v_cos_f32 v70, v80
    v_sin_f32 v71, v80
    v_cos_f32 v72, v81
    v_sin_f32 v73, v81
    v_mul_f32 v64, v74, v64
    v_mul_f32 v65, v74, v65
    v_mul_f32 v68, v75, v68
    v_mul_f32 v69, v75, v69
    v_mul_f32 v70, v76, v70
    v_mul_f32 v71, v76, v71
    v_mul_f32 v72, v77, v72
    v_mul_f32 v73, v77, v73
    v_mul_f32 v74, v63, v65
    v_mul_f32 v75, v63, v64
    v_fma_f32 v66, v62, v64, -v74
    v_fma_f32 v67, -v62, v65, -v75
    s_nop 1

    v_mfma_f32_16x16x4_f32 v[40:43], v68, v66, v[40:43]
    v_mfma_f32_16x16x4_f32 v[44:47], v70, v66, v[44:47]
    v_mfma_f32_16x16x4_f32 v[48:51], v72, v66, v[48:51]
    v_mfma_f32_16x16x4_f32 v[40:43], v69, v67, v[40:43]
    v_mfma_f32_16x16x4_f32 v[44:47], v71, v67, v[44:47]
    v_mfma_f32_16x16x4_f32 v[48:51], v73, v67, v[48:51]
    v_and_b32 v56, 0xffff0000, v15
    v_and_b32 v57, 0xffff0000, v19
    v_and_b32 v58, 0xffff0000, v23
    v_and_b32 v59, 0xffff0000, v27
    v_and_b32 v60, 0xffff0000, v31
    v_and_b32 v61, 0xffff0000, v35
    v_mul_f32 v56, v9, v56
    v_mul_f32 v57, v9, v57
    v_mul_f32 v58, v9, v58
    v_mul_f32 v59, v9, v59
    v_mul_f32 v56, 0x3fb8aa3b, v56
    v_mul_f32 v57, 0x3e22f983, v57
    v_mul_f32 v74, v61, v59
    v_mul_f32 v75, v61, v58
    v_fma_f32 v62, v60, v58, -v74
    v_fma_f32 v63, v60, v59, v75

    v_mul_f32 v74, v56, v7
    v_mul_f32 v75, v56, v36
    v_mul_f32 v76, v56, v37
    v_mul_f32 v77, v56, v38
    v_mul_f32 v78, v57, v7
    v_mul_f32 v79, v57, v36
    v_mul_f32 v80, v57, v37
    v_mul_f32 v81, v57, v38
    v_exp_f32 v74, v74
    v_exp_f32 v75, v75
    v_exp_f32 v76, v76
    v_exp_f32 v77, v77
    v_fract_f32 v78, v78
    v_fract_f32 v79, v79
    v_fract_f32 v80, v80
    v_fract_f32 v81, v81
    v_cos_f32 v64, v78
    v_sin_f32 v65, v78
    v_cos_f32 v68, v79
    v_sin_f32 v69, v79
    v_cos_f32 v70, v80
    v_sin_f32 v71, v80
    v_cos_f32 v72, v81
    v_sin_f32 v73, v81
    v_mul_f32 v64, v74, v64
    v_mul_f32 v65, v74, v65
    v_mul_f32 v68, v75, v68
    v_mul_f32 v69, v75, v69
    v_mul_f32 v70, v76, v70
    v_mul_f32 v71, v76, v71
    v_mul_f32 v72, v77, v72
    v_mul_f32 v73, v77, v73
    v_mul_f32 v74, v63, v65
    v_mul_f32 v75, v63, v64
    v_fma_f32 v66, v62, v64, -v74
    v_fma_f32 v67, -v62, v65, -v75
    s_nop 1

    v_mfma_f32_16x16x4_f32 v[40:43], v68, v66, v[40:43]
    v_mfma_f32_16x16x4_f32 v[44:47], v70, v66, v[44:47]
    v_mfma_f32_16x16x4_f32 v[48:51], v72, v66, v[48:51]
    v_mfma_f32_16x16x4_f32 v[40:43], v69, v67, v[40:43]
    v_mfma_f32_16x16x4_f32 v[44:47], v71, v67, v[44:47]
    v_mfma_f32_16x16x4_f32 v[48:51], v73, v67, v[48:51]
    v_mul_u32_u24 v10, 3072, v2
    v_lshl_add_u32 v10, v1, 4, v10
    v_lshlrev_b32 v11, 10, v2
    v_lshl_add_u32 v11, v1, 4, v11

    s_nop 7
    ds_write_b128 v10, v[40:43] offset:8704
    ds_write_b128 v10, v[44:47] offset:9728
    ds_write_b128 v10, v[48:51] offset:10752
    s_lshl_b32 s20, s3, 5
    s_waitcnt lgkmcnt(0)
    s_barrier
    s_cmp_eq_u32 s22, 3
    s_cbranch_scc1 KF_nored

    ds_read_b128 v[12:15], v11 offset:8704
    ds_read_b128 v[16:19], v11 offset:11776
    ds_read_b128 v[20:23], v11 offset:14848
    ds_read_b128 v[24:27], v11 offset:17920
    s_waitcnt lgkmcnt(0)
    v_add_f32 v12, v12, v16
    v_add_f32 v20, v20, v24
    v_add_f32 v13, v13, v17
    v_add_f32 v21, v21, v25
    v_add_f32 v14, v14, v18
    v_add_f32 v22, v22, v26
    v_add_f32 v15, v15, v19
    v_add_f32 v23, v23, v27
    v_add_f32 v12, v12, v20
    v_add_f32 v13, v13, v21
    v_add_f32 v14, v14, v22
    v_add_f32 v15, v15, v23
    ds_write_b128 v11, v[12:15] offset:4608
    s_branch KF_nopoll
KF_nored:
    v_mov_b32 v12, 128
    s_mov_b32 s21, 0
KF_poll:
    buffer_load_dword v13, v12, s[12:15], 0 offen sc1
    s_waitcnt vmcnt(0)
    v_readfirstlane_b32 s23, v13
    s_cmp_lg_u32 s23, 0
    s_cbranch_scc1 KF_nopoll
    s_sleep 8
    s_add_u32 s21, s21, 1
    s_cmp_lt_u32 s21, 0x100000
    s_cbranch_scc1 KF_poll

KF_nopoll:
    s_waitcnt lgkmcnt(0)
    s_barrier
    buffer_load_dwordx4 v[84:87], v159, s[4:7], s20 offen sc1
    ds_read_b32 v24, v90 offset:4608
    ds_read_b32 v25, v91 offset:4608
    ds_read_b32 v26, v92 offset:4608
    ds_read_b32 v27, v93 offset:4608
    ds_read_b32 v28, v94 offset:4608
    ds_read_b32 v29, v95 offset:4608
    ds_read_b32 v30, v96 offset:4608
    ds_read_b32 v31, v97 offset:4608
    ds_read_b32 v32, v98 offset:4608
    v_mov_b32 v12, 0
    v_mov_b32 v13, 0
    v_mov_b32 v14, 0
    v_mov_b32 v15, 0
    v_cmp_gt_u32 vcc, 32, v0
    s_and_saveexec_b64 s[16:17], vcc
    ds_write_b128 v158, v[12:15] offset:0
    s_mov_b64 exec, s[16:17]
    v_lshlrev_b32 v35, 2, v0
    v_cmp_gt_u32 vcc, 16, v0
    s_and_saveexec_b64 s[16:17], vcc
    ds_write_b32 v35, v12 offset:16896
    ds_write_b32 v35, v12 offset:25156
    s_mov_b64 exec, s[16:17]
    v_cmp_eq_u32 vcc, 0xff, v0
    v_lshlrev_b32 v35, 5, v0
    s_waitcnt lgkmcnt(0)
    v_cndmask_b32 v32, v32, 0, vcc

    v_cvt_pk_bf16_f32 v33, v24, v25
    v_lshlrev_b32 v44, 16, v33
    v_and_b32 v45, 0xffff0000, v33
    v_cvt_pk_bf16_f32 v33, v26, v27
    v_lshlrev_b32 v46, 16, v33
    v_and_b32 v47, 0xffff0000, v33
    v_cvt_pk_bf16_f32 v33, v28, v29
    v_lshlrev_b32 v48, 16, v33
    v_and_b32 v49, 0xffff0000, v33
    v_cvt_pk_bf16_f32 v33, v30, v31
    v_lshlrev_b32 v50, 16, v33
    v_and_b32 v51, 0xffff0000, v33
    v_cvt_pk_bf16_f32 v33, v32, v32
    v_lshlrev_b32 v52, 16, v33
    v_sub_f32 v24, v24, v44
    v_sub_f32 v25, v25, v45
    v_sub_f32 v26, v26, v46
    v_sub_f32 v27, v27, v47
    v_sub_f32 v28, v28, v48
    v_sub_f32 v29, v29, v49
    v_sub_f32 v30, v30, v50
    v_sub_f32 v31, v31, v51
    v_sub_f32 v32, v32, v52
    v_cvt_pk_bf16_f32 v56, v44, v45
    v_cvt_pk_bf16_f32 v57, v24, v25
    v_cvt_pk_bf16_f32 v65, v45, v46
    v_cvt_pk_bf16_f32 v66, v25, v26
    v_cvt_pk_bf16_f32 v58, v46, v47
    v_cvt_pk_bf16_f32 v59, v26, v27
    v_cvt_pk_bf16_f32 v67, v47, v48
    v_cvt_pk_bf16_f32 v68, v27, v28
    v_cvt_pk_bf16_f32 v60, v48, v49
    v_cvt_pk_bf16_f32 v61, v28, v29
    v_cvt_pk_bf16_f32 v69, v49, v50
    v_cvt_pk_bf16_f32 v70, v29, v30
    v_cvt_pk_bf16_f32 v62, v50, v51
    v_cvt_pk_bf16_f32 v63, v30, v31
    v_cvt_pk_bf16_f32 v71, v51, v52
    v_cvt_pk_bf16_f32 v72, v31, v32
    ds_write_b128 v35, v[56:59] offset:8704
    ds_write_b128 v35, v[60:63] offset:8720
    ds_write_b32 v35, v65 offset:16964
    ds_write_b64 v35, v[66:67] offset:16968
    ds_write_b128 v35, v[68:71] offset:16976
    ds_write_b32 v35, v72 offset:16992
    s_waitcnt vmcnt(0)
    ds_write_b128 v158, v[84:87] offset:512
    s_waitcnt lgkmcnt(0)

    v_mov_b32 v44, 0
    v_mov_b32 v45, 0
    v_mov_b32 v46, 0
    v_mov_b32 v47, 0
    v_mov_b32 v48, 0
    v_mov_b32 v49, 0
    v_mov_b32 v50, 0
    v_mov_b32 v51, 0
    v_mov_b32 v52, 0
    v_mov_b32 v53, 0
    v_mov_b32 v54, 0
    v_mov_b32 v55, 0
    v_mov_b32 v56, 0
    v_mov_b32 v57, 0
    v_mov_b32 v58, 0
    v_mov_b32 v59, 0
    v_mov_b32 v60, 0
    v_mov_b32 v61, 0
    v_mov_b32 v62, 0
    v_mov_b32 v63, 0
    v_mov_b32 v64, 0
    v_mov_b32 v65, 0
    v_mov_b32 v66, 0
    v_mov_b32 v67, 0
    v_mov_b32 v68, 0
    v_mov_b32 v69, 0
    v_mov_b32 v70, 0
    v_mov_b32 v71, 0
    v_mov_b32 v72, 0
    v_mov_b32 v73, 0
    v_mov_b32 v74, 0
    v_mov_b32 v75, 0
    s_barrier
    ds_read_b128 v[84:87], v156 offset:64
    ds_read2_b32 v[76:77], v148 offset0:32 offset1:34
    ds_read2_b32 v[78:79], v148 offset0:36 offset1:38
    ds_read2_b32 v[80:81], v148 offset0:33 offset1:35
    ds_read2_b32 v[82:83], v148 offset0:37 offset1:39
    ds_read_b128 v[96:99], v156 offset:576
    ds_read2_b32 v[88:89], v149 offset0:32 offset1:34
    ds_read2_b32 v[90:91], v149 offset0:36 offset1:38
    ds_read2_b32 v[92:93], v149 offset0:33 offset1:35
    ds_read2_b32 v[94:95], v149 offset0:37 offset1:39
    ds_read_b128 v[108:111], v156 offset:1088
    ds_read2_b32 v[100:101], v150 offset0:32 offset1:34
    ds_read2_b32 v[102:103], v150 offset0:36 offset1:38
    ds_read2_b32 v[104:105], v150 offset0:33 offset1:35
    ds_read2_b32 v[106:107], v150 offset0:37 offset1:39
    s_waitcnt lgkmcnt(10)
    ds_read_b128 v[120:123], v156 offset:1600
    ds_read2_b32 v[112:113], v151 offset0:32 offset1:34
    ds_read2_b32 v[114:115], v151 offset0:36 offset1:38
    ds_read2_b32 v[116:117], v151 offset0:33 offset1:35
    ds_read2_b32 v[118:119], v151 offset0:37 offset1:39
    v_mfma_f32_16x16x32_bf16 v[44:47], v[76:79], v[84:87], v[44:47]
    v_mfma_f32_16x16x32_bf16 v[44:47], v[80:83], v[84:87], v[44:47]
    s_waitcnt lgkmcnt(10)
    ds_read_b128 v[132:135], v156 offset:2112
    ds_read2_b32 v[124:125], v152 offset0:32 offset1:34
    ds_read2_b32 v[126:127], v152 offset0:36 offset1:38
    ds_read2_b32 v[128:129], v152 offset0:33 offset1:35
    ds_read2_b32 v[130:131], v152 offset0:37 offset1:39
    v_mfma_f32_16x16x32_bf16 v[48:51], v[76:79], v[96:99], v[48:51]
    v_mfma_f32_16x16x32_bf16 v[48:51], v[88:91], v[84:87], v[48:51]
    v_mfma_f32_16x16x32_bf16 v[52:55], v[88:91], v[96:99], v[52:55]
    v_mfma_f32_16x16x32_bf16 v[48:51], v[80:83], v[96:99], v[48:51]
    v_mfma_f32_16x16x32_bf16 v[48:51], v[92:95], v[84:87], v[48:51]
    v_mfma_f32_16x16x32_bf16 v[52:55], v[92:95], v[96:99], v[52:55]
    s_waitcnt lgkmcnt(10)
    ds_read_b128 v[144:147], v156 offset:2624
    ds_read2_b32 v[136:137], v153 offset0:32 offset1:34
    ds_read2_b32 v[138:139], v153 offset0:36 offset1:38
    ds_read2_b32 v[140:141], v153 offset0:33 offset1:35
    ds_read2_b32 v[142:143], v153 offset0:37 offset1:39
    v_mfma_f32_16x16x32_bf16 v[52:55], v[76:79], v[108:111], v[52:55]
    v_mfma_f32_16x16x32_bf16 v[56:59], v[88:91], v[108:111], v[56:59]
    v_mfma_f32_16x16x32_bf16 v[52:55], v[100:103], v[84:87], v[52:55]
    v_mfma_f32_16x16x32_bf16 v[56:59], v[100:103], v[96:99], v[56:59]
    v_mfma_f32_16x16x32_bf16 v[60:63], v[100:103], v[108:111], v[60:63]
    v_mfma_f32_16x16x32_bf16 v[52:55], v[80:83], v[108:111], v[52:55]
    v_mfma_f32_16x16x32_bf16 v[56:59], v[92:95], v[108:111], v[56:59]
    v_mfma_f32_16x16x32_bf16 v[52:55], v[104:107], v[84:87], v[52:55]
    v_mfma_f32_16x16x32_bf16 v[56:59], v[104:107], v[96:99], v[56:59]
    v_mfma_f32_16x16x32_bf16 v[60:63], v[104:107], v[108:111], v[60:63]
    s_waitcnt lgkmcnt(10)
    v_mfma_f32_16x16x32_bf16 v[56:59], v[76:79], v[120:123], v[56:59]
    v_mfma_f32_16x16x32_bf16 v[60:63], v[88:91], v[120:123], v[60:63]
    v_mfma_f32_16x16x32_bf16 v[64:67], v[100:103], v[120:123], v[64:67]
    v_mfma_f32_16x16x32_bf16 v[56:59], v[112:115], v[84:87], v[56:59]
    v_mfma_f32_16x16x32_bf16 v[60:63], v[112:115], v[96:99], v[60:63]
    v_mfma_f32_16x16x32_bf16 v[64:67], v[112:115], v[108:111], v[64:67]
    v_mfma_f32_16x16x32_bf16 v[68:71], v[112:115], v[120:123], v[68:71]
    v_mfma_f32_16x16x32_bf16 v[56:59], v[80:83], v[120:123], v[56:59]
    v_mfma_f32_16x16x32_bf16 v[60:63], v[92:95], v[120:123], v[60:63]
    v_mfma_f32_16x16x32_bf16 v[64:67], v[104:107], v[120:123], v[64:67]
    v_mfma_f32_16x16x32_bf16 v[56:59], v[116:119], v[84:87], v[56:59]
    v_mfma_f32_16x16x32_bf16 v[60:63], v[116:119], v[96:99], v[60:63]
    v_mfma_f32_16x16x32_bf16 v[64:67], v[116:119], v[108:111], v[64:67]
    v_mfma_f32_16x16x32_bf16 v[68:71], v[116:119], v[120:123], v[68:71]
    s_waitcnt lgkmcnt(5)
    v_mfma_f32_16x16x32_bf16 v[60:63], v[76:79], v[132:135], v[60:63]
    v_mfma_f32_16x16x32_bf16 v[64:67], v[88:91], v[132:135], v[64:67]
    v_mfma_f32_16x16x32_bf16 v[68:71], v[100:103], v[132:135], v[68:71]
    v_mfma_f32_16x16x32_bf16 v[72:75], v[112:115], v[132:135], v[72:75]
    v_mfma_f32_16x16x32_bf16 v[60:63], v[124:127], v[84:87], v[60:63]
    v_mfma_f32_16x16x32_bf16 v[64:67], v[124:127], v[96:99], v[64:67]
    v_mfma_f32_16x16x32_bf16 v[68:71], v[124:127], v[108:111], v[68:71]
    v_mfma_f32_16x16x32_bf16 v[72:75], v[124:127], v[120:123], v[72:75]
    v_mfma_f32_16x16x32_bf16 v[60:63], v[80:83], v[132:135], v[60:63]
    v_mfma_f32_16x16x32_bf16 v[64:67], v[92:95], v[132:135], v[64:67]
    v_mfma_f32_16x16x32_bf16 v[68:71], v[104:107], v[132:135], v[68:71]
    v_mfma_f32_16x16x32_bf16 v[72:75], v[116:119], v[132:135], v[72:75]
    v_mfma_f32_16x16x32_bf16 v[60:63], v[128:131], v[84:87], v[60:63]
    v_mfma_f32_16x16x32_bf16 v[64:67], v[128:131], v[96:99], v[64:67]
    v_mfma_f32_16x16x32_bf16 v[68:71], v[128:131], v[108:111], v[68:71]
    v_mfma_f32_16x16x32_bf16 v[72:75], v[128:131], v[120:123], v[72:75]
    ds_read_b128 v[132:135], v156 offset:3136
    ds_read2_b32 v[124:125], v154 offset0:32 offset1:34
    ds_read2_b32 v[126:127], v154 offset0:36 offset1:38
    ds_read2_b32 v[128:129], v154 offset0:33 offset1:35
    ds_read2_b32 v[130:131], v154 offset0:37 offset1:39
    s_waitcnt lgkmcnt(5)
    v_mfma_f32_16x16x32_bf16 v[64:67], v[76:79], v[144:147], v[64:67]
    v_mfma_f32_16x16x32_bf16 v[68:71], v[88:91], v[144:147], v[68:71]
    v_mfma_f32_16x16x32_bf16 v[72:75], v[100:103], v[144:147], v[72:75]
    v_mfma_f32_16x16x32_bf16 v[64:67], v[136:139], v[84:87], v[64:67]
    v_mfma_f32_16x16x32_bf16 v[68:71], v[136:139], v[96:99], v[68:71]
    v_mfma_f32_16x16x32_bf16 v[72:75], v[136:139], v[108:111], v[72:75]
    v_mfma_f32_16x16x32_bf16 v[64:67], v[80:83], v[144:147], v[64:67]
    v_mfma_f32_16x16x32_bf16 v[68:71], v[92:95], v[144:147], v[68:71]
    v_mfma_f32_16x16x32_bf16 v[72:75], v[104:107], v[144:147], v[72:75]
    v_mfma_f32_16x16x32_bf16 v[64:67], v[140:143], v[84:87], v[64:67]
    v_mfma_f32_16x16x32_bf16 v[68:71], v[140:143], v[96:99], v[68:71]
    v_mfma_f32_16x16x32_bf16 v[72:75], v[140:143], v[108:111], v[72:75]
    ds_read_b128 v[144:147], v156 offset:3648
    ds_read2_b32 v[136:137], v155 offset0:32 offset1:34
    ds_read2_b32 v[138:139], v155 offset0:36 offset1:38
    ds_read2_b32 v[140:141], v155 offset0:33 offset1:35
    ds_read2_b32 v[142:143], v155 offset0:37 offset1:39
    s_waitcnt lgkmcnt(5)
    v_mfma_f32_16x16x32_bf16 v[68:71], v[76:79], v[132:135], v[68:71]
    v_mfma_f32_16x16x32_bf16 v[72:75], v[88:91], v[132:135], v[72:75]
    v_mfma_f32_16x16x32_bf16 v[68:71], v[124:127], v[84:87], v[68:71]
    v_mfma_f32_16x16x32_bf16 v[72:75], v[124:127], v[96:99], v[72:75]
    v_mfma_f32_16x16x32_bf16 v[68:71], v[80:83], v[132:135], v[68:71]
    v_mfma_f32_16x16x32_bf16 v[72:75], v[92:95], v[132:135], v[72:75]
    v_mfma_f32_16x16x32_bf16 v[68:71], v[128:131], v[84:87], v[68:71]
    v_mfma_f32_16x16x32_bf16 v[72:75], v[128:131], v[96:99], v[72:75]
    s_waitcnt lgkmcnt(0)
    v_mfma_f32_16x16x32_bf16 v[72:75], v[76:79], v[144:147], v[72:75]
    v_mfma_f32_16x16x32_bf16 v[72:75], v[136:139], v[84:87], v[72:75]
    v_mfma_f32_16x16x32_bf16 v[72:75], v[80:83], v[144:147], v[72:75]
    v_mfma_f32_16x16x32_bf16 v[72:75], v[140:143], v[84:87], v[72:75]
    ds_read_b128 v[84:87], v156 offset:0
    ds_read2_b32 v[76:77], v148 offset0:0 offset1:2
    ds_read2_b32 v[78:79], v148 offset0:4 offset1:6
    ds_read2_b32 v[80:81], v148 offset0:1 offset1:3
    ds_read2_b32 v[82:83], v148 offset0:5 offset1:7
    ds_read_b128 v[96:99], v156 offset:512
    ds_read2_b32 v[88:89], v149 offset0:0 offset1:2
    ds_read2_b32 v[90:91], v149 offset0:4 offset1:6
    ds_read2_b32 v[92:93], v149 offset0:1 offset1:3
    ds_read2_b32 v[94:95], v149 offset0:5 offset1:7
    ds_read_b128 v[108:111], v156 offset:1024
    ds_read2_b32 v[100:101], v150 offset0:0 offset1:2
    ds_read2_b32 v[102:103], v150 offset0:4 offset1:6
    ds_read2_b32 v[104:105], v150 offset0:1 offset1:3
    ds_read2_b32 v[106:107], v150 offset0:5 offset1:7
    s_waitcnt lgkmcnt(10)
    ds_read_b128 v[120:123], v156 offset:1536
    ds_read2_b32 v[112:113], v151 offset0:0 offset1:2
    ds_read2_b32 v[114:115], v151 offset0:4 offset1:6
    ds_read2_b32 v[116:117], v151 offset0:1 offset1:3
    ds_read2_b32 v[118:119], v151 offset0:5 offset1:7
    v_mfma_f32_16x16x32_bf16 v[44:47], v[76:79], v[84:87], v[44:47]
    v_mfma_f32_16x16x32_bf16 v[44:47], v[80:83], v[84:87], v[44:47]
    s_waitcnt lgkmcnt(10)
    ds_read_b128 v[132:135], v156 offset:2048
    ds_read2_b32 v[124:125], v152 offset0:0 offset1:2
    ds_read2_b32 v[126:127], v152 offset0:4 offset1:6
    ds_read2_b32 v[128:129], v152 offset0:1 offset1:3
    ds_read2_b32 v[130:131], v152 offset0:5 offset1:7
    v_mfma_f32_16x16x32_bf16 v[48:51], v[76:79], v[96:99], v[48:51]
    v_mfma_f32_16x16x32_bf16 v[48:51], v[88:91], v[84:87], v[48:51]
    v_mfma_f32_16x16x32_bf16 v[52:55], v[88:91], v[96:99], v[52:55]
    v_mfma_f32_16x16x32_bf16 v[48:51], v[80:83], v[96:99], v[48:51]
    v_mfma_f32_16x16x32_bf16 v[48:51], v[92:95], v[84:87], v[48:51]
    v_mfma_f32_16x16x32_bf16 v[52:55], v[92:95], v[96:99], v[52:55]
    s_waitcnt lgkmcnt(10)
    ds_read_b128 v[144:147], v156 offset:2560
    ds_read2_b32 v[136:137], v153 offset0:0 offset1:2
    ds_read2_b32 v[138:139], v153 offset0:4 offset1:6
    ds_read2_b32 v[140:141], v153 offset0:1 offset1:3
    ds_read2_b32 v[142:143], v153 offset0:5 offset1:7
    v_mfma_f32_16x16x32_bf16 v[52:55], v[76:79], v[108:111], v[52:55]
    v_mfma_f32_16x16x32_bf16 v[56:59], v[88:91], v[108:111], v[56:59]
    v_mfma_f32_16x16x32_bf16 v[52:55], v[100:103], v[84:87], v[52:55]
    v_mfma_f32_16x16x32_bf16 v[56:59], v[100:103], v[96:99], v[56:59]
    v_mfma_f32_16x16x32_bf16 v[60:63], v[100:103], v[108:111], v[60:63]
    v_mfma_f32_16x16x32_bf16 v[52:55], v[80:83], v[108:111], v[52:55]
    v_mfma_f32_16x16x32_bf16 v[56:59], v[92:95], v[108:111], v[56:59]
    v_mfma_f32_16x16x32_bf16 v[52:55], v[104:107], v[84:87], v[52:55]
    v_mfma_f32_16x16x32_bf16 v[56:59], v[104:107], v[96:99], v[56:59]
    v_mfma_f32_16x16x32_bf16 v[60:63], v[104:107], v[108:111], v[60:63]
    s_waitcnt lgkmcnt(10)
    v_mfma_f32_16x16x32_bf16 v[56:59], v[76:79], v[120:123], v[56:59]
    v_mfma_f32_16x16x32_bf16 v[60:63], v[88:91], v[120:123], v[60:63]
    v_mfma_f32_16x16x32_bf16 v[64:67], v[100:103], v[120:123], v[64:67]
    v_mfma_f32_16x16x32_bf16 v[56:59], v[112:115], v[84:87], v[56:59]
    v_mfma_f32_16x16x32_bf16 v[60:63], v[112:115], v[96:99], v[60:63]
    v_mfma_f32_16x16x32_bf16 v[64:67], v[112:115], v[108:111], v[64:67]
    v_mfma_f32_16x16x32_bf16 v[68:71], v[112:115], v[120:123], v[68:71]
    v_mfma_f32_16x16x32_bf16 v[56:59], v[80:83], v[120:123], v[56:59]
    v_mfma_f32_16x16x32_bf16 v[60:63], v[92:95], v[120:123], v[60:63]
    v_mfma_f32_16x16x32_bf16 v[64:67], v[104:107], v[120:123], v[64:67]
    v_mfma_f32_16x16x32_bf16 v[56:59], v[116:119], v[84:87], v[56:59]
    v_mfma_f32_16x16x32_bf16 v[60:63], v[116:119], v[96:99], v[60:63]
    v_mfma_f32_16x16x32_bf16 v[64:67], v[116:119], v[108:111], v[64:67]
    v_mfma_f32_16x16x32_bf16 v[68:71], v[116:119], v[120:123], v[68:71]
    s_waitcnt lgkmcnt(5)
    v_mfma_f32_16x16x32_bf16 v[60:63], v[76:79], v[132:135], v[60:63]
    v_mfma_f32_16x16x32_bf16 v[64:67], v[88:91], v[132:135], v[64:67]
    v_mfma_f32_16x16x32_bf16 v[68:71], v[100:103], v[132:135], v[68:71]
    v_mfma_f32_16x16x32_bf16 v[72:75], v[112:115], v[132:135], v[72:75]
    v_mfma_f32_16x16x32_bf16 v[60:63], v[124:127], v[84:87], v[60:63]
    v_mfma_f32_16x16x32_bf16 v[64:67], v[124:127], v[96:99], v[64:67]
    v_mfma_f32_16x16x32_bf16 v[68:71], v[124:127], v[108:111], v[68:71]
    v_mfma_f32_16x16x32_bf16 v[72:75], v[124:127], v[120:123], v[72:75]
    v_mfma_f32_16x16x32_bf16 v[60:63], v[80:83], v[132:135], v[60:63]
    v_mfma_f32_16x16x32_bf16 v[64:67], v[92:95], v[132:135], v[64:67]
    v_mfma_f32_16x16x32_bf16 v[68:71], v[104:107], v[132:135], v[68:71]
    v_mfma_f32_16x16x32_bf16 v[72:75], v[116:119], v[132:135], v[72:75]
    v_mfma_f32_16x16x32_bf16 v[60:63], v[128:131], v[84:87], v[60:63]
    v_mfma_f32_16x16x32_bf16 v[64:67], v[128:131], v[96:99], v[64:67]
    v_mfma_f32_16x16x32_bf16 v[68:71], v[128:131], v[108:111], v[68:71]
    v_mfma_f32_16x16x32_bf16 v[72:75], v[128:131], v[120:123], v[72:75]
    ds_read_b128 v[132:135], v156 offset:3072
    ds_read2_b32 v[124:125], v154 offset0:0 offset1:2
    ds_read2_b32 v[126:127], v154 offset0:4 offset1:6
    ds_read2_b32 v[128:129], v154 offset0:1 offset1:3
    ds_read2_b32 v[130:131], v154 offset0:5 offset1:7
    s_waitcnt lgkmcnt(5)
    v_mfma_f32_16x16x32_bf16 v[64:67], v[76:79], v[144:147], v[64:67]
    v_mfma_f32_16x16x32_bf16 v[68:71], v[88:91], v[144:147], v[68:71]
    v_mfma_f32_16x16x32_bf16 v[72:75], v[100:103], v[144:147], v[72:75]
    v_mfma_f32_16x16x32_bf16 v[64:67], v[136:139], v[84:87], v[64:67]
    v_mfma_f32_16x16x32_bf16 v[68:71], v[136:139], v[96:99], v[68:71]
    v_mfma_f32_16x16x32_bf16 v[72:75], v[136:139], v[108:111], v[72:75]
    v_mfma_f32_16x16x32_bf16 v[64:67], v[80:83], v[144:147], v[64:67]
    v_mfma_f32_16x16x32_bf16 v[68:71], v[92:95], v[144:147], v[68:71]
    v_mfma_f32_16x16x32_bf16 v[72:75], v[104:107], v[144:147], v[72:75]
    v_mfma_f32_16x16x32_bf16 v[64:67], v[140:143], v[84:87], v[64:67]
    v_mfma_f32_16x16x32_bf16 v[68:71], v[140:143], v[96:99], v[68:71]
    v_mfma_f32_16x16x32_bf16 v[72:75], v[140:143], v[108:111], v[72:75]
    ds_read_b128 v[144:147], v156 offset:3584
    ds_read2_b32 v[136:137], v155 offset0:0 offset1:2
    ds_read2_b32 v[138:139], v155 offset0:4 offset1:6
    ds_read2_b32 v[140:141], v155 offset0:1 offset1:3
    ds_read2_b32 v[142:143], v155 offset0:5 offset1:7
    s_waitcnt lgkmcnt(5)
    v_mfma_f32_16x16x32_bf16 v[68:71], v[76:79], v[132:135], v[68:71]
    v_mfma_f32_16x16x32_bf16 v[72:75], v[88:91], v[132:135], v[72:75]
    v_mfma_f32_16x16x32_bf16 v[68:71], v[124:127], v[84:87], v[68:71]
    v_mfma_f32_16x16x32_bf16 v[72:75], v[124:127], v[96:99], v[72:75]
    v_mfma_f32_16x16x32_bf16 v[68:71], v[80:83], v[132:135], v[68:71]
    v_mfma_f32_16x16x32_bf16 v[72:75], v[92:95], v[132:135], v[72:75]
    v_mfma_f32_16x16x32_bf16 v[68:71], v[128:131], v[84:87], v[68:71]
    v_mfma_f32_16x16x32_bf16 v[72:75], v[128:131], v[96:99], v[72:75]
    s_waitcnt lgkmcnt(0)
    v_mfma_f32_16x16x32_bf16 v[72:75], v[76:79], v[144:147], v[72:75]
    v_mfma_f32_16x16x32_bf16 v[72:75], v[136:139], v[84:87], v[72:75]
    v_mfma_f32_16x16x32_bf16 v[72:75], v[80:83], v[144:147], v[72:75]
    v_mfma_f32_16x16x32_bf16 v[72:75], v[140:143], v[84:87], v[72:75]
    v_lshlrev_b32 v8, 13, v2
    v_lshl_add_u32 v8, v1, 4, v8
    v_lshlrev_b32 v9, 11, v2
    v_lshl_add_u32 v9, v1, 4, v9
    s_nop 7
    s_barrier

    ds_write_b128 v8, v[44:47] offset:0
    ds_write_b128 v8, v[48:51] offset:1024
    ds_write_b128 v8, v[52:55] offset:2048
    ds_write_b128 v8, v[56:59] offset:3072
    ds_write_b128 v8, v[60:63] offset:4096
    ds_write_b128 v8, v[64:67] offset:5120
    ds_write_b128 v8, v[68:71] offset:6144
    ds_write_b128 v8, v[72:75] offset:7168
    s_waitcnt lgkmcnt(0)
    s_barrier
    ds_read_b128 v[76:79], v9 offset:0
    ds_read_b128 v[80:83], v9 offset:8192
    ds_read_b128 v[84:87], v9 offset:16384
    ds_read_b128 v[88:91], v9 offset:24576
    ds_read_b128 v[92:95], v9 offset:1024
    ds_read_b128 v[96:99], v9 offset:9216
    ds_read_b128 v[100:103], v9 offset:17408
    ds_read_b128 v[104:107], v9 offset:25600
    s_lshl_b32 s20, s3, 4
    s_add_u32 s21, s20, 294912
    s_waitcnt lgkmcnt(0)

    v_add_f32 v76, v76, v80
    v_add_f32 v84, v84, v88
    v_add_f32 v77, v77, v81
    v_add_f32 v85, v85, v89
    v_add_f32 v78, v78, v82
    v_add_f32 v86, v86, v90
    v_add_f32 v79, v79, v83
    v_add_f32 v87, v87, v91
    v_add_f32 v76, v76, v84
    v_add_f32 v77, v77, v85
    v_add_f32 v78, v78, v86
    v_add_f32 v79, v79, v87
    v_cvt_pk_bf16_f32 v12, v76, v77
    v_cvt_pk_bf16_f32 v13, v78, v79
    v_add_f32 v92, v92, v96
    v_add_f32 v100, v100, v104
    v_add_f32 v93, v93, v97
    v_add_f32 v101, v101, v105
    v_add_f32 v94, v94, v98
    v_add_f32 v102, v102, v106
    v_add_f32 v95, v95, v99
    v_add_f32 v103, v103, v107
    v_add_f32 v92, v92, v100
    v_add_f32 v93, v93, v101
    v_add_f32 v94, v94, v102
    v_add_f32 v95, v95, v103
    v_cvt_pk_bf16_f32 v14, v92, v93
    v_cvt_pk_bf16_f32 v15, v94, v95
    buffer_store_dwordx2 v[12:13], v157, s[8:11], s20 offen
    buffer_store_dwordx2 v[14:15], v157, s[8:11], s21 offen
KF_end:
    s_endpgm
KF_pref:
    s_load_dwordx4 s[24:27], s[0:1], 80
    s_load_dwordx2 s[40:41], s[0:1], 112
    v_lshrrev_b32 v2, 6, v0
    s_nop 0
    v_readfirstlane_b32 s22, v2
    s_sub_u32 s28, s2, 704
    s_lshr_b32 s28, s28, 3
    s_and_b32 s29, s2, 7
    s_lshr_b32 s29, s29, 1
    s_mul_i32 s36, s29, 2304
    s_mov_b32 s34, 0x510000
    s_mov_b32 s35, 0x20000
    s_mov_b32 s30, 0x1c72
    s_movk_i32 s31, 9216
    s_waitcnt lgkmcnt(0)
    s_cmp_ge_u32 s28, 9
    s_cselect_b32 s32, s26, s24
    s_cselect_b32 s33, s27, s25
    s_cselect_b32 s29, 9, 0
    s_sub_u32 s28, s28, s29
    s_mul_i32 s28, s28, 589824
    s_add_u32 s28, s28, s36

    v_add_u32 v8, 0, v0
    v_mul_lo_u32 v9, v8, s30
    v_lshrrev_b32 v9, 20, v9
    v_mul_u32_u24 v10, 144, v9
    v_sub_u32 v10, v8, v10
    v_mul_lo_u32 v9, v9, s31
    v_lshl_add_u32 v16, v10, 4, v9

    v_add_u32 v8, 256, v0
    v_mul_lo_u32 v9, v8, s30
    v_lshrrev_b32 v9, 20, v9
    v_mul_u32_u24 v10, 144, v9
    v_sub_u32 v10, v8, v10
    v_mul_lo_u32 v9, v9, s31
    v_lshl_add_u32 v17, v10, 4, v9

    v_add_u32 v8, 512, v0
    v_mul_lo_u32 v9, v8, s30
    v_lshrrev_b32 v9, 20, v9
    v_mul_u32_u24 v10, 144, v9
    v_sub_u32 v10, v8, v10
    v_mul_lo_u32 v9, v9, s31
    v_lshl_add_u32 v18, v10, 4, v9

    v_add_u32 v8, 768, v0
    v_mul_lo_u32 v9, v8, s30
    v_lshrrev_b32 v9, 20, v9
    v_mul_u32_u24 v10, 144, v9
    v_sub_u32 v10, v8, v10
    v_mul_lo_u32 v9, v9, s31
    v_lshl_add_u32 v19, v10, 4, v9

    v_add_u32 v8, 1024, v0
    v_mul_lo_u32 v9, v8, s30
    v_lshrrev_b32 v9, 20, v9
    v_mul_u32_u24 v10, 144, v9
    v_sub_u32 v10, v8, v10
    v_mul_lo_u32 v9, v9, s31
    v_lshl_add_u32 v20, v10, 4, v9

    v_add_u32 v8, 1280, v0
    v_mul_lo_u32 v9, v8, s30
    v_lshrrev_b32 v9, 20, v9
    v_mul_u32_u24 v10, 144, v9
    v_sub_u32 v10, v8, v10
    v_mul_lo_u32 v9, v9, s31
    v_lshl_add_u32 v21, v10, 4, v9

    v_add_u32 v8, 1536, v0
    v_mul_lo_u32 v9, v8, s30
    v_lshrrev_b32 v9, 20, v9
    v_mul_u32_u24 v10, 144, v9
    v_sub_u32 v10, v8, v10
    v_mul_lo_u32 v9, v9, s31
    v_lshl_add_u32 v22, v10, 4, v9

    v_add_u32 v8, 1792, v0
    v_mul_lo_u32 v9, v8, s30
    v_lshrrev_b32 v9, 20, v9
    v_mul_u32_u24 v10, 144, v9
    v_sub_u32 v10, v8, v10
    v_mul_lo_u32 v9, v9, s31
    v_lshl_add_u32 v23, v10, 4, v9

    v_add_u32 v8, 2048, v0
    v_mul_lo_u32 v9, v8, s30
    v_lshrrev_b32 v9, 20, v9
    v_mul_u32_u24 v10, 144, v9
    v_sub_u32 v10, v8, v10
    v_mul_lo_u32 v9, v9, s31
    v_lshl_add_u32 v24, v10, 4, v9

    s_getpc_b64 s[44:45]
KF_pcl:
    s_add_u32 s44, s44, gemm1_kernel-KF_pcl
    s_addc_u32 s45, s45, 0
    s_mov_b32 s46, gemm_code_end-gemm1_kernel
    s_mov_b32 s47, 0x20000
    s_sub_u32 s48, s2, 704
    s_lshr_b32 s48, s48, 3
    s_lshl_b32 s48, s48, 13
    v_lshlrev_b32 v12, 4, v0
    buffer_load_dwordx4 v[32:35], v12, s[44:47], s48 offen
    s_add_u32 s48, s48, 4096
    buffer_load_dwordx4 v[32:35], v12, s[44:47], s48 offen

    buffer_load_dwordx4 v[32:35], v16, s[32:35], s28 offen
    s_waitcnt vmcnt(8)
    buffer_load_dwordx4 v[36:39], v17, s[32:35], s28 offen
    s_waitcnt vmcnt(8)
    buffer_load_dwordx4 v[40:43], v18, s[32:35], s28 offen
    s_waitcnt vmcnt(8)
    buffer_load_dwordx4 v[44:47], v19, s[32:35], s28 offen
    s_waitcnt vmcnt(8)
    buffer_load_dwordx4 v[32:35], v20, s[32:35], s28 offen
    s_waitcnt vmcnt(8)
    buffer_load_dwordx4 v[36:39], v21, s[32:35], s28 offen
    s_waitcnt vmcnt(8)
    buffer_load_dwordx4 v[40:43], v22, s[32:35], s28 offen
    s_waitcnt vmcnt(8)
    buffer_load_dwordx4 v[44:47], v23, s[32:35], s28 offen
    s_waitcnt vmcnt(8)
    buffer_load_dwordx4 v[32:35], v24, s[32:35], s28 offen
    s_waitcnt vmcnt(8)
    s_add_u32 s28, s28, 147456
    buffer_load_dwordx4 v[32:35], v16, s[32:35], s28 offen
    s_waitcnt vmcnt(8)
    buffer_load_dwordx4 v[36:39], v17, s[32:35], s28 offen
    s_waitcnt vmcnt(8)
    buffer_load_dwordx4 v[40:43], v18, s[32:35], s28 offen
    s_waitcnt vmcnt(8)
    buffer_load_dwordx4 v[44:47], v19, s[32:35], s28 offen
    s_waitcnt vmcnt(8)
    buffer_load_dwordx4 v[32:35], v20, s[32:35], s28 offen
    s_waitcnt vmcnt(8)
    buffer_load_dwordx4 v[36:39], v21, s[32:35], s28 offen
    s_waitcnt vmcnt(8)
    buffer_load_dwordx4 v[40:43], v22, s[32:35], s28 offen
    s_waitcnt vmcnt(8)
    buffer_load_dwordx4 v[44:47], v23, s[32:35], s28 offen
    s_waitcnt vmcnt(8)
    buffer_load_dwordx4 v[32:35], v24, s[32:35], s28 offen
    s_waitcnt vmcnt(8)
    s_add_u32 s28, s28, 147456
    buffer_load_dwordx4 v[32:35], v16, s[32:35], s28 offen
    s_waitcnt vmcnt(8)
    buffer_load_dwordx4 v[36:39], v17, s[32:35], s28 offen
    s_waitcnt vmcnt(8)
    buffer_load_dwordx4 v[40:43], v18, s[32:35], s28 offen
    s_waitcnt vmcnt(8)
    buffer_load_dwordx4 v[44:47], v19, s[32:35], s28 offen
    s_waitcnt vmcnt(8)
    buffer_load_dwordx4 v[32:35], v20, s[32:35], s28 offen
    s_waitcnt vmcnt(8)
    buffer_load_dwordx4 v[36:39], v21, s[32:35], s28 offen
    s_waitcnt vmcnt(8)
    buffer_load_dwordx4 v[40:43], v22, s[32:35], s28 offen
    s_waitcnt vmcnt(8)
    buffer_load_dwordx4 v[44:47], v23, s[32:35], s28 offen
    s_waitcnt vmcnt(8)
    buffer_load_dwordx4 v[32:35], v24, s[32:35], s28 offen
    s_waitcnt vmcnt(8)
    s_add_u32 s28, s28, 147456
    buffer_load_dwordx4 v[32:35], v16, s[32:35], s28 offen
    s_waitcnt vmcnt(8)
    buffer_load_dwordx4 v[36:39], v17, s[32:35], s28 offen
    s_waitcnt vmcnt(8)
    buffer_load_dwordx4 v[40:43], v18, s[32:35], s28 offen
    s_waitcnt vmcnt(8)
    buffer_load_dwordx4 v[44:47], v19, s[32:35], s28 offen
    s_waitcnt vmcnt(8)
    buffer_load_dwordx4 v[32:35], v20, s[32:35], s28 offen
    s_waitcnt vmcnt(8)
    buffer_load_dwordx4 v[36:39], v21, s[32:35], s28 offen
    s_waitcnt vmcnt(8)
    buffer_load_dwordx4 v[40:43], v22, s[32:35], s28 offen
    s_waitcnt vmcnt(8)
    buffer_load_dwordx4 v[44:47], v23, s[32:35], s28 offen
    s_waitcnt vmcnt(8)
    buffer_load_dwordx4 v[32:35], v24, s[32:35], s28 offen
    s_waitcnt vmcnt(8)
    s_add_u32 s28, s28, 147456
    s_endpgm
.globl gemm1_kernel
.p2align 8
.type gemm1_kernel,@function
gemm1_kernel:
    s_cmp_ge_u32 s2, 256
    s_cbranch_scc1 G2_end

    s_load_dwordx4 s[4:7], s[0:1], 80
    s_load_dwordx2 s[24:25], s[0:1], 120
    s_load_dwordx2 s[46:47], s[0:1], 96
    s_load_dwordx2 s[54:55], s[0:1], 0
    s_load_dwordx2 s[40:41], s[0:1], 64
    v_lshrrev_b32 v2, 6, v0
    v_and_b32 v1, 63, v0
    s_mov_b32 s36, 0xe38f
    v_readfirstlane_b32 s3, v2
    s_and_b32 s26, s2, 7
    s_lshr_b32 s27, s2, 3
    s_mov_b32 s37, 9216

    v_add_u32 v3, 0, v1
    v_mul_lo_u32 v4, v3, s36
    v_lshrrev_b32 v4, 20, v4
    v_mul_u32_u24 v5, 18, v4
    v_sub_u32 v5, v3, v5
    v_mul_lo_u32 v4, v4, s37
    v_lshl_add_u32 v4, v5, 4, v4
    v_subrev_u32 v34, 0, v4

    v_add_u32 v3, 32, v1
    v_mul_lo_u32 v4, v3, s36
    v_lshrrev_b32 v4, 20, v4
    v_mul_u32_u24 v5, 18, v4
    v_sub_u32 v5, v3, v5
    v_mul_lo_u32 v4, v4, s37
    v_lshl_add_u32 v4, v5, 4, v4
    v_subrev_u32 v35, 512, v4

    v_add_u32 v3, 96, v1
    v_mul_lo_u32 v4, v3, s36
    v_lshrrev_b32 v4, 20, v4
    v_mul_u32_u24 v5, 18, v4
    v_sub_u32 v5, v3, v5
    v_mul_lo_u32 v4, v4, s37
    v_lshl_add_u32 v4, v5, 4, v4
    v_subrev_u32 v36, 1536, v4

    v_add_u32 v3, 160, v1
    v_mul_lo_u32 v4, v3, s36
    v_lshrrev_b32 v4, 20, v4
    v_mul_u32_u24 v5, 18, v4
    v_sub_u32 v5, v3, v5
    v_mul_lo_u32 v4, v4, s37
    v_lshl_add_u32 v4, v5, 4, v4
    v_subrev_u32 v37, 2560, v4

    v_add_u32 v3, 224, v1
    v_mul_lo_u32 v4, v3, s36
    v_lshrrev_b32 v4, 20, v4
    v_mul_u32_u24 v5, 18, v4
    v_sub_u32 v5, v3, v5
    v_mul_lo_u32 v4, v4, s37
    v_lshl_add_u32 v4, v5, 4, v4
    v_subrev_u32 v38, 3584, v4

    v_lshlrev_b32 v39, 4, v1
    s_and_b32 s42, s27, 7
    s_lshr_b32 s29, s26, 1
    s_lshl_b32 s29, s29, 3
    s_add_u32 s28, s42, s29
    s_and_b32 s29, s26, 1
    s_lshl_b32 s29, s29, 2
    s_lshr_b32 s30, s27, 3
    s_add_u32 s29, s29, s30
    s_lshl_b32 s30, s30, 3
    s_and_b32 s30, s30, 7
    s_add_u32 s42, s42, s30
    s_cmp_ge_u32 s42, 9
    s_cselect_b32 s43, 9, 0
    s_sub_u32 s42, s42, s43
    s_and_b32 s30, s3, 3
    s_mul_i32 s30, s30, 147456
    s_mul_i32 s31, s28, 288
    s_add_u32 s20, s30, s31
    s_lshl_b32 s30, s29, 3
    s_add_u32 s33, s30, s3
    s_mul_i32 s22, s33, 36864
    s_lshr_b32 s31, s3, 2
    s_mul_i32 s21, s3, 4608
    s_lshl_b32 s30, s31, 7
    s_add_u32 s21, s21, s30
    v_lshrrev_b32 v3, 5, v1
    v_lshlrev_b32 v3, 3, v3
    v_bfe_u32 v4, v1, 2, 2
    v_add_u32 v3, v3, v4
    v_mul_u32_u24 v3, 288, v3
    v_and_b32 v4, 3, v1
    v_lshl_add_u32 v3, v4, 3, v3
    v_bfe_u32 v4, v1, 4, 1
    v_mul_u32_u24 v4, 18560, v4
    v_add_u32 v30, v3, v4

    v_add_u32 v31, 36992, v30
    v_add_u32 v32, 36992, v31
    v_add_u32 v33, 36992, v32
    s_mul_i32 s43, s42, 589824
    s_add_u32 s20, s20, s43
    s_mul_i32 s43, s42, 4096
    s_add_u32 s22, s22, s43
    s_add_u32 s23, s23, s43
    s_mov_b32 s52, 589824
    s_mov_b32 s53, 4096
    s_mov_b32 s44, s42
    s_mov_b32 s45, s42
    s_waitcnt lgkmcnt(0)

    s_cmp_eq_u32 s31, 0
    s_cselect_b32 s8, s4, s6
    s_cselect_b32 s9, s5, s7
    s_mov_b32 s10, 0x510000
    s_mov_b32 s11, 0x20000

    s_add_u32 s12, s24, 0x6c0000
    s_addc_u32 s13, s25, 0
    s_mov_b32 s14, 0x240000
    s_mov_b32 s15, 0x20000
    s_add_u32 s16, s24, 0xb40000
    s_addc_u32 s17, s25, 0
    s_mov_b32 s18, 0x1200000
    s_mov_b32 s19, 0x20000
    s_lshl_b32 s35, s29, 5
    s_add_u32 s35, s35, s28
    s_lshl_b32 s32, s35, 3
    v_add_u32 v115, s32, v2
    s_movk_i32 s34, 1152
    v_mul_lo_u32 v115, v115, s34
    v_lshl_add_u32 v115, v1, 1, v115
    v_lshlrev_b32 v116, 1, v1
    v_lshlrev_b32 v117, 4, v0
    s_mul_i32 s32, s35, 9216
    s_add_u32 s34, s32, 8192

    s_mov_b32 s4, s54
    s_mov_b32 s5, s55
    s_mov_b32 s6, 0x240000
    s_mov_b32 s7, 0x20000
    s_mov_b32 s48, s40
    s_mov_b32 s49, s41
    s_mov_b32 s50, 0x480
    s_mov_b32 s51, 0x20000
    s_add_u32 s56, s24, 0x240000
    s_addc_u32 s57, s25, 0
    s_mov_b32 s58, 0x240000
    s_mov_b32 s59, 0x20000
    buffer_load_dwordx4 v[160:163], v117, s[56:59], s32 offen
    s_cmp_lg_u32 s3, 0
    s_cbranch_scc1 G1L_skip1
    buffer_load_dwordx4 v[164:167], v117, s[56:59], s34 offen

G1L_skip1:
    buffer_load_short_d16_hi v122, v115, s[4:7], 0 offen offset:0
    buffer_load_short_d16_hi v123, v115, s[4:7], 0 offen offset:128
    buffer_load_short_d16_hi v124, v115, s[4:7], 0 offen offset:256
    buffer_load_short_d16_hi v125, v115, s[4:7], 0 offen offset:384
    buffer_load_short_d16_hi v126, v115, s[4:7], 0 offen offset:512
    buffer_load_short_d16_hi v127, v115, s[4:7], 0 offen offset:640
    buffer_load_short_d16_hi v128, v115, s[4:7], 0 offen offset:768
    buffer_load_short_d16_hi v129, v115, s[4:7], 0 offen offset:896
    buffer_load_short_d16_hi v130, v115, s[4:7], 0 offen offset:1024
    buffer_load_short_d16_hi v131, v116, s[48:51], 0 offen offset:0
    buffer_load_short_d16_hi v132, v116, s[48:51], 0 offen offset:128
    buffer_load_short_d16_hi v133, v116, s[48:51], 0 offen offset:256
    buffer_load_short_d16_hi v134, v116, s[48:51], 0 offen offset:384
    buffer_load_short_d16_hi v135, v116, s[48:51], 0 offen offset:512
    buffer_load_short_d16_hi v136, v116, s[48:51], 0 offen offset:640
    buffer_load_short_d16_hi v137, v116, s[48:51], 0 offen offset:768
    buffer_load_short_d16_hi v138, v116, s[48:51], 0 offen offset:896
    buffer_load_short_d16_hi v139, v116, s[48:51], 0 offen offset:1024
    s_add_u32 s56, s24, 0x2f80000
    s_addc_u32 s57, s25, 0
    s_mov_b32 s58, 0x4000
    s_mov_b32 s59, 0x20000
    s_lshl_b32 s32, s35, 6
    v_lshlrev_b32 v119, 3, v2
    buffer_load_dwordx2 v[168:169], v119, s[56:59], s32 offen

    s_add_u32 s56, s24, 0x480000
    s_addc_u32 s57, s25, 0
    s_mov_b32 s58, 0x240000
    s_mov_b32 s59, 0x20000
    s_add_u32 s48, s24, 0x2f40000
    s_addc_u32 s49, s25, 0
    s_mov_b32 s50, 0x20000
    s_mov_b32 s51, 0x20000
    v_lshlrev_b32 v118, 1, v0
    v_add_u32 v118, 110976, v118
    s_waitcnt vmcnt(19)

    ds_write_b16 v118, v160 offset:0
    ds_write_b16_d16_hi v118, v160 offset:1160
    ds_write_b16 v118, v161 offset:2320
    ds_write_b16_d16_hi v118, v161 offset:3480
    ds_write_b16 v118, v162 offset:4640
    ds_write_b16_d16_hi v118, v162 offset:5800
    ds_write_b16 v118, v163 offset:6960
    ds_write_b16_d16_hi v118, v163 offset:8120
    s_cmp_lg_u32 s3, 0
    s_cbranch_scc1 G1L_skip2

    ds_write_b16 v118, v164 offset:1024
    ds_write_b16_d16_hi v118, v164 offset:2184
    ds_write_b16 v118, v165 offset:3344
    ds_write_b16_d16_hi v118, v165 offset:4504
    ds_write_b16 v118, v166 offset:5664
    ds_write_b16_d16_hi v118, v166 offset:6824
    ds_write_b16 v118, v167 offset:7984
    ds_write_b16_d16_hi v118, v167 offset:9144
G1L_skip2:
    v_mul_u32_u24 v119, 1160, v2
    v_lshl_add_u32 v119, v1, 1, v119
    v_add_u32 v119, 110976, v119
    s_waitcnt vmcnt(0)

    v_mov_b32 v149, v122
    v_mov_b32 v150, v123
    v_mov_b32 v151, v124
    v_mov_b32 v152, v125
    v_mov_b32 v153, v126
    v_mov_b32 v154, v127
    v_mov_b32 v155, v128
    v_mov_b32 v156, v129
    v_mov_b32 v157, v130
    v_rcp_f32 v170, v168
    s_nop 0
    v_sub_f32 v149, v149, v169
    v_sub_f32 v150, v150, v169
    v_cvt_pk_bf16_f32 v171, v149, v150
    v_lshlrev_b32 v149, 16, v171
    v_and_b32 v150, 0xffff0000, v171
    v_sub_f32 v151, v151, v169
    v_sub_f32 v152, v152, v169
    v_cvt_pk_bf16_f32 v171, v151, v152
    v_lshlrev_b32 v151, 16, v171
    v_and_b32 v152, 0xffff0000, v171
    v_sub_f32 v153, v153, v169
    v_sub_f32 v154, v154, v169
    v_cvt_pk_bf16_f32 v171, v153, v154
    v_lshlrev_b32 v153, 16, v171
    v_and_b32 v154, 0xffff0000, v171
    v_sub_f32 v155, v155, v169
    v_sub_f32 v156, v156, v169
    v_cvt_pk_bf16_f32 v171, v155, v156
    v_lshlrev_b32 v155, 16, v171
    v_and_b32 v156, 0xffff0000, v171
    v_sub_f32 v157, v157, v169
    v_cvt_pk_bf16_f32 v171, v157, v157
    v_lshlrev_b32 v157, 16, v171
    v_mul_f32 v171, v149, v170
    v_fma_f32 v149, -v171, v168, v149
    v_fma_f32 v149, v149, v170, v171
    v_mul_f32 v171, v150, v170
    v_fma_f32 v150, -v171, v168, v150
    v_fma_f32 v150, v150, v170, v171
    v_mul_f32 v171, v151, v170
    v_fma_f32 v151, -v171, v168, v151
    v_fma_f32 v151, v151, v170, v171
    v_mul_f32 v171, v152, v170
    v_fma_f32 v152, -v171, v168, v152
    v_fma_f32 v152, v152, v170, v171
    v_mul_f32 v171, v153, v170
    v_fma_f32 v153, -v171, v168, v153
    v_fma_f32 v153, v153, v170, v171
    v_mul_f32 v171, v154, v170
    v_fma_f32 v154, -v171, v168, v154
    v_fma_f32 v154, v154, v170, v171
    v_mul_f32 v171, v155, v170
    v_fma_f32 v155, -v171, v168, v155
    v_fma_f32 v155, v155, v170, v171
    v_mul_f32 v171, v156, v170
    v_fma_f32 v156, -v171, v168, v156
    v_fma_f32 v156, v156, v170, v171
    v_mul_f32 v171, v157, v170
    v_fma_f32 v157, -v171, v168, v157
    v_fma_f32 v157, v157, v170, v171
    s_waitcnt lgkmcnt(0)
    s_barrier
    ds_read_u16_d16_hi v140, v119 offset:0
    ds_read_u16_d16_hi v141, v119 offset:128
    ds_read_u16_d16_hi v142, v119 offset:256
    ds_read_u16_d16_hi v143, v119 offset:384
    ds_read_u16_d16_hi v144, v119 offset:512
    ds_read_u16_d16_hi v145, v119 offset:640
    ds_read_u16_d16_hi v146, v119 offset:768
    ds_read_u16_d16_hi v147, v119 offset:896
    ds_read_u16_d16_hi v148, v119 offset:1024
    v_cvt_pk_bf16_f32 v168, v149, v150
    v_lshlrev_b32 v149, 16, v168
    v_and_b32 v150, 0xffff0000, v168
    v_cvt_pk_bf16_f32 v168, v151, v152
    v_lshlrev_b32 v151, 16, v168
    v_and_b32 v152, 0xffff0000, v168
    v_cvt_pk_bf16_f32 v168, v153, v154
    v_lshlrev_b32 v153, 16, v168
    v_and_b32 v154, 0xffff0000, v168
    v_cvt_pk_bf16_f32 v168, v155, v156
    v_lshlrev_b32 v155, 16, v168
    v_and_b32 v156, 0xffff0000, v168
    v_cvt_pk_bf16_f32 v168, v157, v157
    v_lshlrev_b32 v157, 16, v168
    v_mul_f32 v149, v149, v131
    v_mul_f32 v150, v150, v132
    v_mul_f32 v151, v151, v133
    v_mul_f32 v152, v152, v134
    v_mul_f32 v153, v153, v135
    v_mul_f32 v154, v154, v136
    v_mul_f32 v155, v155, v137
    v_mul_f32 v156, v156, v138
    v_mul_f32 v157, v157, v139
    v_cvt_pk_bf16_f32 v168, v149, v150
    v_lshlrev_b32 v149, 16, v168
    v_and_b32 v150, 0xffff0000, v168
    v_cvt_pk_bf16_f32 v168, v151, v152
    v_lshlrev_b32 v151, 16, v168
    v_and_b32 v152, 0xffff0000, v168
    v_cvt_pk_bf16_f32 v168, v153, v154
    v_lshlrev_b32 v153, 16, v168
    v_and_b32 v154, 0xffff0000, v168
    v_cvt_pk_bf16_f32 v168, v155, v156
    v_lshlrev_b32 v155, 16, v168
    v_and_b32 v156, 0xffff0000, v168
    v_cvt_pk_bf16_f32 v168, v157, v157
    v_lshlrev_b32 v157, 16, v168
    s_waitcnt lgkmcnt(0)
    v_add_f32 v149, v149, v140
    v_add_f32 v150, v150, v141
    v_add_f32 v151, v151, v142
    v_add_f32 v152, v152, v143
    v_add_f32 v153, v153, v144
    v_add_f32 v154, v154, v145
    v_add_f32 v155, v155, v146
    v_add_f32 v156, v156, v147
    v_add_f32 v157, v157, v148
    v_cvt_pk_bf16_f32 v168, v149, v150
    v_lshlrev_b32 v149, 16, v168
    v_and_b32 v150, 0xffff0000, v168
    v_cvt_pk_bf16_f32 v168, v151, v152
    v_lshlrev_b32 v151, 16, v168
    v_and_b32 v152, 0xffff0000, v168
    v_cvt_pk_bf16_f32 v168, v153, v154
    v_lshlrev_b32 v153, 16, v168
    v_and_b32 v154, 0xffff0000, v168
    v_cvt_pk_bf16_f32 v168, v155, v156
    v_lshlrev_b32 v155, 16, v168
    v_and_b32 v156, 0xffff0000, v168
    v_cvt_pk_bf16_f32 v168, v157, v157
    v_lshlrev_b32 v157, 16, v168
    v_add_f32 v122, v122, v149
    v_add_f32 v123, v123, v150
    v_add_f32 v124, v124, v151
    v_add_f32 v125, v125, v152
    v_add_f32 v126, v126, v153
    v_add_f32 v127, v127, v154
    v_add_f32 v128, v128, v155
    v_add_f32 v129, v129, v156
    v_add_f32 v130, v130, v157
    v_cvt_pk_bf16_f32 v168, v122, v123
    v_lshlrev_b32 v122, 16, v168
    v_and_b32 v123, 0xffff0000, v168
    v_cvt_pk_bf16_f32 v168, v124, v125
    v_lshlrev_b32 v124, 16, v168
    v_and_b32 v125, 0xffff0000, v168
    v_cvt_pk_bf16_f32 v168, v126, v127
    v_lshlrev_b32 v126, 16, v168
    v_and_b32 v127, 0xffff0000, v168
    v_cvt_pk_bf16_f32 v168, v128, v129
    v_lshlrev_b32 v128, 16, v168
    v_and_b32 v129, 0xffff0000, v168
    v_cvt_pk_bf16_f32 v168, v130, v130
    v_lshlrev_b32 v130, 16, v168
    buffer_store_short_d16_hi v122, v115, s[56:59], 0 offen offset:0 sc1
    buffer_store_short_d16_hi v123, v115, s[56:59], 0 offen offset:128 sc1
    buffer_store_short_d16_hi v124, v115, s[56:59], 0 offen offset:256 sc1
    buffer_store_short_d16_hi v125, v115, s[56:59], 0 offen offset:384 sc1
    buffer_store_short_d16_hi v126, v115, s[56:59], 0 offen offset:512 sc1
    buffer_store_short_d16_hi v127, v115, s[56:59], 0 offen offset:640 sc1
    buffer_store_short_d16_hi v128, v115, s[56:59], 0 offen offset:768 sc1
    buffer_store_short_d16_hi v129, v115, s[56:59], 0 offen offset:896 sc1
    buffer_store_short_d16_hi v130, v115, s[56:59], 0 offen offset:1024 sc1
    v_mov_b32 v149, v122
    v_mov_b32 v150, v123
    v_mov_b32 v151, v124
    v_mov_b32 v152, v125
    v_mov_b32 v153, v126
    v_mov_b32 v154, v127
    v_mov_b32 v155, v128
    v_mov_b32 v156, v129
    v_mov_b32 v157, v130
    v_add_f32 v168, v149, v150
    v_add_f32 v168, v168, v151
    v_add_f32 v168, v168, v152
    v_add_f32 v168, v168, v153
    v_add_f32 v168, v168, v154
    v_add_f32 v168, v168, v155
    v_add_f32 v168, v168, v156
    v_add_f32 v168, v168, v157
    s_nop 2
    v_add_f32_dpp v168, v168, v168 quad_perm:[1,0,3,2] row_mask:0xf bank_mask:0xf
    s_nop 1
    v_add_f32_dpp v168, v168, v168 quad_perm:[2,3,0,1] row_mask:0xf bank_mask:0xf
    s_nop 1
    v_add_f32_dpp v168, v168, v168 row_half_mirror row_mask:0xf bank_mask:0xf
    s_nop 1
    v_add_f32_dpp v168, v168, v168 row_mirror row_mask:0xf bank_mask:0xf
    s_nop 1
    v_add_f32_dpp v168, v168, v168 row_bcast:15 row_mask:0xa bank_mask:0xf
    s_nop 1
    v_add_f32_dpp v168, v168, v168 row_bcast:31 row_mask:0xc bank_mask:0xf
    s_nop 1
    s_nop 1
    v_readlane_b32 s38, v168, 63
    s_nop 1
    v_mov_b32 v169, s38
    v_mul_f32 v169, 0x3ae38e39, v169
    v_mov_b32 v168, 0
    v_sub_f32 v170, v149, v169
    v_fmac_f32 v168, v170, v170
    v_sub_f32 v170, v150, v169
    v_fmac_f32 v168, v170, v170
    v_sub_f32 v170, v151, v169
    v_fmac_f32 v168, v170, v170
    v_sub_f32 v170, v152, v169
    v_fmac_f32 v168, v170, v170
    v_sub_f32 v170, v153, v169
    v_fmac_f32 v168, v170, v170
    v_sub_f32 v170, v154, v169
    v_fmac_f32 v168, v170, v170
    v_sub_f32 v170, v155, v169
    v_fmac_f32 v168, v170, v170
    v_sub_f32 v170, v156, v169
    v_fmac_f32 v168, v170, v170
    v_sub_f32 v170, v157, v169
    v_fmac_f32 v168, v170, v170
    s_nop 2
    v_add_f32_dpp v168, v168, v168 quad_perm:[1,0,3,2] row_mask:0xf bank_mask:0xf
    s_nop 1
    v_add_f32_dpp v168, v168, v168 quad_perm:[2,3,0,1] row_mask:0xf bank_mask:0xf
    s_nop 1
    v_add_f32_dpp v168, v168, v168 row_half_mirror row_mask:0xf bank_mask:0xf
    s_nop 1
    v_add_f32_dpp v168, v168, v168 row_mirror row_mask:0xf bank_mask:0xf
    s_nop 1
    v_add_f32_dpp v168, v168, v168 row_bcast:15 row_mask:0xa bank_mask:0xf
    s_nop 1
    v_add_f32_dpp v168, v168, v168 row_bcast:31 row_mask:0xc bank_mask:0xf
    s_nop 1
    s_nop 1
    v_readlane_b32 s38, v168, 63
    s_nop 1
    v_mov_b32 v168, s38
    v_mul_f32 v168, 0x3ae38e39, v168
    v_cvt_pk_bf16_f32 v170, v169, v168
    v_lshlrev_b32 v169, 16, v170
    v_and_b32 v168, 0xffff0000, v170
    v_add_f32 v168, 0x3727c5ac, v168
    v_cvt_pk_bf16_f32 v168, v168, v168
    v_and_b32 v168, 0xffff0000, v168
    v_sqrt_f32 v168, v168
    s_nop 0
    v_cvt_pk_bf16_f32 v168, v168, v168
    v_and_b32 v168, 0xffff0000, v168
    v_rcp_f32 v170, v168
    s_nop 0
    v_sub_f32 v149, v149, v169
    v_sub_f32 v150, v150, v169
    v_cvt_pk_bf16_f32 v171, v149, v150
    v_lshlrev_b32 v149, 16, v171
    v_and_b32 v150, 0xffff0000, v171
    v_sub_f32 v151, v151, v169
    v_sub_f32 v152, v152, v169
    v_cvt_pk_bf16_f32 v171, v151, v152
    v_lshlrev_b32 v151, 16, v171
    v_and_b32 v152, 0xffff0000, v171
    v_sub_f32 v153, v153, v169
    v_sub_f32 v154, v154, v169
    v_cvt_pk_bf16_f32 v171, v153, v154
    v_lshlrev_b32 v153, 16, v171
    v_and_b32 v154, 0xffff0000, v171
    v_sub_f32 v155, v155, v169
    v_sub_f32 v156, v156, v169
    v_cvt_pk_bf16_f32 v171, v155, v156
    v_lshlrev_b32 v155, 16, v171
    v_and_b32 v156, 0xffff0000, v171
    v_sub_f32 v157, v157, v169
    v_cvt_pk_bf16_f32 v171, v157, v157
    v_lshlrev_b32 v157, 16, v171
    v_mul_f32 v171, v149, v170
    v_fma_f32 v149, -v171, v168, v149
    v_fma_f32 v149, v149, v170, v171
    v_mul_f32 v171, v150, v170
    v_fma_f32 v150, -v171, v168, v150
    v_fma_f32 v150, v150, v170, v171
    v_mul_f32 v171, v151, v170
    v_fma_f32 v151, -v171, v168, v151
    v_fma_f32 v151, v151, v170, v171
    v_mul_f32 v171, v152, v170
    v_fma_f32 v152, -v171, v168, v152
    v_fma_f32 v152, v152, v170, v171
    v_mul_f32 v171, v153, v170
    v_fma_f32 v153, -v171, v168, v153
    v_fma_f32 v153, v153, v170, v171
    v_mul_f32 v171, v154, v170
    v_fma_f32 v154, -v171, v168, v154
    v_fma_f32 v154, v154, v170, v171
    v_mul_f32 v171, v155, v170
    v_fma_f32 v155, -v171, v168, v155
    v_fma_f32 v155, v155, v170, v171
    v_mul_f32 v171, v156, v170
    v_fma_f32 v156, -v171, v168, v156
    v_fma_f32 v156, v156, v170, v171
    v_mul_f32 v171, v157, v170
    v_fma_f32 v157, -v171, v168, v157
    v_fma_f32 v157, v157, v170, v171
    v_lshrrev_b32 v120, 3, v1
    v_lshlrev_b32 v120, 7, v120
    v_lshl_add_u32 v120, v2, 4, v120
    v_and_b32 v121, 7, v1
    v_lshl_add_u32 v120, v121, 1, v120
    v_add_u32 v120, 110976, v120

    v_cvt_pk_bf16_f32 v149, v149, v150
    v_cvt_pk_bf16_f32 v151, v151, v152
    v_cvt_pk_bf16_f32 v153, v153, v154
    v_cvt_pk_bf16_f32 v155, v155, v156
    v_cvt_pk_bf16_f32 v157, v157, v157
    ds_write_b16 v120, v149 offset:9280
    ds_write_b16_d16_hi v120, v149 offset:10304
    ds_write_b16 v120, v151 offset:11328
    ds_write_b16_d16_hi v120, v151 offset:12352
    ds_write_b16 v120, v153 offset:13376
    ds_write_b16_d16_hi v120, v153 offset:14400
    ds_write_b16 v120, v155 offset:15424
    ds_write_b16_d16_hi v120, v155 offset:16448
    ds_write_b16 v120, v157 offset:17472
    v_add_u32 v120, 110976, v117
    v_lshrrev_b32 v121, 3, v0
    v_lshlrev_b32 v121, 9, v121
    v_and_b32 v118, 7, v0
    v_lshl_add_u32 v121, v118, 4, v121
    s_lshr_b32 s32, s35, 2
    s_mul_i32 s34, s32, 36864
    s_and_b32 s38, s35, 3
    s_lshl_b32 s38, s38, 7
    s_add_u32 s34, s34, s38
    s_add_u32 s38, s34, 32768
    s_lshl_b32 s32, s32, 7
    s_add_u32 s32, s32, 8192
    s_lshl_b32 s35, s33, 7
    s_add_u32 s35, s35, 8192
    s_waitcnt lgkmcnt(0)
    s_barrier
    ds_read_b128 v[160:163], v120 offset:9280
    s_cmp_lg_u32 s3, 0
    s_cbranch_scc1 G1L_skip3
    ds_read_b128 v[164:167], v120 offset:17472
    s_waitcnt lgkmcnt(0)
    buffer_store_dwordx4 v[164:167], v121, s[12:15], s38 offen sc1

G1L_skip3:
    s_waitcnt lgkmcnt(0)
    buffer_store_dwordx4 v[160:163], v121, s[12:15], s34 offen sc1
    v_mov_b32 v118, 0
    v_mov_b32 v119, 1
    s_waitcnt vmcnt(0)
    s_barrier

    s_mov_b64 exec, 1
    s_cmp_lg_u32 s3, 0
    s_cbranch_scc1 G1L_noat
    buffer_atomic_add v119, v118, s[48:51], s32 offen sc1

G1L_noat:
    s_mov_b64 exec, -1
    s_add_u32 s39, s21, 0
    s_mov_b32 m0, s39
    s_mov_b64 exec, 0xffffffff
    buffer_load_dwordx4 v34, s[8:11], s20 offen lds
    s_mov_b64 exec, -1
    buffer_load_dwordx4 v35, s[8:11], s20 offen offset:512 lds
    buffer_load_dwordx4 v36, s[8:11], s20 offen offset:1536 lds
    buffer_load_dwordx4 v37, s[8:11], s20 offen offset:2560 lds
    buffer_load_dwordx4 v38, s[8:11], s20 offen offset:3584 lds
    s_add_u32 s44, s44, 1
    s_cmp_eq_u32 s44, 9
    s_cselect_b32 s43, 0xffb80000, s52
    s_add_u32 s20, s20, s43
    s_add_u32 s39, s21, 36992
    s_mov_b32 m0, s39
    s_mov_b64 exec, 0xffffffff
    buffer_load_dwordx4 v34, s[8:11], s20 offen lds
    s_mov_b64 exec, -1
    buffer_load_dwordx4 v35, s[8:11], s20 offen offset:512 lds
    buffer_load_dwordx4 v36, s[8:11], s20 offen offset:1536 lds
    buffer_load_dwordx4 v37, s[8:11], s20 offen offset:2560 lds
    buffer_load_dwordx4 v38, s[8:11], s20 offen offset:3584 lds
    s_add_u32 s44, s44, 1
    s_cmp_eq_u32 s44, 9
    s_cselect_b32 s43, 0xffb80000, s52
    s_add_u32 s20, s20, s43
    s_add_u32 s39, s21, 73984
    s_mov_b32 m0, s39
    s_mov_b64 exec, 0xffffffff
    buffer_load_dwordx4 v34, s[8:11], s20 offen lds
    s_mov_b64 exec, -1
    buffer_load_dwordx4 v35, s[8:11], s20 offen offset:512 lds
    buffer_load_dwordx4 v36, s[8:11], s20 offen offset:1536 lds
    buffer_load_dwordx4 v37, s[8:11], s20 offen offset:2560 lds
    buffer_load_dwordx4 v38, s[8:11], s20 offen offset:3584 lds
    s_add_u32 s44, s44, 1
    s_cmp_eq_u32 s44, 9
    s_cselect_b32 s43, 0xffb80000, s52
    s_add_u32 s20, s20, s43
    s_mov_b64 exec, 1
    s_mov_b32 s39, 0
G1L_poll:
    buffer_load_dword v119, v118, s[48:51], s35 offen sc1
    s_waitcnt vmcnt(0)
    v_readfirstlane_b32 s38, v119
    s_cmp_ge_u32 s38, 4
    s_cbranch_scc1 G1L_go
    s_sleep 1
    s_add_u32 s39, s39, 1
    s_cmp_lt_u32 s39, 0x100000
    s_cbranch_scc1 G1L_poll

G1L_go:
    s_mov_b64 exec, -1

    buffer_load_dwordx4 v[40:43], v39, s[12:15], s22 offen offset:0 sc1
    buffer_load_dwordx4 v[44:47], v39, s[12:15], s22 offen offset:1024 sc1
    buffer_load_dwordx4 v[48:51], v39, s[12:15], s22 offen offset:2048 sc1
    buffer_load_dwordx4 v[52:55], v39, s[12:15], s22 offen offset:3072 sc1
    s_add_u32 s45, s45, 1
    s_cmp_eq_u32 s45, 9
    s_cselect_b32 s43, 0xffff8000, s53
    s_add_u32 s22, s22, s43
    buffer_load_dwordx4 v[56:59], v39, s[12:15], s22 offen offset:0 sc1
    buffer_load_dwordx4 v[60:63], v39, s[12:15], s22 offen offset:1024 sc1
    buffer_load_dwordx4 v[64:67], v39, s[12:15], s22 offen offset:2048 sc1
    buffer_load_dwordx4 v[68:71], v39, s[12:15], s22 offen offset:3072 sc1
    s_add_u32 s45, s45, 1
    s_cmp_eq_u32 s45, 9
    s_cselect_b32 s43, 0xffff8000, s53
    s_add_u32 s22, s22, s43
    v_mov_b32 v112, 0
    v_mov_b32 v113, 0
    v_mov_b32 v114, 0
    v_mov_b32 v115, 0
    v_mov_b32 v116, 0
    v_mov_b32 v117, 0
    v_mov_b32 v118, 0
    v_mov_b32 v119, 0
    v_mov_b32 v120, 0
    v_mov_b32 v121, 0
    v_mov_b32 v122, 0
    v_mov_b32 v123, 0
    v_mov_b32 v124, 0
    v_mov_b32 v125, 0
    v_mov_b32 v126, 0
    v_mov_b32 v127, 0
    v_mov_b32 v128, 0
    v_mov_b32 v129, 0
    v_mov_b32 v130, 0
    v_mov_b32 v131, 0
    v_mov_b32 v132, 0
    v_mov_b32 v133, 0
    v_mov_b32 v134, 0
    v_mov_b32 v135, 0
    v_mov_b32 v136, 0
    v_mov_b32 v137, 0
    v_mov_b32 v138, 0
    v_mov_b32 v139, 0
    v_mov_b32 v140, 0
    v_mov_b32 v141, 0
    v_mov_b32 v142, 0
    v_mov_b32 v143, 0
    v_mov_b32 v144, 0
    v_mov_b32 v145, 0
    v_mov_b32 v146, 0
    v_mov_b32 v147, 0
    v_mov_b32 v148, 0
    v_mov_b32 v149, 0
    v_mov_b32 v150, 0
    v_mov_b32 v151, 0
    v_mov_b32 v152, 0
    v_mov_b32 v153, 0
    v_mov_b32 v154, 0
    v_mov_b32 v155, 0
    v_mov_b32 v156, 0
    v_mov_b32 v157, 0
    v_mov_b32 v158, 0
    v_mov_b32 v159, 0
    v_mov_b32 v160, 0
    v_mov_b32 v161, 0
    v_mov_b32 v162, 0
    v_mov_b32 v163, 0
    v_mov_b32 v164, 0
    v_mov_b32 v165, 0
    v_mov_b32 v166, 0
    v_mov_b32 v167, 0
    v_mov_b32 v168, 0
    v_mov_b32 v169, 0
    v_mov_b32 v170, 0
    v_mov_b32 v171, 0
    v_mov_b32 v172, 0
    v_mov_b32 v173, 0
    v_mov_b32 v174, 0
    v_mov_b32 v175, 0
    v_mov_b32 v176, 0
    v_mov_b32 v177, 0
    v_mov_b32 v178, 0
    v_mov_b32 v179, 0
    v_mov_b32 v180, 0
    v_mov_b32 v181, 0
    v_mov_b32 v182, 0
    v_mov_b32 v183, 0
    v_mov_b32 v184, 0
    v_mov_b32 v185, 0
    v_mov_b32 v186, 0
    v_mov_b32 v187, 0
    v_mov_b32 v188, 0
    v_mov_b32 v189, 0
    v_mov_b32 v190, 0
    v_mov_b32 v191, 0
    v_mov_b32 v192, 0
    v_mov_b32 v193, 0
    v_mov_b32 v194, 0
    v_mov_b32 v195, 0
    v_mov_b32 v196, 0
    v_mov_b32 v197, 0
    v_mov_b32 v198, 0
    v_mov_b32 v199, 0
    v_mov_b32 v200, 0
    v_mov_b32 v201, 0
    v_mov_b32 v202, 0
    v_mov_b32 v203, 0
    v_mov_b32 v204, 0
    v_mov_b32 v205, 0
    v_mov_b32 v206, 0
    v_mov_b32 v207, 0
    v_mov_b32 v208, 0
    v_mov_b32 v209, 0
    v_mov_b32 v210, 0
    v_mov_b32 v211, 0
    v_mov_b32 v212, 0
    v_mov_b32 v213, 0
    v_mov_b32 v214, 0
    v_mov_b32 v215, 0
    v_mov_b32 v216, 0
    v_mov_b32 v217, 0
    v_mov_b32 v218, 0
    v_mov_b32 v219, 0
    v_mov_b32 v220, 0
    v_mov_b32 v221, 0
    v_mov_b32 v222, 0
    v_mov_b32 v223, 0
    v_mov_b32 v224, 0
    v_mov_b32 v225, 0
    v_mov_b32 v226, 0
    v_mov_b32 v227, 0
    v_mov_b32 v228, 0
    v_mov_b32 v229, 0
    v_mov_b32 v230, 0
    v_mov_b32 v231, 0
    v_mov_b32 v232, 0
    v_mov_b32 v233, 0
    v_mov_b32 v234, 0
    v_mov_b32 v235, 0
    v_mov_b32 v236, 0
    v_mov_b32 v237, 0
    v_mov_b32 v238, 0
    v_mov_b32 v239, 0
    v_mov_b32 v240, 0
    v_mov_b32 v241, 0
    v_mov_b32 v242, 0
    v_mov_b32 v243, 0
    v_mov_b32 v244, 0
    v_mov_b32 v245, 0
    v_mov_b32 v246, 0
    v_mov_b32 v247, 0
    v_mov_b32 v248, 0
    v_mov_b32 v249, 0
    v_mov_b32 v250, 0
    v_mov_b32 v251, 0
    v_mov_b32 v252, 0
    v_mov_b32 v253, 0
    v_mov_b32 v254, 0
    v_mov_b32 v255, 0
    s_waitcnt vmcnt(4)
    s_barrier
    ds_read_b64_tr_b16 v[88:89], v30 offset:0
    ds_read_b64_tr_b16 v[90:91], v30 offset:1152
    ds_read_b64_tr_b16 v[92:93], v30 offset:32
    ds_read_b64_tr_b16 v[94:95], v30 offset:1184
    ds_read_b64_tr_b16 v[96:97], v30 offset:64
    ds_read_b64_tr_b16 v[98:99], v30 offset:1216
    ds_read_b64_tr_b16 v[100:101], v30 offset:96
    ds_read_b64_tr_b16 v[102:103], v30 offset:1248
    ds_read_b64_tr_b16 v[104:105], v30 offset:128
    ds_read_b64_tr_b16 v[106:107], v30 offset:1280
    ds_read_b64_tr_b16 v[108:109], v30 offset:160
    ds_read_b64_tr_b16 v[110:111], v30 offset:1312
    s_waitcnt lgkmcnt(10)
    v_mfma_f32_32x32x16_bf16 v[112:127], v[88:91], v[40:43], v[112:127]
    ds_read_b64_tr_b16 v[88:89], v30 offset:192
    ds_read_b64_tr_b16 v[90:91], v30 offset:1344
    s_waitcnt lgkmcnt(10)
    v_mfma_f32_32x32x16_bf16 v[128:143], v[92:95], v[40:43], v[128:143]
    buffer_load_dwordx4 v[72:75], v39, s[12:15], s22 offen offset:0 sc1
    ds_read_b64_tr_b16 v[92:93], v30 offset:224
    ds_read_b64_tr_b16 v[94:95], v30 offset:1376
    s_waitcnt lgkmcnt(10)
    v_mfma_f32_32x32x16_bf16 v[144:159], v[96:99], v[40:43], v[144:159]
    ds_read_b64_tr_b16 v[96:97], v30 offset:256
    ds_read_b64_tr_b16 v[98:99], v30 offset:1408
    s_waitcnt lgkmcnt(10)
    v_mfma_f32_32x32x16_bf16 v[160:175], v[100:103], v[40:43], v[160:175]
    ds_read_b64_tr_b16 v[100:101], v30 offset:4608
    ds_read_b64_tr_b16 v[102:103], v30 offset:5760
    s_waitcnt lgkmcnt(10)
    v_mfma_f32_32x32x16_bf16 v[176:191], v[104:107], v[40:43], v[176:191]
    buffer_load_dwordx4 v[76:79], v39, s[12:15], s22 offen offset:1024 sc1
    ds_read_b64_tr_b16 v[104:105], v30 offset:4640
    ds_read_b64_tr_b16 v[106:107], v30 offset:5792
    s_waitcnt lgkmcnt(10)
    v_mfma_f32_32x32x16_bf16 v[192:207], v[108:111], v[40:43], v[192:207]
    ds_read_b64_tr_b16 v[108:109], v30 offset:4672
    ds_read_b64_tr_b16 v[110:111], v30 offset:5824
    s_waitcnt lgkmcnt(10)
    v_mfma_f32_32x32x16_bf16 v[208:223], v[88:91], v[40:43], v[208:223]
    ds_read_b64_tr_b16 v[88:89], v30 offset:4704
    ds_read_b64_tr_b16 v[90:91], v30 offset:5856
    s_waitcnt lgkmcnt(10)
    v_mfma_f32_32x32x16_bf16 v[224:239], v[92:95], v[40:43], v[224:239]
    ds_read_b64_tr_b16 v[92:93], v30 offset:4736
    ds_read_b64_tr_b16 v[94:95], v30 offset:5888
    s_waitcnt lgkmcnt(10)
    v_mfma_f32_32x32x16_bf16 v[240:255], v[96:99], v[40:43], v[240:255]
    buffer_load_dwordx4 v[80:83], v39, s[12:15], s22 offen offset:2048 sc1
    ds_read_b64_tr_b16 v[96:97], v30 offset:4768
    ds_read_b64_tr_b16 v[98:99], v30 offset:5920
    s_waitcnt lgkmcnt(10)
    v_mfma_f32_32x32x16_bf16 v[112:127], v[100:103], v[44:47], v[112:127]
    ds_read_b64_tr_b16 v[100:101], v30 offset:4800
    ds_read_b64_tr_b16 v[102:103], v30 offset:5952
    s_waitcnt lgkmcnt(10)
    v_mfma_f32_32x32x16_bf16 v[128:143], v[104:107], v[44:47], v[128:143]
    ds_read_b64_tr_b16 v[104:105], v30 offset:4832
    ds_read_b64_tr_b16 v[106:107], v30 offset:5984
    s_waitcnt lgkmcnt(10)
    v_mfma_f32_32x32x16_bf16 v[144:159], v[108:111], v[44:47], v[144:159]
    ds_read_b64_tr_b16 v[108:109], v30 offset:4864
    ds_read_b64_tr_b16 v[110:111], v30 offset:6016
    s_waitcnt lgkmcnt(10)
    v_mfma_f32_32x32x16_bf16 v[160:175], v[88:91], v[44:47], v[160:175]
    buffer_load_dwordx4 v[84:87], v39, s[12:15], s22 offen offset:3072 sc1
    s_add_u32 s45, s45, 1
    s_cmp_eq_u32 s45, 9
    s_cselect_b32 s43, 0xffff8000, s53
    s_add_u32 s22, s22, s43
    ds_read_b64_tr_b16 v[88:89], v30 offset:9216
    ds_read_b64_tr_b16 v[90:91], v30 offset:10368
    s_waitcnt lgkmcnt(10)
    v_mfma_f32_32x32x16_bf16 v[176:191], v[92:95], v[44:47], v[176:191]
    ds_read_b64_tr_b16 v[92:93], v30 offset:9248
    ds_read_b64_tr_b16 v[94:95], v30 offset:10400
    s_waitcnt lgkmcnt(10)
    v_mfma_f32_32x32x16_bf16 v[192:207], v[96:99], v[44:47], v[192:207]
    ds_read_b64_tr_b16 v[96:97], v30 offset:9280
    ds_read_b64_tr_b16 v[98:99], v30 offset:10432
    s_waitcnt lgkmcnt(10)
    v_mfma_f32_32x32x16_bf16 v[208:223], v[100:103], v[44:47], v[208:223]
    ds_read_b64_tr_b16 v[100:101], v30 offset:9312
    ds_read_b64_tr_b16 v[102:103], v30 offset:10464
    s_waitcnt lgkmcnt(10)
    v_mfma_f32_32x32x16_bf16 v[224:239], v[104:107], v[44:47], v[224:239]
    s_add_u32 s39, s21, 110976
    s_mov_b32 m0, s39
    s_mov_b64 exec, 0xffffffff
    buffer_load_dwordx4 v34, s[8:11], s20 offen lds
    s_mov_b64 exec, -1
    ds_read_b64_tr_b16 v[104:105], v30 offset:9344
    ds_read_b64_tr_b16 v[106:107], v30 offset:10496
    s_waitcnt lgkmcnt(10)
    v_mfma_f32_32x32x16_bf16 v[240:255], v[108:111], v[44:47], v[240:255]
    ds_read_b64_tr_b16 v[108:109], v30 offset:9376
    ds_read_b64_tr_b16 v[110:111], v30 offset:10528
    s_waitcnt lgkmcnt(10)
    v_mfma_f32_32x32x16_bf16 v[112:127], v[88:91], v[48:51], v[112:127]
    ds_read_b64_tr_b16 v[88:89], v30 offset:9408
    ds_read_b64_tr_b16 v[90:91], v30 offset:10560
    s_waitcnt lgkmcnt(10)
    v_mfma_f32_32x32x16_bf16 v[128:143], v[92:95], v[48:51], v[128:143]
    ds_read_b64_tr_b16 v[92:93], v30 offset:9440
    ds_read_b64_tr_b16 v[94:95], v30 offset:10592
    s_waitcnt lgkmcnt(10)
    v_mfma_f32_32x32x16_bf16 v[144:159], v[96:99], v[48:51], v[144:159]
    buffer_load_dwordx4 v35, s[8:11], s20 offen offset:512 lds
    ds_read_b64_tr_b16 v[96:97], v30 offset:9472
    ds_read_b64_tr_b16 v[98:99], v30 offset:10624
    s_waitcnt lgkmcnt(10)
    v_mfma_f32_32x32x16_bf16 v[160:175], v[100:103], v[48:51], v[160:175]
    ds_read_b64_tr_b16 v[100:101], v30 offset:13824
    ds_read_b64_tr_b16 v[102:103], v30 offset:14976
    s_waitcnt lgkmcnt(10)
    v_mfma_f32_32x32x16_bf16 v[176:191], v[104:107], v[48:51], v[176:191]
    ds_read_b64_tr_b16 v[104:105], v30 offset:13856
    ds_read_b64_tr_b16 v[106:107], v30 offset:15008
    s_waitcnt lgkmcnt(10)
    v_mfma_f32_32x32x16_bf16 v[192:207], v[108:111], v[48:51], v[192:207]
    buffer_load_dwordx4 v36, s[8:11], s20 offen offset:1536 lds
    ds_read_b64_tr_b16 v[108:109], v30 offset:13888
    ds_read_b64_tr_b16 v[110:111], v30 offset:15040
    s_waitcnt lgkmcnt(10)
    v_mfma_f32_32x32x16_bf16 v[208:223], v[88:91], v[48:51], v[208:223]
    ds_read_b64_tr_b16 v[88:89], v30 offset:13920
    ds_read_b64_tr_b16 v[90:91], v30 offset:15072
    s_waitcnt lgkmcnt(10)
    v_mfma_f32_32x32x16_bf16 v[224:239], v[92:95], v[48:51], v[224:239]
    ds_read_b64_tr_b16 v[92:93], v30 offset:13952
    ds_read_b64_tr_b16 v[94:95], v30 offset:15104
    s_waitcnt lgkmcnt(10)
    v_mfma_f32_32x32x16_bf16 v[240:255], v[96:99], v[48:51], v[240:255]
    ds_read_b64_tr_b16 v[96:97], v30 offset:13984
    ds_read_b64_tr_b16 v[98:99], v30 offset:15136
    s_waitcnt lgkmcnt(10)
    v_mfma_f32_32x32x16_bf16 v[112:127], v[100:103], v[52:55], v[112:127]
    buffer_load_dwordx4 v37, s[8:11], s20 offen offset:2560 lds
    ds_read_b64_tr_b16 v[100:101], v30 offset:14016
    ds_read_b64_tr_b16 v[102:103], v30 offset:15168
    s_waitcnt lgkmcnt(10)
    v_mfma_f32_32x32x16_bf16 v[128:143], v[104:107], v[52:55], v[128:143]
    ds_read_b64_tr_b16 v[104:105], v30 offset:14048
    ds_read_b64_tr_b16 v[106:107], v30 offset:15200
    s_waitcnt lgkmcnt(10)
    v_mfma_f32_32x32x16_bf16 v[144:159], v[108:111], v[52:55], v[144:159]
    ds_read_b64_tr_b16 v[108:109], v30 offset:14080
    ds_read_b64_tr_b16 v[110:111], v30 offset:15232
    s_waitcnt lgkmcnt(10)
    v_mfma_f32_32x32x16_bf16 v[160:175], v[88:91], v[52:55], v[160:175]
    ds_read_b64_tr_b16 v[88:89], v31 offset:0
    ds_read_b64_tr_b16 v[90:91], v31 offset:1152
    s_waitcnt lgkmcnt(10)
    v_mfma_f32_32x32x16_bf16 v[176:191], v[92:95], v[52:55], v[176:191]
    buffer_load_dwordx4 v38, s[8:11], s20 offen offset:3584 lds
    s_add_u32 s44, s44, 1
    s_cmp_eq_u32 s44, 9
    s_cselect_b32 s43, 0xffb80000, s52
    s_add_u32 s20, s20, s43
    ds_read_b64_tr_b16 v[92:93], v31 offset:32
    ds_read_b64_tr_b16 v[94:95], v31 offset:1184
    s_waitcnt lgkmcnt(10)
    v_mfma_f32_32x32x16_bf16 v[192:207], v[96:99], v[52:55], v[192:207]
    ds_read_b64_tr_b16 v[96:97], v31 offset:64
    ds_read_b64_tr_b16 v[98:99], v31 offset:1216
    s_waitcnt lgkmcnt(10)
    v_mfma_f32_32x32x16_bf16 v[208:223], v[100:103], v[52:55], v[208:223]
    ds_read_b64_tr_b16 v[100:101], v31 offset:96
    ds_read_b64_tr_b16 v[102:103], v31 offset:1248
    s_waitcnt lgkmcnt(10)
    v_mfma_f32_32x32x16_bf16 v[224:239], v[104:107], v[52:55], v[224:239]
    ds_read_b64_tr_b16 v[104:105], v31 offset:128
    ds_read_b64_tr_b16 v[106:107], v31 offset:1280
    s_waitcnt lgkmcnt(10)
    v_mfma_f32_32x32x16_bf16 v[240:255], v[108:111], v[52:55], v[240:255]
    s_waitcnt vmcnt(9)
    s_barrier
    ds_read_b64_tr_b16 v[108:109], v31 offset:160
    ds_read_b64_tr_b16 v[110:111], v31 offset:1312
    s_waitcnt lgkmcnt(10)
    v_mfma_f32_32x32x16_bf16 v[112:127], v[88:91], v[56:59], v[112:127]
    ds_read_b64_tr_b16 v[88:89], v31 offset:192
    ds_read_b64_tr_b16 v[90:91], v31 offset:1344
    s_waitcnt lgkmcnt(10)
    v_mfma_f32_32x32x16_bf16 v[128:143], v[92:95], v[56:59], v[128:143]
    buffer_load_dwordx4 v[40:43], v39, s[12:15], s22 offen offset:0 sc1
    ds_read_b64_tr_b16 v[92:93], v31 offset:224
    ds_read_b64_tr_b16 v[94:95], v31 offset:1376
    s_waitcnt lgkmcnt(10)
    v_mfma_f32_32x32x16_bf16 v[144:159], v[96:99], v[56:59], v[144:159]
    ds_read_b64_tr_b16 v[96:97], v31 offset:256
    ds_read_b64_tr_b16 v[98:99], v31 offset:1408
    s_waitcnt lgkmcnt(10)
    v_mfma_f32_32x32x16_bf16 v[160:175], v[100:103], v[56:59], v[160:175]
    ds_read_b64_tr_b16 v[100:101], v31 offset:4608
    ds_read_b64_tr_b16 v[102:103], v31 offset:5760
    s_waitcnt lgkmcnt(10)
    v_mfma_f32_32x32x16_bf16 v[176:191], v[104:107], v[56:59], v[176:191]
    buffer_load_dwordx4 v[44:47], v39, s[12:15], s22 offen offset:1024 sc1
    ds_read_b64_tr_b16 v[104:105], v31 offset:4640
    ds_read_b64_tr_b16 v[106:107], v31 offset:5792
    s_waitcnt lgkmcnt(10)
    v_mfma_f32_32x32x16_bf16 v[192:207], v[108:111], v[56:59], v[192:207]
    ds_read_b64_tr_b16 v[108:109], v31 offset:4672
    ds_read_b64_tr_b16 v[110:111], v31 offset:5824
    s_waitcnt lgkmcnt(10)
    v_mfma_f32_32x32x16_bf16 v[208:223], v[88:91], v[56:59], v[208:223]
    ds_read_b64_tr_b16 v[88:89], v31 offset:4704
    ds_read_b64_tr_b16 v[90:91], v31 offset:5856
    s_waitcnt lgkmcnt(10)
    v_mfma_f32_32x32x16_bf16 v[224:239], v[92:95], v[56:59], v[224:239]
    ds_read_b64_tr_b16 v[92:93], v31 offset:4736
    ds_read_b64_tr_b16 v[94:95], v31 offset:5888
    s_waitcnt lgkmcnt(10)
    v_mfma_f32_32x32x16_bf16 v[240:255], v[96:99], v[56:59], v[240:255]
    buffer_load_dwordx4 v[48:51], v39, s[12:15], s22 offen offset:2048 sc1
    ds_read_b64_tr_b16 v[96:97], v31 offset:4768
    ds_read_b64_tr_b16 v[98:99], v31 offset:5920
    s_waitcnt lgkmcnt(10)
    v_mfma_f32_32x32x16_bf16 v[112:127], v[100:103], v[60:63], v[112:127]
    ds_read_b64_tr_b16 v[100:101], v31 offset:4800
    ds_read_b64_tr_b16 v[102:103], v31 offset:5952
    s_waitcnt lgkmcnt(10)
    v_mfma_f32_32x32x16_bf16 v[128:143], v[104:107], v[60:63], v[128:143]
    ds_read_b64_tr_b16 v[104:105], v31 offset:4832
    ds_read_b64_tr_b16 v[106:107], v31 offset:5984
    s_waitcnt lgkmcnt(10)
    v_mfma_f32_32x32x16_bf16 v[144:159], v[108:111], v[60:63], v[144:159]
    ds_read_b64_tr_b16 v[108:109], v31 offset:4864
    ds_read_b64_tr_b16 v[110:111], v31 offset:6016
    s_waitcnt lgkmcnt(10)
    v_mfma_f32_32x32x16_bf16 v[160:175], v[88:91], v[60:63], v[160:175]
    buffer_load_dwordx4 v[52:55], v39, s[12:15], s22 offen offset:3072 sc1
    s_add_u32 s45, s45, 1
    s_cmp_eq_u32 s45, 9
    s_cselect_b32 s43, 0xffff8000, s53
    s_add_u32 s22, s22, s43
    ds_read_b64_tr_b16 v[88:89], v31 offset:9216
    ds_read_b64_tr_b16 v[90:91], v31 offset:10368
    s_waitcnt lgkmcnt(10)
    v_mfma_f32_32x32x16_bf16 v[176:191], v[92:95], v[60:63], v[176:191]
    ds_read_b64_tr_b16 v[92:93], v31 offset:9248
    ds_read_b64_tr_b16 v[94:95], v31 offset:10400
    s_waitcnt lgkmcnt(10)
    v_mfma_f32_32x32x16_bf16 v[192:207], v[96:99], v[60:63], v[192:207]
    ds_read_b64_tr_b16 v[96:97], v31 offset:9280
    ds_read_b64_tr_b16 v[98:99], v31 offset:10432
    s_waitcnt lgkmcnt(10)
    v_mfma_f32_32x32x16_bf16 v[208:223], v[100:103], v[60:63], v[208:223]
    ds_read_b64_tr_b16 v[100:101], v31 offset:9312
    ds_read_b64_tr_b16 v[102:103], v31 offset:10464
    s_waitcnt lgkmcnt(10)
    v_mfma_f32_32x32x16_bf16 v[224:239], v[104:107], v[60:63], v[224:239]
    s_add_u32 s39, s21, 0
    s_mov_b32 m0, s39
    s_mov_b64 exec, 0xffffffff
    buffer_load_dwordx4 v34, s[8:11], s20 offen lds
    s_mov_b64 exec, -1
    ds_read_b64_tr_b16 v[104:105], v31 offset:9344
    ds_read_b64_tr_b16 v[106:107], v31 offset:10496
    s_waitcnt lgkmcnt(10)
    v_mfma_f32_32x32x16_bf16 v[240:255], v[108:111], v[60:63], v[240:255]
    ds_read_b64_tr_b16 v[108:109], v31 offset:9376
    ds_read_b64_tr_b16 v[110:111], v31 offset:10528
    s_waitcnt lgkmcnt(10)
    v_mfma_f32_32x32x16_bf16 v[112:127], v[88:91], v[64:67], v[112:127]
    ds_read_b64_tr_b16 v[88:89], v31 offset:9408
    ds_read_b64_tr_b16 v[90:91], v31 offset:10560
    s_waitcnt lgkmcnt(10)
    v_mfma_f32_32x32x16_bf16 v[128:143], v[92:95], v[64:67], v[128:143]
    ds_read_b64_tr_b16 v[92:93], v31 offset:9440
    ds_read_b64_tr_b16 v[94:95], v31 offset:10592
    s_waitcnt lgkmcnt(10)
    v_mfma_f32_32x32x16_bf16 v[144:159], v[96:99], v[64:67], v[144:159]
    buffer_load_dwordx4 v35, s[8:11], s20 offen offset:512 lds
    ds_read_b64_tr_b16 v[96:97], v31 offset:9472
    ds_read_b64_tr_b16 v[98:99], v31 offset:10624
    s_waitcnt lgkmcnt(10)
    v_mfma_f32_32x32x16_bf16 v[160:175], v[100:103], v[64:67], v[160:175]
    ds_read_b64_tr_b16 v[100:101], v31 offset:13824
    ds_read_b64_tr_b16 v[102:103], v31 offset:14976
    s_waitcnt lgkmcnt(10)
    v_mfma_f32_32x32x16_bf16 v[176:191], v[104:107], v[64:67], v[176:191]
    ds_read_b64_tr_b16 v[104:105], v31 offset:13856
    ds_read_b64_tr_b16 v[106:107], v31 offset:15008
    s_waitcnt lgkmcnt(10)
    v_mfma_f32_32x32x16_bf16 v[192:207], v[108:111], v[64:67], v[192:207]
    buffer_load_dwordx4 v36, s[8:11], s20 offen offset:1536 lds
    ds_read_b64_tr_b16 v[108:109], v31 offset:13888
    ds_read_b64_tr_b16 v[110:111], v31 offset:15040
    s_waitcnt lgkmcnt(10)
    v_mfma_f32_32x32x16_bf16 v[208:223], v[88:91], v[64:67], v[208:223]
    ds_read_b64_tr_b16 v[88:89], v31 offset:13920
    ds_read_b64_tr_b16 v[90:91], v31 offset:15072
    s_waitcnt lgkmcnt(10)
    v_mfma_f32_32x32x16_bf16 v[224:239], v[92:95], v[64:67], v[224:239]
    ds_read_b64_tr_b16 v[92:93], v31 offset:13952
    ds_read_b64_tr_b16 v[94:95], v31 offset:15104
    s_waitcnt lgkmcnt(10)
    v_mfma_f32_32x32x16_bf16 v[240:255], v[96:99], v[64:67], v[240:255]
    ds_read_b64_tr_b16 v[96:97], v31 offset:13984
    ds_read_b64_tr_b16 v[98:99], v31 offset:15136
    s_waitcnt lgkmcnt(10)
    v_mfma_f32_32x32x16_bf16 v[112:127], v[100:103], v[68:71], v[112:127]
    buffer_load_dwordx4 v37, s[8:11], s20 offen offset:2560 lds
    ds_read_b64_tr_b16 v[100:101], v31 offset:14016
    ds_read_b64_tr_b16 v[102:103], v31 offset:15168
    s_waitcnt lgkmcnt(10)
    v_mfma_f32_32x32x16_bf16 v[128:143], v[104:107], v[68:71], v[128:143]
    ds_read_b64_tr_b16 v[104:105], v31 offset:14048
    ds_read_b64_tr_b16 v[106:107], v31 offset:15200
    s_waitcnt lgkmcnt(10)
    v_mfma_f32_32x32x16_bf16 v[144:159], v[108:111], v[68:71], v[144:159]
    ds_read_b64_tr_b16 v[108:109], v31 offset:14080
    ds_read_b64_tr_b16 v[110:111], v31 offset:15232
    s_waitcnt lgkmcnt(10)
    v_mfma_f32_32x32x16_bf16 v[160:175], v[88:91], v[68:71], v[160:175]
    ds_read_b64_tr_b16 v[88:89], v32 offset:0
    ds_read_b64_tr_b16 v[90:91], v32 offset:1152
    s_waitcnt lgkmcnt(10)
    v_mfma_f32_32x32x16_bf16 v[176:191], v[92:95], v[68:71], v[176:191]
    buffer_load_dwordx4 v38, s[8:11], s20 offen offset:3584 lds
    s_add_u32 s44, s44, 1
    s_cmp_eq_u32 s44, 9
    s_cselect_b32 s43, 0xffb80000, s52
    s_add_u32 s20, s20, s43
    ds_read_b64_tr_b16 v[92:93], v32 offset:32
    ds_read_b64_tr_b16 v[94:95], v32 offset:1184
    s_waitcnt lgkmcnt(10)
    v_mfma_f32_32x32x16_bf16 v[192:207], v[96:99], v[68:71], v[192:207]
    ds_read_b64_tr_b16 v[96:97], v32 offset:64
    ds_read_b64_tr_b16 v[98:99], v32 offset:1216
    s_waitcnt lgkmcnt(10)
    v_mfma_f32_32x32x16_bf16 v[208:223], v[100:103], v[68:71], v[208:223]
    ds_read_b64_tr_b16 v[100:101], v32 offset:96
    ds_read_b64_tr_b16 v[102:103], v32 offset:1248
    s_waitcnt lgkmcnt(10)
    v_mfma_f32_32x32x16_bf16 v[224:239], v[104:107], v[68:71], v[224:239]
    ds_read_b64_tr_b16 v[104:105], v32 offset:128
    ds_read_b64_tr_b16 v[106:107], v32 offset:1280
    s_waitcnt lgkmcnt(10)
    v_mfma_f32_32x32x16_bf16 v[240:255], v[108:111], v[68:71], v[240:255]
    s_waitcnt vmcnt(9)
    s_barrier
    ds_read_b64_tr_b16 v[108:109], v32 offset:160
    ds_read_b64_tr_b16 v[110:111], v32 offset:1312
    s_waitcnt lgkmcnt(10)
    v_mfma_f32_32x32x16_bf16 v[112:127], v[88:91], v[72:75], v[112:127]
    ds_read_b64_tr_b16 v[88:89], v32 offset:192
    ds_read_b64_tr_b16 v[90:91], v32 offset:1344
    s_waitcnt lgkmcnt(10)
    v_mfma_f32_32x32x16_bf16 v[128:143], v[92:95], v[72:75], v[128:143]
    buffer_load_dwordx4 v[56:59], v39, s[12:15], s22 offen offset:0 sc1
    ds_read_b64_tr_b16 v[92:93], v32 offset:224
    ds_read_b64_tr_b16 v[94:95], v32 offset:1376
    s_waitcnt lgkmcnt(10)
    v_mfma_f32_32x32x16_bf16 v[144:159], v[96:99], v[72:75], v[144:159]
    ds_read_b64_tr_b16 v[96:97], v32 offset:256
    ds_read_b64_tr_b16 v[98:99], v32 offset:1408
    s_waitcnt lgkmcnt(10)
    v_mfma_f32_32x32x16_bf16 v[160:175], v[100:103], v[72:75], v[160:175]
    ds_read_b64_tr_b16 v[100:101], v32 offset:4608
    ds_read_b64_tr_b16 v[102:103], v32 offset:5760
    s_waitcnt lgkmcnt(10)
    v_mfma_f32_32x32x16_bf16 v[176:191], v[104:107], v[72:75], v[176:191]
    buffer_load_dwordx4 v[60:63], v39, s[12:15], s22 offen offset:1024 sc1
    ds_read_b64_tr_b16 v[104:105], v32 offset:4640
    ds_read_b64_tr_b16 v[106:107], v32 offset:5792
    s_waitcnt lgkmcnt(10)
    v_mfma_f32_32x32x16_bf16 v[192:207], v[108:111], v[72:75], v[192:207]
    ds_read_b64_tr_b16 v[108:109], v32 offset:4672
    ds_read_b64_tr_b16 v[110:111], v32 offset:5824
    s_waitcnt lgkmcnt(10)
    v_mfma_f32_32x32x16_bf16 v[208:223], v[88:91], v[72:75], v[208:223]
    ds_read_b64_tr_b16 v[88:89], v32 offset:4704
    ds_read_b64_tr_b16 v[90:91], v32 offset:5856
    s_waitcnt lgkmcnt(10)
    v_mfma_f32_32x32x16_bf16 v[224:239], v[92:95], v[72:75], v[224:239]
    ds_read_b64_tr_b16 v[92:93], v32 offset:4736
    ds_read_b64_tr_b16 v[94:95], v32 offset:5888
    s_waitcnt lgkmcnt(10)
    v_mfma_f32_32x32x16_bf16 v[240:255], v[96:99], v[72:75], v[240:255]
    buffer_load_dwordx4 v[64:67], v39, s[12:15], s22 offen offset:2048 sc1
    ds_read_b64_tr_b16 v[96:97], v32 offset:4768
    ds_read_b64_tr_b16 v[98:99], v32 offset:5920
    s_waitcnt lgkmcnt(10)
    v_mfma_f32_32x32x16_bf16 v[112:127], v[100:103], v[76:79], v[112:127]
    ds_read_b64_tr_b16 v[100:101], v32 offset:4800
    ds_read_b64_tr_b16 v[102:103], v32 offset:5952
    s_waitcnt lgkmcnt(10)
    v_mfma_f32_32x32x16_bf16 v[128:143], v[104:107], v[76:79], v[128:143]
    ds_read_b64_tr_b16 v[104:105], v32 offset:4832
    ds_read_b64_tr_b16 v[106:107], v32 offset:5984
    s_waitcnt lgkmcnt(10)
    v_mfma_f32_32x32x16_bf16 v[144:159], v[108:111], v[76:79], v[144:159]
    ds_read_b64_tr_b16 v[108:109], v32 offset:4864
    ds_read_b64_tr_b16 v[110:111], v32 offset:6016
    s_waitcnt lgkmcnt(10)
    v_mfma_f32_32x32x16_bf16 v[160:175], v[88:91], v[76:79], v[160:175]
    buffer_load_dwordx4 v[68:71], v39, s[12:15], s22 offen offset:3072 sc1
    s_add_u32 s45, s45, 1
    s_cmp_eq_u32 s45, 9
    s_cselect_b32 s43, 0xffff8000, s53
    s_add_u32 s22, s22, s43
    ds_read_b64_tr_b16 v[88:89], v32 offset:9216
    ds_read_b64_tr_b16 v[90:91], v32 offset:10368
    s_waitcnt lgkmcnt(10)
    v_mfma_f32_32x32x16_bf16 v[176:191], v[92:95], v[76:79], v[176:191]
    ds_read_b64_tr_b16 v[92:93], v32 offset:9248
    ds_read_b64_tr_b16 v[94:95], v32 offset:10400
    s_waitcnt lgkmcnt(10)
    v_mfma_f32_32x32x16_bf16 v[192:207], v[96:99], v[76:79], v[192:207]
    ds_read_b64_tr_b16 v[96:97], v32 offset:9280
    ds_read_b64_tr_b16 v[98:99], v32 offset:10432
    s_waitcnt lgkmcnt(10)
    v_mfma_f32_32x32x16_bf16 v[208:223], v[100:103], v[76:79], v[208:223]
    ds_read_b64_tr_b16 v[100:101], v32 offset:9312
    ds_read_b64_tr_b16 v[102:103], v32 offset:10464
    s_waitcnt lgkmcnt(10)
    v_mfma_f32_32x32x16_bf16 v[224:239], v[104:107], v[76:79], v[224:239]
    s_add_u32 s39, s21, 36992
    s_mov_b32 m0, s39
    s_mov_b64 exec, 0xffffffff
    buffer_load_dwordx4 v34, s[8:11], s20 offen lds
    s_mov_b64 exec, -1
    ds_read_b64_tr_b16 v[104:105], v32 offset:9344
    ds_read_b64_tr_b16 v[106:107], v32 offset:10496
    s_waitcnt lgkmcnt(10)
    v_mfma_f32_32x32x16_bf16 v[240:255], v[108:111], v[76:79], v[240:255]
    ds_read_b64_tr_b16 v[108:109], v32 offset:9376
    ds_read_b64_tr_b16 v[110:111], v32 offset:10528
    s_waitcnt lgkmcnt(10)
    v_mfma_f32_32x32x16_bf16 v[112:127], v[88:91], v[80:83], v[112:127]
    ds_read_b64_tr_b16 v[88:89], v32 offset:9408
    ds_read_b64_tr_b16 v[90:91], v32 offset:10560
    s_waitcnt lgkmcnt(10)
    v_mfma_f32_32x32x16_bf16 v[128:143], v[92:95], v[80:83], v[128:143]
    ds_read_b64_tr_b16 v[92:93], v32 offset:9440
    ds_read_b64_tr_b16 v[94:95], v32 offset:10592
    s_waitcnt lgkmcnt(10)
    v_mfma_f32_32x32x16_bf16 v[144:159], v[96:99], v[80:83], v[144:159]
    buffer_load_dwordx4 v35, s[8:11], s20 offen offset:512 lds
    ds_read_b64_tr_b16 v[96:97], v32 offset:9472
    ds_read_b64_tr_b16 v[98:99], v32 offset:10624
    s_waitcnt lgkmcnt(10)
    v_mfma_f32_32x32x16_bf16 v[160:175], v[100:103], v[80:83], v[160:175]
    ds_read_b64_tr_b16 v[100:101], v32 offset:13824
    ds_read_b64_tr_b16 v[102:103], v32 offset:14976
    s_waitcnt lgkmcnt(10)
    v_mfma_f32_32x32x16_bf16 v[176:191], v[104:107], v[80:83], v[176:191]
    ds_read_b64_tr_b16 v[104:105], v32 offset:13856
    ds_read_b64_tr_b16 v[106:107], v32 offset:15008
    s_waitcnt lgkmcnt(10)
    v_mfma_f32_32x32x16_bf16 v[192:207], v[108:111], v[80:83], v[192:207]
    buffer_load_dwordx4 v36, s[8:11], s20 offen offset:1536 lds
    ds_read_b64_tr_b16 v[108:109], v32 offset:13888
    ds_read_b64_tr_b16 v[110:111], v32 offset:15040
    s_waitcnt lgkmcnt(10)
    v_mfma_f32_32x32x16_bf16 v[208:223], v[88:91], v[80:83], v[208:223]
    ds_read_b64_tr_b16 v[88:89], v32 offset:13920
    ds_read_b64_tr_b16 v[90:91], v32 offset:15072
    s_waitcnt lgkmcnt(10)
    v_mfma_f32_32x32x16_bf16 v[224:239], v[92:95], v[80:83], v[224:239]
    ds_read_b64_tr_b16 v[92:93], v32 offset:13952
    ds_read_b64_tr_b16 v[94:95], v32 offset:15104
    s_waitcnt lgkmcnt(10)
    v_mfma_f32_32x32x16_bf16 v[240:255], v[96:99], v[80:83], v[240:255]
    ds_read_b64_tr_b16 v[96:97], v32 offset:13984
    ds_read_b64_tr_b16 v[98:99], v32 offset:15136
    s_waitcnt lgkmcnt(10)
    v_mfma_f32_32x32x16_bf16 v[112:127], v[100:103], v[84:87], v[112:127]
    buffer_load_dwordx4 v37, s[8:11], s20 offen offset:2560 lds
    ds_read_b64_tr_b16 v[100:101], v32 offset:14016
    ds_read_b64_tr_b16 v[102:103], v32 offset:15168
    s_waitcnt lgkmcnt(10)
    v_mfma_f32_32x32x16_bf16 v[128:143], v[104:107], v[84:87], v[128:143]
    ds_read_b64_tr_b16 v[104:105], v32 offset:14048
    ds_read_b64_tr_b16 v[106:107], v32 offset:15200
    s_waitcnt lgkmcnt(10)
    v_mfma_f32_32x32x16_bf16 v[144:159], v[108:111], v[84:87], v[144:159]
    ds_read_b64_tr_b16 v[108:109], v32 offset:14080
    ds_read_b64_tr_b16 v[110:111], v32 offset:15232
    s_waitcnt lgkmcnt(10)
    v_mfma_f32_32x32x16_bf16 v[160:175], v[88:91], v[84:87], v[160:175]
    ds_read_b64_tr_b16 v[88:89], v33 offset:0
    ds_read_b64_tr_b16 v[90:91], v33 offset:1152
    s_waitcnt lgkmcnt(10)
    v_mfma_f32_32x32x16_bf16 v[176:191], v[92:95], v[84:87], v[176:191]
    buffer_load_dwordx4 v38, s[8:11], s20 offen offset:3584 lds
    s_add_u32 s44, s44, 1
    s_cmp_eq_u32 s44, 9
    s_cselect_b32 s43, 0xffb80000, s52
    s_add_u32 s20, s20, s43
    ds_read_b64_tr_b16 v[92:93], v33 offset:32
    ds_read_b64_tr_b16 v[94:95], v33 offset:1184
    s_waitcnt lgkmcnt(10)
    v_mfma_f32_32x32x16_bf16 v[192:207], v[96:99], v[84:87], v[192:207]
    ds_read_b64_tr_b16 v[96:97], v33 offset:64
    ds_read_b64_tr_b16 v[98:99], v33 offset:1216
    s_waitcnt lgkmcnt(10)
    v_mfma_f32_32x32x16_bf16 v[208:223], v[100:103], v[84:87], v[208:223]
    ds_read_b64_tr_b16 v[100:101], v33 offset:96
    ds_read_b64_tr_b16 v[102:103], v33 offset:1248
    s_waitcnt lgkmcnt(10)
    v_mfma_f32_32x32x16_bf16 v[224:239], v[104:107], v[84:87], v[224:239]
    ds_read_b64_tr_b16 v[104:105], v33 offset:128
    ds_read_b64_tr_b16 v[106:107], v33 offset:1280
    s_waitcnt lgkmcnt(10)
    v_mfma_f32_32x32x16_bf16 v[240:255], v[108:111], v[84:87], v[240:255]
    s_waitcnt vmcnt(9)
    s_barrier
    ds_read_b64_tr_b16 v[108:109], v33 offset:160
    ds_read_b64_tr_b16 v[110:111], v33 offset:1312
    s_waitcnt lgkmcnt(10)
    v_mfma_f32_32x32x16_bf16 v[112:127], v[88:91], v[40:43], v[112:127]
    ds_read_b64_tr_b16 v[88:89], v33 offset:192
    ds_read_b64_tr_b16 v[90:91], v33 offset:1344
    s_waitcnt lgkmcnt(10)
    v_mfma_f32_32x32x16_bf16 v[128:143], v[92:95], v[40:43], v[128:143]
    buffer_load_dwordx4 v[72:75], v39, s[12:15], s22 offen offset:0 sc1
    ds_read_b64_tr_b16 v[92:93], v33 offset:224
    ds_read_b64_tr_b16 v[94:95], v33 offset:1376
    s_waitcnt lgkmcnt(10)
    v_mfma_f32_32x32x16_bf16 v[144:159], v[96:99], v[40:43], v[144:159]
    ds_read_b64_tr_b16 v[96:97], v33 offset:256
    ds_read_b64_tr_b16 v[98:99], v33 offset:1408
    s_waitcnt lgkmcnt(10)
    v_mfma_f32_32x32x16_bf16 v[160:175], v[100:103], v[40:43], v[160:175]
    ds_read_b64_tr_b16 v[100:101], v33 offset:4608
    ds_read_b64_tr_b16 v[102:103], v33 offset:5760
    s_waitcnt lgkmcnt(10)
    v_mfma_f32_32x32x16_bf16 v[176:191], v[104:107], v[40:43], v[176:191]
    buffer_load_dwordx4 v[76:79], v39, s[12:15], s22 offen offset:1024 sc1
    ds_read_b64_tr_b16 v[104:105], v33 offset:4640
    ds_read_b64_tr_b16 v[106:107], v33 offset:5792
    s_waitcnt lgkmcnt(10)
    v_mfma_f32_32x32x16_bf16 v[192:207], v[108:111], v[40:43], v[192:207]
    ds_read_b64_tr_b16 v[108:109], v33 offset:4672
    ds_read_b64_tr_b16 v[110:111], v33 offset:5824
    s_waitcnt lgkmcnt(10)
    v_mfma_f32_32x32x16_bf16 v[208:223], v[88:91], v[40:43], v[208:223]
    ds_read_b64_tr_b16 v[88:89], v33 offset:4704
    ds_read_b64_tr_b16 v[90:91], v33 offset:5856
    s_waitcnt lgkmcnt(10)
    v_mfma_f32_32x32x16_bf16 v[224:239], v[92:95], v[40:43], v[224:239]
    ds_read_b64_tr_b16 v[92:93], v33 offset:4736
    ds_read_b64_tr_b16 v[94:95], v33 offset:5888
    s_waitcnt lgkmcnt(10)
    v_mfma_f32_32x32x16_bf16 v[240:255], v[96:99], v[40:43], v[240:255]
    buffer_load_dwordx4 v[80:83], v39, s[12:15], s22 offen offset:2048 sc1
    ds_read_b64_tr_b16 v[96:97], v33 offset:4768
    ds_read_b64_tr_b16 v[98:99], v33 offset:5920
    s_waitcnt lgkmcnt(10)
    v_mfma_f32_32x32x16_bf16 v[112:127], v[100:103], v[44:47], v[112:127]
    ds_read_b64_tr_b16 v[100:101], v33 offset:4800
    ds_read_b64_tr_b16 v[102:103], v33 offset:5952
    s_waitcnt lgkmcnt(10)
    v_mfma_f32_32x32x16_bf16 v[128:143], v[104:107], v[44:47], v[128:143]
    ds_read_b64_tr_b16 v[104:105], v33 offset:4832
    ds_read_b64_tr_b16 v[106:107], v33 offset:5984
    s_waitcnt lgkmcnt(10)
    v_mfma_f32_32x32x16_bf16 v[144:159], v[108:111], v[44:47], v[144:159]
    ds_read_b64_tr_b16 v[108:109], v33 offset:4864
    ds_read_b64_tr_b16 v[110:111], v33 offset:6016
    s_waitcnt lgkmcnt(10)
    v_mfma_f32_32x32x16_bf16 v[160:175], v[88:91], v[44:47], v[160:175]
    buffer_load_dwordx4 v[84:87], v39, s[12:15], s22 offen offset:3072 sc1
    s_add_u32 s45, s45, 1
    s_cmp_eq_u32 s45, 9
    s_cselect_b32 s43, 0xffff8000, s53
    s_add_u32 s22, s22, s43
    ds_read_b64_tr_b16 v[88:89], v33 offset:9216
    ds_read_b64_tr_b16 v[90:91], v33 offset:10368
    s_waitcnt lgkmcnt(10)
    v_mfma_f32_32x32x16_bf16 v[176:191], v[92:95], v[44:47], v[176:191]
    ds_read_b64_tr_b16 v[92:93], v33 offset:9248
    ds_read_b64_tr_b16 v[94:95], v33 offset:10400
    s_waitcnt lgkmcnt(10)
    v_mfma_f32_32x32x16_bf16 v[192:207], v[96:99], v[44:47], v[192:207]
    ds_read_b64_tr_b16 v[96:97], v33 offset:9280
    ds_read_b64_tr_b16 v[98:99], v33 offset:10432
    s_waitcnt lgkmcnt(10)
    v_mfma_f32_32x32x16_bf16 v[208:223], v[100:103], v[44:47], v[208:223]
    ds_read_b64_tr_b16 v[100:101], v33 offset:9312
    ds_read_b64_tr_b16 v[102:103], v33 offset:10464
    s_waitcnt lgkmcnt(10)
    v_mfma_f32_32x32x16_bf16 v[224:239], v[104:107], v[44:47], v[224:239]
    s_add_u32 s39, s21, 73984
    s_mov_b32 m0, s39
    s_mov_b64 exec, 0xffffffff
    buffer_load_dwordx4 v34, s[8:11], s20 offen lds
    s_mov_b64 exec, -1
    ds_read_b64_tr_b16 v[104:105], v33 offset:9344
    ds_read_b64_tr_b16 v[106:107], v33 offset:10496
    s_waitcnt lgkmcnt(10)
    v_mfma_f32_32x32x16_bf16 v[240:255], v[108:111], v[44:47], v[240:255]
    ds_read_b64_tr_b16 v[108:109], v33 offset:9376
    ds_read_b64_tr_b16 v[110:111], v33 offset:10528
    s_waitcnt lgkmcnt(10)
    v_mfma_f32_32x32x16_bf16 v[112:127], v[88:91], v[48:51], v[112:127]
    ds_read_b64_tr_b16 v[88:89], v33 offset:9408
    ds_read_b64_tr_b16 v[90:91], v33 offset:10560
    s_waitcnt lgkmcnt(10)
    v_mfma_f32_32x32x16_bf16 v[128:143], v[92:95], v[48:51], v[128:143]
    ds_read_b64_tr_b16 v[92:93], v33 offset:9440
    ds_read_b64_tr_b16 v[94:95], v33 offset:10592
    s_waitcnt lgkmcnt(10)
    v_mfma_f32_32x32x16_bf16 v[144:159], v[96:99], v[48:51], v[144:159]
    buffer_load_dwordx4 v35, s[8:11], s20 offen offset:512 lds
    ds_read_b64_tr_b16 v[96:97], v33 offset:9472
    ds_read_b64_tr_b16 v[98:99], v33 offset:10624
    s_waitcnt lgkmcnt(10)
    v_mfma_f32_32x32x16_bf16 v[160:175], v[100:103], v[48:51], v[160:175]
    ds_read_b64_tr_b16 v[100:101], v33 offset:13824
    ds_read_b64_tr_b16 v[102:103], v33 offset:14976
    s_waitcnt lgkmcnt(10)
    v_mfma_f32_32x32x16_bf16 v[176:191], v[104:107], v[48:51], v[176:191]
    ds_read_b64_tr_b16 v[104:105], v33 offset:13856
    ds_read_b64_tr_b16 v[106:107], v33 offset:15008
    s_waitcnt lgkmcnt(10)
    v_mfma_f32_32x32x16_bf16 v[192:207], v[108:111], v[48:51], v[192:207]
    buffer_load_dwordx4 v36, s[8:11], s20 offen offset:1536 lds
    ds_read_b64_tr_b16 v[108:109], v33 offset:13888
    ds_read_b64_tr_b16 v[110:111], v33 offset:15040
    s_waitcnt lgkmcnt(10)
    v_mfma_f32_32x32x16_bf16 v[208:223], v[88:91], v[48:51], v[208:223]
    ds_read_b64_tr_b16 v[88:89], v33 offset:13920
    ds_read_b64_tr_b16 v[90:91], v33 offset:15072
    s_waitcnt lgkmcnt(10)
    v_mfma_f32_32x32x16_bf16 v[224:239], v[92:95], v[48:51], v[224:239]
    ds_read_b64_tr_b16 v[92:93], v33 offset:13952
    ds_read_b64_tr_b16 v[94:95], v33 offset:15104
    s_waitcnt lgkmcnt(10)
    v_mfma_f32_32x32x16_bf16 v[240:255], v[96:99], v[48:51], v[240:255]
    ds_read_b64_tr_b16 v[96:97], v33 offset:13984
    ds_read_b64_tr_b16 v[98:99], v33 offset:15136
    s_waitcnt lgkmcnt(10)
    v_mfma_f32_32x32x16_bf16 v[112:127], v[100:103], v[52:55], v[112:127]
    buffer_load_dwordx4 v37, s[8:11], s20 offen offset:2560 lds
    ds_read_b64_tr_b16 v[100:101], v33 offset:14016
    ds_read_b64_tr_b16 v[102:103], v33 offset:15168
    s_waitcnt lgkmcnt(10)
    v_mfma_f32_32x32x16_bf16 v[128:143], v[104:107], v[52:55], v[128:143]
    ds_read_b64_tr_b16 v[104:105], v33 offset:14048
    ds_read_b64_tr_b16 v[106:107], v33 offset:15200
    s_waitcnt lgkmcnt(10)
    v_mfma_f32_32x32x16_bf16 v[144:159], v[108:111], v[52:55], v[144:159]
    ds_read_b64_tr_b16 v[108:109], v33 offset:14080
    ds_read_b64_tr_b16 v[110:111], v33 offset:15232
    s_waitcnt lgkmcnt(10)
    v_mfma_f32_32x32x16_bf16 v[160:175], v[88:91], v[52:55], v[160:175]
    ds_read_b64_tr_b16 v[88:89], v30 offset:0
    ds_read_b64_tr_b16 v[90:91], v30 offset:1152
    s_waitcnt lgkmcnt(10)
    v_mfma_f32_32x32x16_bf16 v[176:191], v[92:95], v[52:55], v[176:191]
    buffer_load_dwordx4 v38, s[8:11], s20 offen offset:3584 lds
    s_add_u32 s44, s44, 1
    s_cmp_eq_u32 s44, 9
    s_cselect_b32 s43, 0xffb80000, s52
    s_add_u32 s20, s20, s43
    ds_read_b64_tr_b16 v[92:93], v30 offset:32
    ds_read_b64_tr_b16 v[94:95], v30 offset:1184
    s_waitcnt lgkmcnt(10)
    v_mfma_f32_32x32x16_bf16 v[192:207], v[96:99], v[52:55], v[192:207]
    ds_read_b64_tr_b16 v[96:97], v30 offset:64
    ds_read_b64_tr_b16 v[98:99], v30 offset:1216
    s_waitcnt lgkmcnt(10)
    v_mfma_f32_32x32x16_bf16 v[208:223], v[100:103], v[52:55], v[208:223]
    ds_read_b64_tr_b16 v[100:101], v30 offset:96
    ds_read_b64_tr_b16 v[102:103], v30 offset:1248
    s_waitcnt lgkmcnt(10)
    v_mfma_f32_32x32x16_bf16 v[224:239], v[104:107], v[52:55], v[224:239]
    ds_read_b64_tr_b16 v[104:105], v30 offset:128
    ds_read_b64_tr_b16 v[106:107], v30 offset:1280
    s_waitcnt lgkmcnt(10)
    v_mfma_f32_32x32x16_bf16 v[240:255], v[108:111], v[52:55], v[240:255]
    s_waitcnt vmcnt(9)
    s_barrier
    ds_read_b64_tr_b16 v[108:109], v30 offset:160
    ds_read_b64_tr_b16 v[110:111], v30 offset:1312
    s_waitcnt lgkmcnt(10)
    v_mfma_f32_32x32x16_bf16 v[112:127], v[88:91], v[56:59], v[112:127]
    ds_read_b64_tr_b16 v[88:89], v30 offset:192
    ds_read_b64_tr_b16 v[90:91], v30 offset:1344
    s_waitcnt lgkmcnt(10)
    v_mfma_f32_32x32x16_bf16 v[128:143], v[92:95], v[56:59], v[128:143]
    buffer_load_dwordx4 v[40:43], v39, s[12:15], s22 offen offset:0 sc1
    ds_read_b64_tr_b16 v[92:93], v30 offset:224
    ds_read_b64_tr_b16 v[94:95], v30 offset:1376
    s_waitcnt lgkmcnt(10)
    v_mfma_f32_32x32x16_bf16 v[144:159], v[96:99], v[56:59], v[144:159]
    ds_read_b64_tr_b16 v[96:97], v30 offset:256
    ds_read_b64_tr_b16 v[98:99], v30 offset:1408
    s_waitcnt lgkmcnt(10)
    v_mfma_f32_32x32x16_bf16 v[160:175], v[100:103], v[56:59], v[160:175]
    ds_read_b64_tr_b16 v[100:101], v30 offset:4608
    ds_read_b64_tr_b16 v[102:103], v30 offset:5760
    s_waitcnt lgkmcnt(10)
    v_mfma_f32_32x32x16_bf16 v[176:191], v[104:107], v[56:59], v[176:191]
    buffer_load_dwordx4 v[44:47], v39, s[12:15], s22 offen offset:1024 sc1
    ds_read_b64_tr_b16 v[104:105], v30 offset:4640
    ds_read_b64_tr_b16 v[106:107], v30 offset:5792
    s_waitcnt lgkmcnt(10)
    v_mfma_f32_32x32x16_bf16 v[192:207], v[108:111], v[56:59], v[192:207]
    ds_read_b64_tr_b16 v[108:109], v30 offset:4672
    ds_read_b64_tr_b16 v[110:111], v30 offset:5824
    s_waitcnt lgkmcnt(10)
    v_mfma_f32_32x32x16_bf16 v[208:223], v[88:91], v[56:59], v[208:223]
    ds_read_b64_tr_b16 v[88:89], v30 offset:4704
    ds_read_b64_tr_b16 v[90:91], v30 offset:5856
    s_waitcnt lgkmcnt(10)
    v_mfma_f32_32x32x16_bf16 v[224:239], v[92:95], v[56:59], v[224:239]
    ds_read_b64_tr_b16 v[92:93], v30 offset:4736
    ds_read_b64_tr_b16 v[94:95], v30 offset:5888
    s_waitcnt lgkmcnt(10)
    v_mfma_f32_32x32x16_bf16 v[240:255], v[96:99], v[56:59], v[240:255]
    buffer_load_dwordx4 v[48:51], v39, s[12:15], s22 offen offset:2048 sc1
    ds_read_b64_tr_b16 v[96:97], v30 offset:4768
    ds_read_b64_tr_b16 v[98:99], v30 offset:5920
    s_waitcnt lgkmcnt(10)
    v_mfma_f32_32x32x16_bf16 v[112:127], v[100:103], v[60:63], v[112:127]
    ds_read_b64_tr_b16 v[100:101], v30 offset:4800
    ds_read_b64_tr_b16 v[102:103], v30 offset:5952
    s_waitcnt lgkmcnt(10)
    v_mfma_f32_32x32x16_bf16 v[128:143], v[104:107], v[60:63], v[128:143]
    ds_read_b64_tr_b16 v[104:105], v30 offset:4832
    ds_read_b64_tr_b16 v[106:107], v30 offset:5984
    s_waitcnt lgkmcnt(10)
    v_mfma_f32_32x32x16_bf16 v[144:159], v[108:111], v[60:63], v[144:159]
    ds_read_b64_tr_b16 v[108:109], v30 offset:4864
    ds_read_b64_tr_b16 v[110:111], v30 offset:6016
    s_waitcnt lgkmcnt(10)
    v_mfma_f32_32x32x16_bf16 v[160:175], v[88:91], v[60:63], v[160:175]
    buffer_load_dwordx4 v[52:55], v39, s[12:15], s22 offen offset:3072 sc1
    s_add_u32 s45, s45, 1
    s_cmp_eq_u32 s45, 9
    s_cselect_b32 s43, 0xffff8000, s53
    s_add_u32 s22, s22, s43
    ds_read_b64_tr_b16 v[88:89], v30 offset:9216
    ds_read_b64_tr_b16 v[90:91], v30 offset:10368
    s_waitcnt lgkmcnt(10)
    v_mfma_f32_32x32x16_bf16 v[176:191], v[92:95], v[60:63], v[176:191]
    ds_read_b64_tr_b16 v[92:93], v30 offset:9248
    ds_read_b64_tr_b16 v[94:95], v30 offset:10400
    s_waitcnt lgkmcnt(10)
    v_mfma_f32_32x32x16_bf16 v[192:207], v[96:99], v[60:63], v[192:207]
    ds_read_b64_tr_b16 v[96:97], v30 offset:9280
    ds_read_b64_tr_b16 v[98:99], v30 offset:10432
    s_waitcnt lgkmcnt(10)
    v_mfma_f32_32x32x16_bf16 v[208:223], v[100:103], v[60:63], v[208:223]
    ds_read_b64_tr_b16 v[100:101], v30 offset:9312
    ds_read_b64_tr_b16 v[102:103], v30 offset:10464
    s_waitcnt lgkmcnt(10)
    v_mfma_f32_32x32x16_bf16 v[224:239], v[104:107], v[60:63], v[224:239]
    s_add_u32 s39, s21, 110976
    s_mov_b32 m0, s39
    s_mov_b64 exec, 0xffffffff
    buffer_load_dwordx4 v34, s[8:11], s20 offen lds
    s_mov_b64 exec, -1
    ds_read_b64_tr_b16 v[104:105], v30 offset:9344
    ds_read_b64_tr_b16 v[106:107], v30 offset:10496
    s_waitcnt lgkmcnt(10)
    v_mfma_f32_32x32x16_bf16 v[240:255], v[108:111], v[60:63], v[240:255]
    ds_read_b64_tr_b16 v[108:109], v30 offset:9376
    ds_read_b64_tr_b16 v[110:111], v30 offset:10528
    s_waitcnt lgkmcnt(10)
    v_mfma_f32_32x32x16_bf16 v[112:127], v[88:91], v[64:67], v[112:127]
    ds_read_b64_tr_b16 v[88:89], v30 offset:9408
    ds_read_b64_tr_b16 v[90:91], v30 offset:10560
    s_waitcnt lgkmcnt(10)
    v_mfma_f32_32x32x16_bf16 v[128:143], v[92:95], v[64:67], v[128:143]
    ds_read_b64_tr_b16 v[92:93], v30 offset:9440
    ds_read_b64_tr_b16 v[94:95], v30 offset:10592
    s_waitcnt lgkmcnt(10)
    v_mfma_f32_32x32x16_bf16 v[144:159], v[96:99], v[64:67], v[144:159]
    buffer_load_dwordx4 v35, s[8:11], s20 offen offset:512 lds
    ds_read_b64_tr_b16 v[96:97], v30 offset:9472
    ds_read_b64_tr_b16 v[98:99], v30 offset:10624
    s_waitcnt lgkmcnt(10)
    v_mfma_f32_32x32x16_bf16 v[160:175], v[100:103], v[64:67], v[160:175]
    ds_read_b64_tr_b16 v[100:101], v30 offset:13824
    ds_read_b64_tr_b16 v[102:103], v30 offset:14976
    s_waitcnt lgkmcnt(10)
    v_mfma_f32_32x32x16_bf16 v[176:191], v[104:107], v[64:67], v[176:191]
    ds_read_b64_tr_b16 v[104:105], v30 offset:13856
    ds_read_b64_tr_b16 v[106:107], v30 offset:15008
    s_waitcnt lgkmcnt(10)
    v_mfma_f32_32x32x16_bf16 v[192:207], v[108:111], v[64:67], v[192:207]
    buffer_load_dwordx4 v36, s[8:11], s20 offen offset:1536 lds
    ds_read_b64_tr_b16 v[108:109], v30 offset:13888
    ds_read_b64_tr_b16 v[110:111], v30 offset:15040
    s_waitcnt lgkmcnt(10)
    v_mfma_f32_32x32x16_bf16 v[208:223], v[88:91], v[64:67], v[208:223]
    ds_read_b64_tr_b16 v[88:89], v30 offset:13920
    ds_read_b64_tr_b16 v[90:91], v30 offset:15072
    s_waitcnt lgkmcnt(10)
    v_mfma_f32_32x32x16_bf16 v[224:239], v[92:95], v[64:67], v[224:239]
    ds_read_b64_tr_b16 v[92:93], v30 offset:13952
    ds_read_b64_tr_b16 v[94:95], v30 offset:15104
    s_waitcnt lgkmcnt(10)
    v_mfma_f32_32x32x16_bf16 v[240:255], v[96:99], v[64:67], v[240:255]
    ds_read_b64_tr_b16 v[96:97], v30 offset:13984
    ds_read_b64_tr_b16 v[98:99], v30 offset:15136
    s_waitcnt lgkmcnt(10)
    v_mfma_f32_32x32x16_bf16 v[112:127], v[100:103], v[68:71], v[112:127]
    buffer_load_dwordx4 v37, s[8:11], s20 offen offset:2560 lds
    ds_read_b64_tr_b16 v[100:101], v30 offset:14016
    ds_read_b64_tr_b16 v[102:103], v30 offset:15168
    s_waitcnt lgkmcnt(10)
    v_mfma_f32_32x32x16_bf16 v[128:143], v[104:107], v[68:71], v[128:143]
    ds_read_b64_tr_b16 v[104:105], v30 offset:14048
    ds_read_b64_tr_b16 v[106:107], v30 offset:15200
    s_waitcnt lgkmcnt(10)
    v_mfma_f32_32x32x16_bf16 v[144:159], v[108:111], v[68:71], v[144:159]
    ds_read_b64_tr_b16 v[108:109], v30 offset:14080
    ds_read_b64_tr_b16 v[110:111], v30 offset:15232
    s_waitcnt lgkmcnt(10)
    v_mfma_f32_32x32x16_bf16 v[160:175], v[88:91], v[68:71], v[160:175]
    ds_read_b64_tr_b16 v[88:89], v31 offset:0
    ds_read_b64_tr_b16 v[90:91], v31 offset:1152
    s_waitcnt lgkmcnt(10)
    v_mfma_f32_32x32x16_bf16 v[176:191], v[92:95], v[68:71], v[176:191]
    buffer_load_dwordx4 v38, s[8:11], s20 offen offset:3584 lds
    s_add_u32 s44, s44, 1
    s_cmp_eq_u32 s44, 9
    s_cselect_b32 s43, 0xffb80000, s52
    s_add_u32 s20, s20, s43
    ds_read_b64_tr_b16 v[92:93], v31 offset:32
    ds_read_b64_tr_b16 v[94:95], v31 offset:1184
    s_waitcnt lgkmcnt(10)
    v_mfma_f32_32x32x16_bf16 v[192:207], v[96:99], v[68:71], v[192:207]
    ds_read_b64_tr_b16 v[96:97], v31 offset:64
    ds_read_b64_tr_b16 v[98:99], v31 offset:1216
    s_waitcnt lgkmcnt(10)
    v_mfma_f32_32x32x16_bf16 v[208:223], v[100:103], v[68:71], v[208:223]
    ds_read_b64_tr_b16 v[100:101], v31 offset:96
    ds_read_b64_tr_b16 v[102:103], v31 offset:1248
    s_waitcnt lgkmcnt(10)
    v_mfma_f32_32x32x16_bf16 v[224:239], v[104:107], v[68:71], v[224:239]
    ds_read_b64_tr_b16 v[104:105], v31 offset:128
    ds_read_b64_tr_b16 v[106:107], v31 offset:1280
    s_waitcnt lgkmcnt(10)
    v_mfma_f32_32x32x16_bf16 v[240:255], v[108:111], v[68:71], v[240:255]
    s_waitcnt vmcnt(9)
    s_barrier
    ds_read_b64_tr_b16 v[108:109], v31 offset:160
    ds_read_b64_tr_b16 v[110:111], v31 offset:1312
    s_waitcnt lgkmcnt(10)
    v_mfma_f32_32x32x16_bf16 v[112:127], v[88:91], v[72:75], v[112:127]
    s_add_u32 s39, s21, 0
    s_mov_b32 m0, s39
    s_mov_b64 exec, 0xffffffff
    buffer_load_dwordx4 v34, s[8:11], s20 offen lds
    s_mov_b64 exec, -1
    ds_read_b64_tr_b16 v[88:89], v31 offset:192
    ds_read_b64_tr_b16 v[90:91], v31 offset:1344
    s_waitcnt lgkmcnt(10)
    v_mfma_f32_32x32x16_bf16 v[128:143], v[92:95], v[72:75], v[128:143]
    ds_read_b64_tr_b16 v[92:93], v31 offset:224
    ds_read_b64_tr_b16 v[94:95], v31 offset:1376
    s_waitcnt lgkmcnt(10)
    v_mfma_f32_32x32x16_bf16 v[144:159], v[96:99], v[72:75], v[144:159]
    ds_read_b64_tr_b16 v[96:97], v31 offset:256
    ds_read_b64_tr_b16 v[98:99], v31 offset:1408
    s_waitcnt lgkmcnt(10)
    v_mfma_f32_32x32x16_bf16 v[160:175], v[100:103], v[72:75], v[160:175]
    buffer_load_dwordx4 v35, s[8:11], s20 offen offset:512 lds
    ds_read_b64_tr_b16 v[100:101], v31 offset:4608
    ds_read_b64_tr_b16 v[102:103], v31 offset:5760
    s_waitcnt lgkmcnt(10)
    v_mfma_f32_32x32x16_bf16 v[176:191], v[104:107], v[72:75], v[176:191]
    ds_read_b64_tr_b16 v[104:105], v31 offset:4640
    ds_read_b64_tr_b16 v[106:107], v31 offset:5792
    s_waitcnt lgkmcnt(10)
    v_mfma_f32_32x32x16_bf16 v[192:207], v[108:111], v[72:75], v[192:207]
    ds_read_b64_tr_b16 v[108:109], v31 offset:4672
    ds_read_b64_tr_b16 v[110:111], v31 offset:5824
    s_waitcnt lgkmcnt(10)
    v_mfma_f32_32x32x16_bf16 v[208:223], v[88:91], v[72:75], v[208:223]
    buffer_load_dwordx4 v36, s[8:11], s20 offen offset:1536 lds
    ds_read_b64_tr_b16 v[88:89], v31 offset:4704
    ds_read_b64_tr_b16 v[90:91], v31 offset:5856
    s_waitcnt lgkmcnt(10)
    v_mfma_f32_32x32x16_bf16 v[224:239], v[92:95], v[72:75], v[224:239]
    ds_read_b64_tr_b16 v[92:93], v31 offset:4736
    ds_read_b64_tr_b16 v[94:95], v31 offset:5888
    s_waitcnt lgkmcnt(10)
    v_mfma_f32_32x32x16_bf16 v[240:255], v[96:99], v[72:75], v[240:255]
    buffer_load_dwordx4 v37, s[8:11], s20 offen offset:2560 lds
    ds_read_b64_tr_b16 v[96:97], v31 offset:4768
    ds_read_b64_tr_b16 v[98:99], v31 offset:5920
    s_waitcnt lgkmcnt(10)
    v_mfma_f32_32x32x16_bf16 v[112:127], v[100:103], v[76:79], v[112:127]
    ds_read_b64_tr_b16 v[100:101], v31 offset:4800
    ds_read_b64_tr_b16 v[102:103], v31 offset:5952
    s_waitcnt lgkmcnt(10)
    v_mfma_f32_32x32x16_bf16 v[128:143], v[104:107], v[76:79], v[128:143]
    ds_read_b64_tr_b16 v[104:105], v31 offset:4832
    ds_read_b64_tr_b16 v[106:107], v31 offset:5984
    s_waitcnt lgkmcnt(10)
    v_mfma_f32_32x32x16_bf16 v[144:159], v[108:111], v[76:79], v[144:159]
    buffer_load_dwordx4 v38, s[8:11], s20 offen offset:3584 lds
    s_add_u32 s44, s44, 1
    s_cmp_eq_u32 s44, 9
    s_cselect_b32 s43, 0xffb80000, s52
    s_add_u32 s20, s20, s43
    ds_read_b64_tr_b16 v[108:109], v31 offset:4864
    ds_read_b64_tr_b16 v[110:111], v31 offset:6016
    s_waitcnt lgkmcnt(10)
    v_mfma_f32_32x32x16_bf16 v[160:175], v[88:91], v[76:79], v[160:175]
    ds_read_b64_tr_b16 v[88:89], v31 offset:9216
    ds_read_b64_tr_b16 v[90:91], v31 offset:10368
    s_waitcnt lgkmcnt(10)
    v_mfma_f32_32x32x16_bf16 v[176:191], v[92:95], v[76:79], v[176:191]
    buffer_load_dwordx4 v[56:59], v39, s[12:15], s22 offen offset:0 sc1
    ds_read_b64_tr_b16 v[92:93], v31 offset:9248
    ds_read_b64_tr_b16 v[94:95], v31 offset:10400
    s_waitcnt lgkmcnt(10)
    v_mfma_f32_32x32x16_bf16 v[192:207], v[96:99], v[76:79], v[192:207]
    ds_read_b64_tr_b16 v[96:97], v31 offset:9280
    ds_read_b64_tr_b16 v[98:99], v31 offset:10432
    s_waitcnt lgkmcnt(10)
    v_mfma_f32_32x32x16_bf16 v[208:223], v[100:103], v[76:79], v[208:223]
    ds_read_b64_tr_b16 v[100:101], v31 offset:9312
    ds_read_b64_tr_b16 v[102:103], v31 offset:10464
    s_waitcnt lgkmcnt(10)
    v_mfma_f32_32x32x16_bf16 v[224:239], v[104:107], v[76:79], v[224:239]
    buffer_load_dwordx4 v[60:63], v39, s[12:15], s22 offen offset:1024 sc1
    ds_read_b64_tr_b16 v[104:105], v31 offset:9344
    ds_read_b64_tr_b16 v[106:107], v31 offset:10496
    s_waitcnt lgkmcnt(10)
    v_mfma_f32_32x32x16_bf16 v[240:255], v[108:111], v[76:79], v[240:255]
    ds_read_b64_tr_b16 v[108:109], v31 offset:9376
    ds_read_b64_tr_b16 v[110:111], v31 offset:10528
    s_waitcnt lgkmcnt(10)
    v_mfma_f32_32x32x16_bf16 v[112:127], v[88:91], v[80:83], v[112:127]
    ds_read_b64_tr_b16 v[88:89], v31 offset:9408
    ds_read_b64_tr_b16 v[90:91], v31 offset:10560
    s_waitcnt lgkmcnt(10)
    v_mfma_f32_32x32x16_bf16 v[128:143], v[92:95], v[80:83], v[128:143]
    buffer_load_dwordx4 v[64:67], v39, s[12:15], s22 offen offset:2048 sc1
    ds_read_b64_tr_b16 v[92:93], v31 offset:9440
    ds_read_b64_tr_b16 v[94:95], v31 offset:10592
    s_waitcnt lgkmcnt(10)
    v_mfma_f32_32x32x16_bf16 v[144:159], v[96:99], v[80:83], v[144:159]
    ds_read_b64_tr_b16 v[96:97], v31 offset:9472
    ds_read_b64_tr_b16 v[98:99], v31 offset:10624
    s_waitcnt lgkmcnt(10)
    v_mfma_f32_32x32x16_bf16 v[160:175], v[100:103], v[80:83], v[160:175]
    buffer_load_dwordx4 v[68:71], v39, s[12:15], s22 offen offset:3072 sc1
    s_add_u32 s45, s45, 1
    s_cmp_eq_u32 s45, 9
    s_cselect_b32 s43, 0xffff8000, s53
    s_add_u32 s22, s22, s43
    ds_read_b64_tr_b16 v[100:101], v31 offset:13824
    ds_read_b64_tr_b16 v[102:103], v31 offset:14976
    s_waitcnt lgkmcnt(10)
    v_mfma_f32_32x32x16_bf16 v[176:191], v[104:107], v[80:83], v[176:191]
    ds_read_b64_tr_b16 v[104:105], v31 offset:13856
    ds_read_b64_tr_b16 v[106:107], v31 offset:15008
    s_waitcnt lgkmcnt(10)
    v_mfma_f32_32x32x16_bf16 v[192:207], v[108:111], v[80:83], v[192:207]
    ds_read_b64_tr_b16 v[108:109], v31 offset:13888
    ds_read_b64_tr_b16 v[110:111], v31 offset:15040
    s_waitcnt lgkmcnt(10)
    v_mfma_f32_32x32x16_bf16 v[208:223], v[88:91], v[80:83], v[208:223]
    buffer_load_dwordx4 v[12:15], v39, s[12:15], s22 offen offset:0 sc1
    ds_read_b64_tr_b16 v[88:89], v31 offset:13920
    ds_read_b64_tr_b16 v[90:91], v31 offset:15072
    s_waitcnt lgkmcnt(10)
    v_mfma_f32_32x32x16_bf16 v[224:239], v[92:95], v[80:83], v[224:239]
    ds_read_b64_tr_b16 v[92:93], v31 offset:13952
    ds_read_b64_tr_b16 v[94:95], v31 offset:15104
    s_waitcnt lgkmcnt(10)
    v_mfma_f32_32x32x16_bf16 v[240:255], v[96:99], v[80:83], v[240:255]
    buffer_load_dwordx4 v[16:19], v39, s[12:15], s22 offen offset:1024 sc1
    ds_read_b64_tr_b16 v[96:97], v31 offset:13984
    ds_read_b64_tr_b16 v[98:99], v31 offset:15136
    s_waitcnt lgkmcnt(10)
    v_mfma_f32_32x32x16_bf16 v[112:127], v[100:103], v[84:87], v[112:127]
    ds_read_b64_tr_b16 v[100:101], v31 offset:14016
    ds_read_b64_tr_b16 v[102:103], v31 offset:15168
    s_waitcnt lgkmcnt(10)
    v_mfma_f32_32x32x16_bf16 v[128:143], v[104:107], v[84:87], v[128:143]
    ds_read_b64_tr_b16 v[104:105], v31 offset:14048
    ds_read_b64_tr_b16 v[106:107], v31 offset:15200
    s_waitcnt lgkmcnt(10)
    v_mfma_f32_32x32x16_bf16 v[144:159], v[108:111], v[84:87], v[144:159]
    buffer_load_dwordx4 v[20:23], v39, s[12:15], s22 offen offset:2048 sc1
    ds_read_b64_tr_b16 v[108:109], v31 offset:14080
    ds_read_b64_tr_b16 v[110:111], v31 offset:15232
    s_waitcnt lgkmcnt(10)
    v_mfma_f32_32x32x16_bf16 v[160:175], v[88:91], v[84:87], v[160:175]
    ds_read_b64_tr_b16 v[88:89], v32 offset:0
    ds_read_b64_tr_b16 v[90:91], v32 offset:1152
    s_waitcnt lgkmcnt(10)
    v_mfma_f32_32x32x16_bf16 v[176:191], v[92:95], v[84:87], v[176:191]
    ds_read_b64_tr_b16 v[92:93], v32 offset:4608
    ds_read_b64_tr_b16 v[94:95], v32 offset:5760
    s_waitcnt lgkmcnt(10)
    v_mfma_f32_32x32x16_bf16 v[192:207], v[96:99], v[84:87], v[192:207]
    buffer_load_dwordx4 v[24:27], v39, s[12:15], s22 offen offset:3072 sc1
    s_add_u32 s45, s45, 1
    s_cmp_eq_u32 s45, 9
    s_cselect_b32 s43, 0xffff8000, s53
    s_add_u32 s22, s22, s43
    ds_read_b64_tr_b16 v[96:97], v32 offset:9216
    ds_read_b64_tr_b16 v[98:99], v32 offset:10368
    s_waitcnt lgkmcnt(10)
    v_mfma_f32_32x32x16_bf16 v[208:223], v[100:103], v[84:87], v[208:223]
    ds_read_b64_tr_b16 v[100:101], v32 offset:13824
    ds_read_b64_tr_b16 v[102:103], v32 offset:14976
    s_waitcnt lgkmcnt(10)
    v_mfma_f32_32x32x16_bf16 v[224:239], v[104:107], v[84:87], v[224:239]
    s_waitcnt lgkmcnt(8)
    v_mfma_f32_32x32x16_bf16 v[240:255], v[108:111], v[84:87], v[240:255]
    s_waitcnt vmcnt(0)
    s_barrier
    s_lshr_b32 s30, s26, 1
    s_mul_i32 s30, s30, 1327104
    s_mul_i32 s31, s27, 41472
    s_add_u32 s30, s30, s31
    v_lshlrev_b32 v5, 4, v0
    s_mov_b32 s54, 0xbfb8aa3b
    s_mov_b32 s55, 0xbfb8aa3b
    s_mov_b32 s56, 1.0
    s_mov_b32 s57, 1.0
    v_bfe_u32 v3, v1, 4, 1
    s_mov_b32 s31, 147456
    v_mul_lo_u32 v3, v3, s31
    v_lshrrev_b32 v4, 5, v1
    v_lshl_add_u32 v3, v4, 8, v3
    v_and_b32 v4, 15, v1
    v_lshl_add_u32 v3, v4, 4, v3
    s_mul_i32 s22, s33, 294912
    s_mul_i32 s31, s28, 4608
    s_add_u32 s22, s22, s31
    s_add_u32 s23, s22, 4096

    s_mov_b32 s48, s46
    s_mov_b32 s49, s47
    s_mov_b32 s50, 0x510000
    s_mov_b32 s51, 0x20000
    buffer_load_dwordx4 v[8:11], v5, s[48:51], s30 offen
    s_add_u32 s30, s30, 8192
    buffer_load_dwordx4 v[8:11], v5, s[48:51], s30 offen
    s_add_u32 s30, s30, 8192
    buffer_load_dwordx4 v[8:11], v5, s[48:51], s30 offen
    s_add_u32 s30, s30, 8192
    buffer_load_dwordx4 v[8:11], v5, s[48:51], s30 offen
    s_add_u32 s30, s30, 8192
    buffer_load_dwordx4 v[8:11], v5, s[48:51], s30 offen
    ds_read_b64_tr_b16 v[104:105], v33 offset:0
    ds_read_b64_tr_b16 v[106:107], v33 offset:1152
    ds_read_b64_tr_b16 v[108:109], v33 offset:4608
    ds_read_b64_tr_b16 v[110:111], v33 offset:5760
    s_waitcnt lgkmcnt(10)
    v_mfma_f32_32x32x16_bf16 v[112:127], v[88:91], v[40:43], v[112:127]
    ds_read_b64_tr_b16 v[88:89], v33 offset:9216
    ds_read_b64_tr_b16 v[90:91], v33 offset:10368
    s_waitcnt lgkmcnt(10)
    v_mfma_f32_32x32x16_bf16 v[112:127], v[92:95], v[44:47], v[112:127]
    ds_read_b64_tr_b16 v[92:93], v33 offset:13824
    ds_read_b64_tr_b16 v[94:95], v33 offset:14976
    s_waitcnt lgkmcnt(10)
    v_mfma_f32_32x32x16_bf16 v[112:127], v[96:99], v[48:51], v[112:127]
    ds_read_b64_tr_b16 v[96:97], v30 offset:0
    ds_read_b64_tr_b16 v[98:99], v30 offset:1152
    s_waitcnt lgkmcnt(10)
    v_mfma_f32_32x32x16_bf16 v[112:127], v[100:103], v[52:55], v[112:127]
    ds_read_b64_tr_b16 v[100:101], v30 offset:4608
    ds_read_b64_tr_b16 v[102:103], v30 offset:5760
    s_waitcnt lgkmcnt(10)
    v_mfma_f32_32x32x16_bf16 v[112:127], v[104:107], v[56:59], v[112:127]
    ds_read_b64_tr_b16 v[104:105], v30 offset:9216
    ds_read_b64_tr_b16 v[106:107], v30 offset:10368
    s_waitcnt lgkmcnt(10)
    v_mfma_f32_32x32x16_bf16 v[112:127], v[108:111], v[60:63], v[112:127]
    ds_read_b64_tr_b16 v[108:109], v30 offset:13824
    ds_read_b64_tr_b16 v[110:111], v30 offset:14976
    s_waitcnt lgkmcnt(10)
    v_mfma_f32_32x32x16_bf16 v[112:127], v[88:91], v[64:67], v[112:127]
    ds_read_b64_tr_b16 v[88:89], v32 offset:32
    ds_read_b64_tr_b16 v[90:91], v32 offset:1184
    s_waitcnt lgkmcnt(10)
    v_mfma_f32_32x32x16_bf16 v[112:127], v[92:95], v[68:71], v[112:127]
    ds_read_b64_tr_b16 v[92:93], v32 offset:4640
    ds_read_b64_tr_b16 v[94:95], v32 offset:5792
    s_waitcnt lgkmcnt(10)
    v_mfma_f32_32x32x16_bf16 v[112:127], v[96:99], v[12:15], v[112:127]
    ds_read_b64_tr_b16 v[96:97], v32 offset:9248
    ds_read_b64_tr_b16 v[98:99], v32 offset:10400
    s_waitcnt lgkmcnt(10)
    v_mfma_f32_32x32x16_bf16 v[112:127], v[100:103], v[16:19], v[112:127]
    ds_read_b64_tr_b16 v[100:101], v32 offset:13856
    ds_read_b64_tr_b16 v[102:103], v32 offset:15008
    s_waitcnt lgkmcnt(10)
    v_mfma_f32_32x32x16_bf16 v[112:127], v[104:107], v[20:23], v[112:127]
    ds_read_b64_tr_b16 v[104:105], v33 offset:32
    ds_read_b64_tr_b16 v[106:107], v33 offset:1184
    s_waitcnt lgkmcnt(10)
    v_mfma_f32_32x32x16_bf16 v[112:127], v[108:111], v[24:27], v[112:127]
    ds_read_b64_tr_b16 v[108:109], v33 offset:4640
    ds_read_b64_tr_b16 v[110:111], v33 offset:5792
    s_waitcnt lgkmcnt(10)
    v_mfma_f32_32x32x16_bf16 v[128:143], v[88:91], v[40:43], v[128:143]
    ds_read_b64_tr_b16 v[88:89], v33 offset:9248
    ds_read_b64_tr_b16 v[90:91], v33 offset:10400
    s_waitcnt lgkmcnt(10)
    v_mfma_f32_32x32x16_bf16 v[128:143], v[92:95], v[44:47], v[128:143]
    ds_read_b64_tr_b16 v[92:93], v33 offset:13856
    ds_read_b64_tr_b16 v[94:95], v33 offset:15008
    s_waitcnt lgkmcnt(10)
    v_mfma_f32_32x32x16_bf16 v[128:143], v[96:99], v[48:51], v[128:143]
    ds_read_b64_tr_b16 v[96:97], v30 offset:32
    ds_read_b64_tr_b16 v[98:99], v30 offset:1184
    s_waitcnt lgkmcnt(10)
    v_mfma_f32_32x32x16_bf16 v[128:143], v[100:103], v[52:55], v[128:143]
    v_cvt_pk_bf16_f32 v72, v112, v113
    v_cvt_pk_bf16_f32 v73, v114, v115
    v_cvt_pk_bf16_f32 v74, v116, v117
    v_cvt_pk_bf16_f32 v75, v118, v119
    v_cvt_pk_bf16_f32 v76, v120, v121
    v_cvt_pk_bf16_f32 v77, v122, v123
    v_cvt_pk_bf16_f32 v78, v124, v125
    v_cvt_pk_bf16_f32 v79, v126, v127
    ds_read_b64_tr_b16 v[100:101], v30 offset:4640
    ds_read_b64_tr_b16 v[102:103], v30 offset:5792
    s_waitcnt lgkmcnt(10)
    v_mfma_f32_32x32x16_bf16 v[128:143], v[104:107], v[56:59], v[128:143]
    v_lshlrev_b32 v112, 16, v72
    v_and_b32 v113, 0xffff0000, v72
    v_lshlrev_b32 v114, 16, v73
    v_and_b32 v115, 0xffff0000, v73
    v_lshlrev_b32 v116, 16, v74
    v_and_b32 v117, 0xffff0000, v74
    v_lshlrev_b32 v118, 16, v75
    v_and_b32 v119, 0xffff0000, v75
    ds_read_b64_tr_b16 v[104:105], v30 offset:9248
    ds_read_b64_tr_b16 v[106:107], v30 offset:10400
    s_waitcnt lgkmcnt(10)
    v_mfma_f32_32x32x16_bf16 v[128:143], v[108:111], v[60:63], v[128:143]
    v_lshlrev_b32 v120, 16, v76
    v_and_b32 v121, 0xffff0000, v76
    v_lshlrev_b32 v122, 16, v77
    v_and_b32 v123, 0xffff0000, v77
    v_lshlrev_b32 v124, 16, v78
    v_and_b32 v125, 0xffff0000, v78
    v_lshlrev_b32 v126, 16, v79
    v_and_b32 v127, 0xffff0000, v79
    ds_read_b64_tr_b16 v[108:109], v30 offset:13856
    ds_read_b64_tr_b16 v[110:111], v30 offset:15008
    s_waitcnt lgkmcnt(10)
    v_mfma_f32_32x32x16_bf16 v[128:143], v[88:91], v[64:67], v[128:143]
    v_mul_f32 v72, s54, v112
    v_mul_f32 v73, s54, v113
    v_mul_f32 v74, s54, v114
    v_mul_f32 v75, s54, v115
    v_mul_f32 v76, s54, v116
    v_mul_f32 v77, s54, v117
    v_mul_f32 v78, s54, v118
    v_mul_f32 v79, s54, v119
    ds_read_b64_tr_b16 v[88:89], v32 offset:64
    ds_read_b64_tr_b16 v[90:91], v32 offset:1216
    s_waitcnt lgkmcnt(10)
    v_mfma_f32_32x32x16_bf16 v[128:143], v[92:95], v[68:71], v[128:143]
    v_exp_f32 v72, v72
    v_exp_f32 v73, v73
    v_exp_f32 v74, v74
    v_exp_f32 v75, v75
    v_exp_f32 v76, v76
    v_exp_f32 v77, v77
    v_exp_f32 v78, v78
    v_exp_f32 v79, v79
    ds_read_b64_tr_b16 v[92:93], v32 offset:4672
    ds_read_b64_tr_b16 v[94:95], v32 offset:5824
    s_waitcnt lgkmcnt(10)
    v_mfma_f32_32x32x16_bf16 v[128:143], v[96:99], v[12:15], v[128:143]
    v_add_f32 v72, 1.0, v72
    v_add_f32 v73, 1.0, v73
    v_add_f32 v74, 1.0, v74
    v_add_f32 v75, 1.0, v75
    v_add_f32 v76, 1.0, v76
    v_add_f32 v77, 1.0, v77
    v_add_f32 v78, 1.0, v78
    v_add_f32 v79, 1.0, v79
    ds_read_b64_tr_b16 v[96:97], v32 offset:9280
    ds_read_b64_tr_b16 v[98:99], v32 offset:10432
    s_waitcnt lgkmcnt(10)
    v_mfma_f32_32x32x16_bf16 v[128:143], v[100:103], v[16:19], v[128:143]
    v_rcp_f32 v72, v72
    v_rcp_f32 v73, v73
    v_rcp_f32 v74, v74
    v_rcp_f32 v75, v75
    v_rcp_f32 v76, v76
    v_rcp_f32 v77, v77
    v_rcp_f32 v78, v78
    v_rcp_f32 v79, v79
    ds_read_b64_tr_b16 v[100:101], v32 offset:13888
    ds_read_b64_tr_b16 v[102:103], v32 offset:15040
    s_waitcnt lgkmcnt(10)
    v_mfma_f32_32x32x16_bf16 v[128:143], v[104:107], v[20:23], v[128:143]
    v_mul_f32 v112, v112, v72
    v_mul_f32 v113, v113, v73
    v_mul_f32 v114, v114, v74
    v_mul_f32 v115, v115, v75
    v_mul_f32 v116, v116, v76
    v_mul_f32 v117, v117, v77
    v_mul_f32 v118, v118, v78
    v_mul_f32 v119, v119, v79
    ds_read_b64_tr_b16 v[104:105], v33 offset:64
    ds_read_b64_tr_b16 v[106:107], v33 offset:1216
    s_waitcnt lgkmcnt(10)
    v_mfma_f32_32x32x16_bf16 v[128:143], v[108:111], v[24:27], v[128:143]
    v_cvt_pk_bf16_f32 v72, v112, v113
    v_cvt_pk_bf16_f32 v73, v114, v115
    v_cvt_pk_bf16_f32 v74, v116, v117
    v_cvt_pk_bf16_f32 v75, v118, v119
    v_lshlrev_b32 v112, 16, v72
    v_and_b32 v113, 0xffff0000, v72
    v_lshlrev_b32 v114, 16, v73
    v_and_b32 v115, 0xffff0000, v73
    ds_read_b64_tr_b16 v[108:109], v33 offset:4672
    ds_read_b64_tr_b16 v[110:111], v33 offset:5824
    s_waitcnt lgkmcnt(10)
    v_mfma_f32_32x32x16_bf16 v[144:159], v[88:91], v[40:43], v[144:159]
    v_lshlrev_b32 v116, 16, v74
    v_and_b32 v117, 0xffff0000, v74
    v_lshlrev_b32 v118, 16, v75
    v_and_b32 v119, 0xffff0000, v75
    v_mul_f32 v112, v112, v120
    v_mul_f32 v113, v113, v121
    v_mul_f32 v114, v114, v122
    v_mul_f32 v115, v115, v123
    ds_read_b64_tr_b16 v[88:89], v33 offset:9280
    ds_read_b64_tr_b16 v[90:91], v33 offset:10432
    s_waitcnt lgkmcnt(10)
    v_mfma_f32_32x32x16_bf16 v[144:159], v[92:95], v[44:47], v[144:159]
    v_mul_f32 v116, v116, v124
    v_mul_f32 v117, v117, v125
    v_mul_f32 v118, v118, v126
    v_mul_f32 v119, v119, v127
    v_cvt_pk_bf16_f32 v80, v112, v113
    v_cvt_pk_bf16_f32 v81, v114, v115
    v_cvt_pk_bf16_f32 v82, v116, v117
    v_cvt_pk_bf16_f32 v83, v118, v119
    ds_read_b64_tr_b16 v[92:93], v33 offset:13888
    ds_read_b64_tr_b16 v[94:95], v33 offset:15040
    s_waitcnt lgkmcnt(10)
    v_mfma_f32_32x32x16_bf16 v[144:159], v[96:99], v[48:51], v[144:159]
    buffer_store_dwordx4 v[80:83], v3, s[16:19], s22 offen offset:0 sc1
    ds_read_b64_tr_b16 v[96:97], v30 offset:64
    ds_read_b64_tr_b16 v[98:99], v30 offset:1216
    s_waitcnt lgkmcnt(10)
    v_mfma_f32_32x32x16_bf16 v[144:159], v[100:103], v[52:55], v[144:159]
    v_cvt_pk_bf16_f32 v72, v128, v129
    v_cvt_pk_bf16_f32 v73, v130, v131
    v_cvt_pk_bf16_f32 v74, v132, v133
    v_cvt_pk_bf16_f32 v75, v134, v135
    v_cvt_pk_bf16_f32 v76, v136, v137
    v_cvt_pk_bf16_f32 v77, v138, v139
    v_cvt_pk_bf16_f32 v78, v140, v141
    v_cvt_pk_bf16_f32 v79, v142, v143
    ds_read_b64_tr_b16 v[100:101], v30 offset:4672
    ds_read_b64_tr_b16 v[102:103], v30 offset:5824
    s_waitcnt lgkmcnt(10)
    v_mfma_f32_32x32x16_bf16 v[144:159], v[104:107], v[56:59], v[144:159]
    v_lshlrev_b32 v128, 16, v72
    v_and_b32 v129, 0xffff0000, v72
    v_lshlrev_b32 v130, 16, v73
    v_and_b32 v131, 0xffff0000, v73
    v_lshlrev_b32 v132, 16, v74
    v_and_b32 v133, 0xffff0000, v74
    v_lshlrev_b32 v134, 16, v75
    v_and_b32 v135, 0xffff0000, v75
    ds_read_b64_tr_b16 v[104:105], v30 offset:9280
    ds_read_b64_tr_b16 v[106:107], v30 offset:10432
    s_waitcnt lgkmcnt(10)
    v_mfma_f32_32x32x16_bf16 v[144:159], v[108:111], v[60:63], v[144:159]
    v_lshlrev_b32 v136, 16, v76
    v_and_b32 v137, 0xffff0000, v76
    v_lshlrev_b32 v138, 16, v77
    v_and_b32 v139, 0xffff0000, v77
    v_lshlrev_b32 v140, 16, v78
    v_and_b32 v141, 0xffff0000, v78
    v_lshlrev_b32 v142, 16, v79
    v_and_b32 v143, 0xffff0000, v79
    ds_read_b64_tr_b16 v[108:109], v30 offset:13888
    ds_read_b64_tr_b16 v[110:111], v30 offset:15040
    s_waitcnt lgkmcnt(10)
    v_mfma_f32_32x32x16_bf16 v[144:159], v[88:91], v[64:67], v[144:159]
    v_mul_f32 v72, s54, v128
    v_mul_f32 v73, s54, v129
    v_mul_f32 v74, s54, v130
    v_mul_f32 v75, s54, v131
    v_mul_f32 v76, s54, v132
    v_mul_f32 v77, s54, v133
    v_mul_f32 v78, s54, v134
    v_mul_f32 v79, s54, v135
    ds_read_b64_tr_b16 v[88:89], v32 offset:96
    ds_read_b64_tr_b16 v[90:91], v32 offset:1248
    s_waitcnt lgkmcnt(10)
    v_mfma_f32_32x32x16_bf16 v[144:159], v[92:95], v[68:71], v[144:159]
    v_exp_f32 v72, v72
    v_exp_f32 v73, v73
    v_exp_f32 v74, v74
    v_exp_f32 v75, v75
    v_exp_f32 v76, v76
    v_exp_f32 v77, v77
    v_exp_f32 v78, v78
    v_exp_f32 v79, v79
    ds_read_b64_tr_b16 v[92:93], v32 offset:4704
    ds_read_b64_tr_b16 v[94:95], v32 offset:5856
    s_waitcnt lgkmcnt(10)
    v_mfma_f32_32x32x16_bf16 v[144:159], v[96:99], v[12:15], v[144:159]
    v_add_f32 v72, 1.0, v72
    v_add_f32 v73, 1.0, v73
    v_add_f32 v74, 1.0, v74
    v_add_f32 v75, 1.0, v75
    v_add_f32 v76, 1.0, v76
    v_add_f32 v77, 1.0, v77
    v_add_f32 v78, 1.0, v78
    v_add_f32 v79, 1.0, v79
    ds_read_b64_tr_b16 v[96:97], v32 offset:9312
    ds_read_b64_tr_b16 v[98:99], v32 offset:10464
    s_waitcnt lgkmcnt(10)
    v_mfma_f32_32x32x16_bf16 v[144:159], v[100:103], v[16:19], v[144:159]
    v_rcp_f32 v72, v72
    v_rcp_f32 v73, v73
    v_rcp_f32 v74, v74
    v_rcp_f32 v75, v75
    v_rcp_f32 v76, v76
    v_rcp_f32 v77, v77
    v_rcp_f32 v78, v78
    v_rcp_f32 v79, v79
    ds_read_b64_tr_b16 v[100:101], v32 offset:13920
    ds_read_b64_tr_b16 v[102:103], v32 offset:15072
    s_waitcnt lgkmcnt(10)
    v_mfma_f32_32x32x16_bf16 v[144:159], v[104:107], v[20:23], v[144:159]
    v_mul_f32 v128, v128, v72
    v_mul_f32 v129, v129, v73
    v_mul_f32 v130, v130, v74
    v_mul_f32 v131, v131, v75
    v_mul_f32 v132, v132, v76
    v_mul_f32 v133, v133, v77
    v_mul_f32 v134, v134, v78
    v_mul_f32 v135, v135, v79
    ds_read_b64_tr_b16 v[104:105], v33 offset:96
    ds_read_b64_tr_b16 v[106:107], v33 offset:1248
    s_waitcnt lgkmcnt(10)
    v_mfma_f32_32x32x16_bf16 v[144:159], v[108:111], v[24:27], v[144:159]
    v_cvt_pk_bf16_f32 v72, v128, v129
    v_cvt_pk_bf16_f32 v73, v130, v131
    v_cvt_pk_bf16_f32 v74, v132, v133
    v_cvt_pk_bf16_f32 v75, v134, v135
    v_lshlrev_b32 v128, 16, v72
    v_and_b32 v129, 0xffff0000, v72
    v_lshlrev_b32 v130, 16, v73
    v_and_b32 v131, 0xffff0000, v73
    ds_read_b64_tr_b16 v[108:109], v33 offset:4704
    ds_read_b64_tr_b16 v[110:111], v33 offset:5856
    s_waitcnt lgkmcnt(10)
    v_mfma_f32_32x32x16_bf16 v[160:175], v[88:91], v[40:43], v[160:175]
    v_lshlrev_b32 v132, 16, v74
    v_and_b32 v133, 0xffff0000, v74
    v_lshlrev_b32 v134, 16, v75
    v_and_b32 v135, 0xffff0000, v75
    v_mul_f32 v128, v128, v136
    v_mul_f32 v129, v129, v137
    v_mul_f32 v130, v130, v138
    v_mul_f32 v131, v131, v139
    ds_read_b64_tr_b16 v[88:89], v33 offset:9312
    ds_read_b64_tr_b16 v[90:91], v33 offset:10464
    s_waitcnt lgkmcnt(10)
    v_mfma_f32_32x32x16_bf16 v[160:175], v[92:95], v[44:47], v[160:175]
    v_mul_f32 v132, v132, v140
    v_mul_f32 v133, v133, v141
    v_mul_f32 v134, v134, v142
    v_mul_f32 v135, v135, v143
    v_cvt_pk_bf16_f32 v84, v128, v129
    v_cvt_pk_bf16_f32 v85, v130, v131
    v_cvt_pk_bf16_f32 v86, v132, v133
    v_cvt_pk_bf16_f32 v87, v134, v135
    ds_read_b64_tr_b16 v[92:93], v33 offset:13920
    ds_read_b64_tr_b16 v[94:95], v33 offset:15072
    s_waitcnt lgkmcnt(10)
    v_mfma_f32_32x32x16_bf16 v[160:175], v[96:99], v[48:51], v[160:175]
    buffer_store_dwordx4 v[84:87], v3, s[16:19], s22 offen offset:512 sc1
    ds_read_b64_tr_b16 v[96:97], v30 offset:96
    ds_read_b64_tr_b16 v[98:99], v30 offset:1248
    s_waitcnt lgkmcnt(10)
    v_mfma_f32_32x32x16_bf16 v[160:175], v[100:103], v[52:55], v[160:175]
    v_cvt_pk_bf16_f32 v72, v144, v145
    v_cvt_pk_bf16_f32 v73, v146, v147
    v_cvt_pk_bf16_f32 v74, v148, v149
    v_cvt_pk_bf16_f32 v75, v150, v151
    v_cvt_pk_bf16_f32 v76, v152, v153
    v_cvt_pk_bf16_f32 v77, v154, v155
    v_cvt_pk_bf16_f32 v78, v156, v157
    v_cvt_pk_bf16_f32 v79, v158, v159
    ds_read_b64_tr_b16 v[100:101], v30 offset:4704
    ds_read_b64_tr_b16 v[102:103], v30 offset:5856
    s_waitcnt lgkmcnt(10)
    v_mfma_f32_32x32x16_bf16 v[160:175], v[104:107], v[56:59], v[160:175]
    v_lshlrev_b32 v144, 16, v72
    v_and_b32 v145, 0xffff0000, v72
    v_lshlrev_b32 v146, 16, v73
    v_and_b32 v147, 0xffff0000, v73
    v_lshlrev_b32 v148, 16, v74
    v_and_b32 v149, 0xffff0000, v74
    v_lshlrev_b32 v150, 16, v75
    v_and_b32 v151, 0xffff0000, v75
    ds_read_b64_tr_b16 v[104:105], v30 offset:9312
    ds_read_b64_tr_b16 v[106:107], v30 offset:10464
    s_waitcnt lgkmcnt(10)
    v_mfma_f32_32x32x16_bf16 v[160:175], v[108:111], v[60:63], v[160:175]
    v_lshlrev_b32 v152, 16, v76
    v_and_b32 v153, 0xffff0000, v76
    v_lshlrev_b32 v154, 16, v77
    v_and_b32 v155, 0xffff0000, v77
    v_lshlrev_b32 v156, 16, v78
    v_and_b32 v157, 0xffff0000, v78
    v_lshlrev_b32 v158, 16, v79
    v_and_b32 v159, 0xffff0000, v79
    ds_read_b64_tr_b16 v[108:109], v30 offset:13920
    ds_read_b64_tr_b16 v[110:111], v30 offset:15072
    s_waitcnt lgkmcnt(10)
    v_mfma_f32_32x32x16_bf16 v[160:175], v[88:91], v[64:67], v[160:175]
    v_mul_f32 v72, s54, v144
    v_mul_f32 v73, s54, v145
    v_mul_f32 v74, s54, v146
    v_mul_f32 v75, s54, v147
    v_mul_f32 v76, s54, v148
    v_mul_f32 v77, s54, v149
    v_mul_f32 v78, s54, v150
    v_mul_f32 v79, s54, v151
    ds_read_b64_tr_b16 v[88:89], v32 offset:128
    ds_read_b64_tr_b16 v[90:91], v32 offset:1280
    s_waitcnt lgkmcnt(10)
    v_mfma_f32_32x32x16_bf16 v[160:175], v[92:95], v[68:71], v[160:175]
    v_exp_f32 v72, v72
    v_exp_f32 v73, v73
    v_exp_f32 v74, v74
    v_exp_f32 v75, v75
    v_exp_f32 v76, v76
    v_exp_f32 v77, v77
    v_exp_f32 v78, v78
    v_exp_f32 v79, v79
    ds_read_b64_tr_b16 v[92:93], v32 offset:4736
    ds_read_b64_tr_b16 v[94:95], v32 offset:5888
    s_waitcnt lgkmcnt(10)
    v_mfma_f32_32x32x16_bf16 v[160:175], v[96:99], v[12:15], v[160:175]
    v_add_f32 v72, 1.0, v72
    v_add_f32 v73, 1.0, v73
    v_add_f32 v74, 1.0, v74
    v_add_f32 v75, 1.0, v75
    v_add_f32 v76, 1.0, v76
    v_add_f32 v77, 1.0, v77
    v_add_f32 v78, 1.0, v78
    v_add_f32 v79, 1.0, v79
    ds_read_b64_tr_b16 v[96:97], v32 offset:9344
    ds_read_b64_tr_b16 v[98:99], v32 offset:10496
    s_waitcnt lgkmcnt(10)
    v_mfma_f32_32x32x16_bf16 v[160:175], v[100:103], v[16:19], v[160:175]
    v_rcp_f32 v72, v72
    v_rcp_f32 v73, v73
    v_rcp_f32 v74, v74
    v_rcp_f32 v75, v75
    v_rcp_f32 v76, v76
    v_rcp_f32 v77, v77
    v_rcp_f32 v78, v78
    v_rcp_f32 v79, v79
    ds_read_b64_tr_b16 v[100:101], v32 offset:13952
    ds_read_b64_tr_b16 v[102:103], v32 offset:15104
    s_waitcnt lgkmcnt(10)
    v_mfma_f32_32x32x16_bf16 v[160:175], v[104:107], v[20:23], v[160:175]
    v_mul_f32 v144, v144, v72
    v_mul_f32 v145, v145, v73
    v_mul_f32 v146, v146, v74
    v_mul_f32 v147, v147, v75
    v_mul_f32 v148, v148, v76
    v_mul_f32 v149, v149, v77
    v_mul_f32 v150, v150, v78
    v_mul_f32 v151, v151, v79
    ds_read_b64_tr_b16 v[104:105], v33 offset:128
    ds_read_b64_tr_b16 v[106:107], v33 offset:1280
    s_waitcnt lgkmcnt(10)
    v_mfma_f32_32x32x16_bf16 v[160:175], v[108:111], v[24:27], v[160:175]
    v_cvt_pk_bf16_f32 v72, v144, v145
    v_cvt_pk_bf16_f32 v73, v146, v147
    v_cvt_pk_bf16_f32 v74, v148, v149
    v_cvt_pk_bf16_f32 v75, v150, v151
    v_lshlrev_b32 v144, 16, v72
    v_and_b32 v145, 0xffff0000, v72
    v_lshlrev_b32 v146, 16, v73
    v_and_b32 v147, 0xffff0000, v73
    ds_read_b64_tr_b16 v[108:109], v33 offset:4736
    ds_read_b64_tr_b16 v[110:111], v33 offset:5888
    s_waitcnt lgkmcnt(10)
    v_mfma_f32_32x32x16_bf16 v[176:191], v[88:91], v[40:43], v[176:191]
    v_lshlrev_b32 v148, 16, v74
    v_and_b32 v149, 0xffff0000, v74
    v_lshlrev_b32 v150, 16, v75
    v_and_b32 v151, 0xffff0000, v75
    v_mul_f32 v144, v144, v152
    v_mul_f32 v145, v145, v153
    v_mul_f32 v146, v146, v154
    v_mul_f32 v147, v147, v155
    ds_read_b64_tr_b16 v[88:89], v33 offset:9344
    ds_read_b64_tr_b16 v[90:91], v33 offset:10496
    s_waitcnt lgkmcnt(10)
    v_mfma_f32_32x32x16_bf16 v[176:191], v[92:95], v[44:47], v[176:191]
    v_mul_f32 v148, v148, v156
    v_mul_f32 v149, v149, v157
    v_mul_f32 v150, v150, v158
    v_mul_f32 v151, v151, v159
    v_cvt_pk_bf16_f32 v80, v144, v145
    v_cvt_pk_bf16_f32 v81, v146, v147
    v_cvt_pk_bf16_f32 v82, v148, v149
    v_cvt_pk_bf16_f32 v83, v150, v151
    ds_read_b64_tr_b16 v[92:93], v33 offset:13952
    ds_read_b64_tr_b16 v[94:95], v33 offset:15104
    s_waitcnt lgkmcnt(10)
    v_mfma_f32_32x32x16_bf16 v[176:191], v[96:99], v[48:51], v[176:191]
    buffer_store_dwordx4 v[80:83], v3, s[16:19], s22 offen offset:1024 sc1
    ds_read_b64_tr_b16 v[96:97], v30 offset:128
    ds_read_b64_tr_b16 v[98:99], v30 offset:1280
    s_waitcnt lgkmcnt(10)
    v_mfma_f32_32x32x16_bf16 v[176:191], v[100:103], v[52:55], v[176:191]
    v_cvt_pk_bf16_f32 v72, v160, v161
    v_cvt_pk_bf16_f32 v73, v162, v163
    v_cvt_pk_bf16_f32 v74, v164, v165
    v_cvt_pk_bf16_f32 v75, v166, v167
    v_cvt_pk_bf16_f32 v76, v168, v169
    v_cvt_pk_bf16_f32 v77, v170, v171
    v_cvt_pk_bf16_f32 v78, v172, v173
    v_cvt_pk_bf16_f32 v79, v174, v175
    ds_read_b64_tr_b16 v[100:101], v30 offset:4736
    ds_read_b64_tr_b16 v[102:103], v30 offset:5888
    s_waitcnt lgkmcnt(10)
    v_mfma_f32_32x32x16_bf16 v[176:191], v[104:107], v[56:59], v[176:191]
    v_lshlrev_b32 v160, 16, v72
    v_and_b32 v161, 0xffff0000, v72
    v_lshlrev_b32 v162, 16, v73
    v_and_b32 v163, 0xffff0000, v73
    v_lshlrev_b32 v164, 16, v74
    v_and_b32 v165, 0xffff0000, v74
    v_lshlrev_b32 v166, 16, v75
    v_and_b32 v167, 0xffff0000, v75
    ds_read_b64_tr_b16 v[104:105], v30 offset:9344
    ds_read_b64_tr_b16 v[106:107], v30 offset:10496
    s_waitcnt lgkmcnt(10)
    v_mfma_f32_32x32x16_bf16 v[176:191], v[108:111], v[60:63], v[176:191]
    v_lshlrev_b32 v168, 16, v76
    v_and_b32 v169, 0xffff0000, v76
    v_lshlrev_b32 v170, 16, v77
    v_and_b32 v171, 0xffff0000, v77
    v_lshlrev_b32 v172, 16, v78
    v_and_b32 v173, 0xffff0000, v78
    v_lshlrev_b32 v174, 16, v79
    v_and_b32 v175, 0xffff0000, v79
    ds_read_b64_tr_b16 v[108:109], v30 offset:13952
    ds_read_b64_tr_b16 v[110:111], v30 offset:15104
    s_waitcnt lgkmcnt(10)
    v_mfma_f32_32x32x16_bf16 v[176:191], v[88:91], v[64:67], v[176:191]
    v_mul_f32 v72, s54, v160
    v_mul_f32 v73, s54, v161
    v_mul_f32 v74, s54, v162
    v_mul_f32 v75, s54, v163
    v_mul_f32 v76, s54, v164
    v_mul_f32 v77, s54, v165
    v_mul_f32 v78, s54, v166
    v_mul_f32 v79, s54, v167
    ds_read_b64_tr_b16 v[88:89], v32 offset:160
    ds_read_b64_tr_b16 v[90:91], v32 offset:1312
    s_waitcnt lgkmcnt(10)
    v_mfma_f32_32x32x16_bf16 v[176:191], v[92:95], v[68:71], v[176:191]
    v_exp_f32 v72, v72
    v_exp_f32 v73, v73
    v_exp_f32 v74, v74
    v_exp_f32 v75, v75
    v_exp_f32 v76, v76
    v_exp_f32 v77, v77
    v_exp_f32 v78, v78
    v_exp_f32 v79, v79
    ds_read_b64_tr_b16 v[92:93], v32 offset:4768
    ds_read_b64_tr_b16 v[94:95], v32 offset:5920
    s_waitcnt lgkmcnt(10)
    v_mfma_f32_32x32x16_bf16 v[176:191], v[96:99], v[12:15], v[176:191]
    v_add_f32 v72, 1.0, v72
    v_add_f32 v73, 1.0, v73
    v_add_f32 v74, 1.0, v74
    v_add_f32 v75, 1.0, v75
    v_add_f32 v76, 1.0, v76
    v_add_f32 v77, 1.0, v77
    v_add_f32 v78, 1.0, v78
    v_add_f32 v79, 1.0, v79
    ds_read_b64_tr_b16 v[96:97], v32 offset:9376
    ds_read_b64_tr_b16 v[98:99], v32 offset:10528
    s_waitcnt lgkmcnt(10)
    v_mfma_f32_32x32x16_bf16 v[176:191], v[100:103], v[16:19], v[176:191]
    v_rcp_f32 v72, v72
    v_rcp_f32 v73, v73
    v_rcp_f32 v74, v74
    v_rcp_f32 v75, v75
    v_rcp_f32 v76, v76
    v_rcp_f32 v77, v77
    v_rcp_f32 v78, v78
    v_rcp_f32 v79, v79
    ds_read_b64_tr_b16 v[100:101], v32 offset:13984
    ds_read_b64_tr_b16 v[102:103], v32 offset:15136
    s_waitcnt lgkmcnt(10)
    v_mfma_f32_32x32x16_bf16 v[176:191], v[104:107], v[20:23], v[176:191]
    v_mul_f32 v160, v160, v72
    v_mul_f32 v161, v161, v73
    v_mul_f32 v162, v162, v74
    v_mul_f32 v163, v163, v75
    v_mul_f32 v164, v164, v76
    v_mul_f32 v165, v165, v77
    v_mul_f32 v166, v166, v78
    v_mul_f32 v167, v167, v79
    ds_read_b64_tr_b16 v[104:105], v33 offset:160
    ds_read_b64_tr_b16 v[106:107], v33 offset:1312
    s_waitcnt lgkmcnt(10)
    v_mfma_f32_32x32x16_bf16 v[176:191], v[108:111], v[24:27], v[176:191]
    v_cvt_pk_bf16_f32 v72, v160, v161
    v_cvt_pk_bf16_f32 v73, v162, v163
    v_cvt_pk_bf16_f32 v74, v164, v165
    v_cvt_pk_bf16_f32 v75, v166, v167
    v_lshlrev_b32 v160, 16, v72
    v_and_b32 v161, 0xffff0000, v72
    v_lshlrev_b32 v162, 16, v73
    v_and_b32 v163, 0xffff0000, v73
    ds_read_b64_tr_b16 v[108:109], v33 offset:4768
    ds_read_b64_tr_b16 v[110:111], v33 offset:5920
    s_waitcnt lgkmcnt(10)
    v_mfma_f32_32x32x16_bf16 v[192:207], v[88:91], v[40:43], v[192:207]
    v_lshlrev_b32 v164, 16, v74
    v_and_b32 v165, 0xffff0000, v74
    v_lshlrev_b32 v166, 16, v75
    v_and_b32 v167, 0xffff0000, v75
    v_mul_f32 v160, v160, v168
    v_mul_f32 v161, v161, v169
    v_mul_f32 v162, v162, v170
    v_mul_f32 v163, v163, v171
    ds_read_b64_tr_b16 v[88:89], v33 offset:9376
    ds_read_b64_tr_b16 v[90:91], v33 offset:10528
    s_waitcnt lgkmcnt(10)
    v_mfma_f32_32x32x16_bf16 v[192:207], v[92:95], v[44:47], v[192:207]
    v_mul_f32 v164, v164, v172
    v_mul_f32 v165, v165, v173
    v_mul_f32 v166, v166, v174
    v_mul_f32 v167, v167, v175
    v_cvt_pk_bf16_f32 v84, v160, v161
    v_cvt_pk_bf16_f32 v85, v162, v163
    v_cvt_pk_bf16_f32 v86, v164, v165
    v_cvt_pk_bf16_f32 v87, v166, v167
    ds_read_b64_tr_b16 v[92:93], v33 offset:13984
    ds_read_b64_tr_b16 v[94:95], v33 offset:15136
    s_waitcnt lgkmcnt(10)
    v_mfma_f32_32x32x16_bf16 v[192:207], v[96:99], v[48:51], v[192:207]
    buffer_store_dwordx4 v[84:87], v3, s[16:19], s22 offen offset:1536 sc1
    ds_read_b64_tr_b16 v[96:97], v30 offset:160
    ds_read_b64_tr_b16 v[98:99], v30 offset:1312
    s_waitcnt lgkmcnt(10)
    v_mfma_f32_32x32x16_bf16 v[192:207], v[100:103], v[52:55], v[192:207]
    v_cvt_pk_bf16_f32 v72, v176, v177
    v_cvt_pk_bf16_f32 v73, v178, v179
    v_cvt_pk_bf16_f32 v74, v180, v181
    v_cvt_pk_bf16_f32 v75, v182, v183
    v_cvt_pk_bf16_f32 v76, v184, v185
    v_cvt_pk_bf16_f32 v77, v186, v187
    v_cvt_pk_bf16_f32 v78, v188, v189
    v_cvt_pk_bf16_f32 v79, v190, v191
    ds_read_b64_tr_b16 v[100:101], v30 offset:4768
    ds_read_b64_tr_b16 v[102:103], v30 offset:5920
    s_waitcnt lgkmcnt(10)
    v_mfma_f32_32x32x16_bf16 v[192:207], v[104:107], v[56:59], v[192:207]
    v_lshlrev_b32 v176, 16, v72
    v_and_b32 v177, 0xffff0000, v72
    v_lshlrev_b32 v178, 16, v73
    v_and_b32 v179, 0xffff0000, v73
    v_lshlrev_b32 v180, 16, v74
    v_and_b32 v181, 0xffff0000, v74
    v_lshlrev_b32 v182, 16, v75
    v_and_b32 v183, 0xffff0000, v75
    ds_read_b64_tr_b16 v[104:105], v30 offset:9376
    ds_read_b64_tr_b16 v[106:107], v30 offset:10528
    s_waitcnt lgkmcnt(10)
    v_mfma_f32_32x32x16_bf16 v[192:207], v[108:111], v[60:63], v[192:207]
    v_lshlrev_b32 v184, 16, v76
    v_and_b32 v185, 0xffff0000, v76
    v_lshlrev_b32 v186, 16, v77
    v_and_b32 v187, 0xffff0000, v77
    v_lshlrev_b32 v188, 16, v78
    v_and_b32 v189, 0xffff0000, v78
    v_lshlrev_b32 v190, 16, v79
    v_and_b32 v191, 0xffff0000, v79
    ds_read_b64_tr_b16 v[108:109], v30 offset:13984
    ds_read_b64_tr_b16 v[110:111], v30 offset:15136
    s_waitcnt lgkmcnt(10)
    v_mfma_f32_32x32x16_bf16 v[192:207], v[88:91], v[64:67], v[192:207]
    v_mul_f32 v72, s54, v176
    v_mul_f32 v73, s54, v177
    v_mul_f32 v74, s54, v178
    v_mul_f32 v75, s54, v179
    v_mul_f32 v76, s54, v180
    v_mul_f32 v77, s54, v181
    v_mul_f32 v78, s54, v182
    v_mul_f32 v79, s54, v183
    ds_read_b64_tr_b16 v[88:89], v32 offset:192
    ds_read_b64_tr_b16 v[90:91], v32 offset:1344
    s_waitcnt lgkmcnt(10)
    v_mfma_f32_32x32x16_bf16 v[192:207], v[92:95], v[68:71], v[192:207]
    v_exp_f32 v72, v72
    v_exp_f32 v73, v73
    v_exp_f32 v74, v74
    v_exp_f32 v75, v75
    v_exp_f32 v76, v76
    v_exp_f32 v77, v77
    v_exp_f32 v78, v78
    v_exp_f32 v79, v79
    ds_read_b64_tr_b16 v[92:93], v32 offset:4800
    ds_read_b64_tr_b16 v[94:95], v32 offset:5952
    s_waitcnt lgkmcnt(10)
    v_mfma_f32_32x32x16_bf16 v[192:207], v[96:99], v[12:15], v[192:207]
    v_add_f32 v72, 1.0, v72
    v_add_f32 v73, 1.0, v73
    v_add_f32 v74, 1.0, v74
    v_add_f32 v75, 1.0, v75
    v_add_f32 v76, 1.0, v76
    v_add_f32 v77, 1.0, v77
    v_add_f32 v78, 1.0, v78
    v_add_f32 v79, 1.0, v79
    ds_read_b64_tr_b16 v[96:97], v32 offset:9408
    ds_read_b64_tr_b16 v[98:99], v32 offset:10560
    s_waitcnt lgkmcnt(10)
    v_mfma_f32_32x32x16_bf16 v[192:207], v[100:103], v[16:19], v[192:207]
    v_rcp_f32 v72, v72
    v_rcp_f32 v73, v73
    v_rcp_f32 v74, v74
    v_rcp_f32 v75, v75
    v_rcp_f32 v76, v76
    v_rcp_f32 v77, v77
    v_rcp_f32 v78, v78
    v_rcp_f32 v79, v79
    ds_read_b64_tr_b16 v[100:101], v32 offset:14016
    ds_read_b64_tr_b16 v[102:103], v32 offset:15168
    s_waitcnt lgkmcnt(10)
    v_mfma_f32_32x32x16_bf16 v[192:207], v[104:107], v[20:23], v[192:207]
    v_mul_f32 v176, v176, v72
    v_mul_f32 v177, v177, v73
    v_mul_f32 v178, v178, v74
    v_mul_f32 v179, v179, v75
    v_mul_f32 v180, v180, v76
    v_mul_f32 v181, v181, v77
    v_mul_f32 v182, v182, v78
    v_mul_f32 v183, v183, v79
    ds_read_b64_tr_b16 v[104:105], v33 offset:192
    ds_read_b64_tr_b16 v[106:107], v33 offset:1344
    s_waitcnt lgkmcnt(10)
    v_mfma_f32_32x32x16_bf16 v[192:207], v[108:111], v[24:27], v[192:207]
    v_cvt_pk_bf16_f32 v72, v176, v177
    v_cvt_pk_bf16_f32 v73, v178, v179
    v_cvt_pk_bf16_f32 v74, v180, v181
    v_cvt_pk_bf16_f32 v75, v182, v183
    v_lshlrev_b32 v176, 16, v72
    v_and_b32 v177, 0xffff0000, v72
    v_lshlrev_b32 v178, 16, v73
    v_and_b32 v179, 0xffff0000, v73
    ds_read_b64_tr_b16 v[108:109], v33 offset:4800
    ds_read_b64_tr_b16 v[110:111], v33 offset:5952
    s_waitcnt lgkmcnt(10)
    v_mfma_f32_32x32x16_bf16 v[208:223], v[88:91], v[40:43], v[208:223]
    v_lshlrev_b32 v180, 16, v74
    v_and_b32 v181, 0xffff0000, v74
    v_lshlrev_b32 v182, 16, v75
    v_and_b32 v183, 0xffff0000, v75
    v_mul_f32 v176, v176, v184
    v_mul_f32 v177, v177, v185
    v_mul_f32 v178, v178, v186
    v_mul_f32 v179, v179, v187
    ds_read_b64_tr_b16 v[88:89], v33 offset:9408
    ds_read_b64_tr_b16 v[90:91], v33 offset:10560
    s_waitcnt lgkmcnt(10)
    v_mfma_f32_32x32x16_bf16 v[208:223], v[92:95], v[44:47], v[208:223]
    v_mul_f32 v180, v180, v188
    v_mul_f32 v181, v181, v189
    v_mul_f32 v182, v182, v190
    v_mul_f32 v183, v183, v191
    v_cvt_pk_bf16_f32 v80, v176, v177
    v_cvt_pk_bf16_f32 v81, v178, v179
    v_cvt_pk_bf16_f32 v82, v180, v181
    v_cvt_pk_bf16_f32 v83, v182, v183
    ds_read_b64_tr_b16 v[92:93], v33 offset:14016
    ds_read_b64_tr_b16 v[94:95], v33 offset:15168
    s_waitcnt lgkmcnt(10)
    v_mfma_f32_32x32x16_bf16 v[208:223], v[96:99], v[48:51], v[208:223]
    buffer_store_dwordx4 v[80:83], v3, s[16:19], s22 offen offset:2048 sc1
    ds_read_b64_tr_b16 v[96:97], v30 offset:192
    ds_read_b64_tr_b16 v[98:99], v30 offset:1344
    s_waitcnt lgkmcnt(10)
    v_mfma_f32_32x32x16_bf16 v[208:223], v[100:103], v[52:55], v[208:223]
    v_cvt_pk_bf16_f32 v72, v192, v193
    v_cvt_pk_bf16_f32 v73, v194, v195
    v_cvt_pk_bf16_f32 v74, v196, v197
    v_cvt_pk_bf16_f32 v75, v198, v199
    v_cvt_pk_bf16_f32 v76, v200, v201
    v_cvt_pk_bf16_f32 v77, v202, v203
    v_cvt_pk_bf16_f32 v78, v204, v205
    v_cvt_pk_bf16_f32 v79, v206, v207
    ds_read_b64_tr_b16 v[100:101], v30 offset:4800
    ds_read_b64_tr_b16 v[102:103], v30 offset:5952
    s_waitcnt lgkmcnt(10)
    v_mfma_f32_32x32x16_bf16 v[208:223], v[104:107], v[56:59], v[208:223]
    v_lshlrev_b32 v192, 16, v72
    v_and_b32 v193, 0xffff0000, v72
    v_lshlrev_b32 v194, 16, v73
    v_and_b32 v195, 0xffff0000, v73
    v_lshlrev_b32 v196, 16, v74
    v_and_b32 v197, 0xffff0000, v74
    v_lshlrev_b32 v198, 16, v75
    v_and_b32 v199, 0xffff0000, v75
    ds_read_b64_tr_b16 v[104:105], v30 offset:9408
    ds_read_b64_tr_b16 v[106:107], v30 offset:10560
    s_waitcnt lgkmcnt(10)
    v_mfma_f32_32x32x16_bf16 v[208:223], v[108:111], v[60:63], v[208:223]
    v_lshlrev_b32 v200, 16, v76
    v_and_b32 v201, 0xffff0000, v76
    v_lshlrev_b32 v202, 16, v77
    v_and_b32 v203, 0xffff0000, v77
    v_lshlrev_b32 v204, 16, v78
    v_and_b32 v205, 0xffff0000, v78
    v_lshlrev_b32 v206, 16, v79
    v_and_b32 v207, 0xffff0000, v79
    ds_read_b64_tr_b16 v[108:109], v30 offset:14016
    ds_read_b64_tr_b16 v[110:111], v30 offset:15168
    s_waitcnt lgkmcnt(10)
    v_mfma_f32_32x32x16_bf16 v[208:223], v[88:91], v[64:67], v[208:223]
    v_mul_f32 v72, s54, v192
    v_mul_f32 v73, s54, v193
    v_mul_f32 v74, s54, v194
    v_mul_f32 v75, s54, v195
    v_mul_f32 v76, s54, v196
    v_mul_f32 v77, s54, v197
    v_mul_f32 v78, s54, v198
    v_mul_f32 v79, s54, v199
    ds_read_b64_tr_b16 v[88:89], v32 offset:224
    ds_read_b64_tr_b16 v[90:91], v32 offset:1376
    s_waitcnt lgkmcnt(10)
    v_mfma_f32_32x32x16_bf16 v[208:223], v[92:95], v[68:71], v[208:223]
    v_exp_f32 v72, v72
    v_exp_f32 v73, v73
    v_exp_f32 v74, v74
    v_exp_f32 v75, v75
    v_exp_f32 v76, v76
    v_exp_f32 v77, v77
    v_exp_f32 v78, v78
    v_exp_f32 v79, v79
    ds_read_b64_tr_b16 v[92:93], v32 offset:4832
    ds_read_b64_tr_b16 v[94:95], v32 offset:5984
    s_waitcnt lgkmcnt(10)
    v_mfma_f32_32x32x16_bf16 v[208:223], v[96:99], v[12:15], v[208:223]
    v_add_f32 v72, 1.0, v72
    v_add_f32 v73, 1.0, v73
    v_add_f32 v74, 1.0, v74
    v_add_f32 v75, 1.0, v75
    v_add_f32 v76, 1.0, v76
    v_add_f32 v77, 1.0, v77
    v_add_f32 v78, 1.0, v78
    v_add_f32 v79, 1.0, v79
    ds_read_b64_tr_b16 v[96:97], v32 offset:9440
    ds_read_b64_tr_b16 v[98:99], v32 offset:10592
    s_waitcnt lgkmcnt(10)
    v_mfma_f32_32x32x16_bf16 v[208:223], v[100:103], v[16:19], v[208:223]
    v_rcp_f32 v72, v72
    v_rcp_f32 v73, v73
    v_rcp_f32 v74, v74
    v_rcp_f32 v75, v75
    v_rcp_f32 v76, v76
    v_rcp_f32 v77, v77
    v_rcp_f32 v78, v78
    v_rcp_f32 v79, v79
    ds_read_b64_tr_b16 v[100:101], v32 offset:14048
    ds_read_b64_tr_b16 v[102:103], v32 offset:15200
    s_waitcnt lgkmcnt(10)
    v_mfma_f32_32x32x16_bf16 v[208:223], v[104:107], v[20:23], v[208:223]
    v_mul_f32 v192, v192, v72
    v_mul_f32 v193, v193, v73
    v_mul_f32 v194, v194, v74
    v_mul_f32 v195, v195, v75
    v_mul_f32 v196, v196, v76
    v_mul_f32 v197, v197, v77
    v_mul_f32 v198, v198, v78
    v_mul_f32 v199, v199, v79
    ds_read_b64_tr_b16 v[104:105], v33 offset:224
    ds_read_b64_tr_b16 v[106:107], v33 offset:1376
    s_waitcnt lgkmcnt(10)
    v_mfma_f32_32x32x16_bf16 v[208:223], v[108:111], v[24:27], v[208:223]
    v_cvt_pk_bf16_f32 v72, v192, v193
    v_cvt_pk_bf16_f32 v73, v194, v195
    v_cvt_pk_bf16_f32 v74, v196, v197
    v_cvt_pk_bf16_f32 v75, v198, v199
    v_lshlrev_b32 v192, 16, v72
    v_and_b32 v193, 0xffff0000, v72
    v_lshlrev_b32 v194, 16, v73
    v_and_b32 v195, 0xffff0000, v73
    ds_read_b64_tr_b16 v[108:109], v33 offset:4832
    ds_read_b64_tr_b16 v[110:111], v33 offset:5984
    s_waitcnt lgkmcnt(10)
    v_mfma_f32_32x32x16_bf16 v[224:239], v[88:91], v[40:43], v[224:239]
    v_lshlrev_b32 v196, 16, v74
    v_and_b32 v197, 0xffff0000, v74
    v_lshlrev_b32 v198, 16, v75
    v_and_b32 v199, 0xffff0000, v75
    v_mul_f32 v192, v192, v200
    v_mul_f32 v193, v193, v201
    v_mul_f32 v194, v194, v202
    v_mul_f32 v195, v195, v203
    ds_read_b64_tr_b16 v[88:89], v33 offset:9440
    ds_read_b64_tr_b16 v[90:91], v33 offset:10592
    s_waitcnt lgkmcnt(10)
    v_mfma_f32_32x32x16_bf16 v[224:239], v[92:95], v[44:47], v[224:239]
    v_mul_f32 v196, v196, v204
    v_mul_f32 v197, v197, v205
    v_mul_f32 v198, v198, v206
    v_mul_f32 v199, v199, v207
    v_cvt_pk_bf16_f32 v84, v192, v193
    v_cvt_pk_bf16_f32 v85, v194, v195
    v_cvt_pk_bf16_f32 v86, v196, v197
    v_cvt_pk_bf16_f32 v87, v198, v199
    ds_read_b64_tr_b16 v[92:93], v33 offset:14048
    ds_read_b64_tr_b16 v[94:95], v33 offset:15200
    s_waitcnt lgkmcnt(10)
    v_mfma_f32_32x32x16_bf16 v[224:239], v[96:99], v[48:51], v[224:239]
    buffer_store_dwordx4 v[84:87], v3, s[16:19], s22 offen offset:2560 sc1
    ds_read_b64_tr_b16 v[96:97], v30 offset:224
    ds_read_b64_tr_b16 v[98:99], v30 offset:1376
    s_waitcnt lgkmcnt(10)
    v_mfma_f32_32x32x16_bf16 v[224:239], v[100:103], v[52:55], v[224:239]
    v_cvt_pk_bf16_f32 v72, v208, v209
    v_cvt_pk_bf16_f32 v73, v210, v211
    v_cvt_pk_bf16_f32 v74, v212, v213
    v_cvt_pk_bf16_f32 v75, v214, v215
    v_cvt_pk_bf16_f32 v76, v216, v217
    v_cvt_pk_bf16_f32 v77, v218, v219
    v_cvt_pk_bf16_f32 v78, v220, v221
    v_cvt_pk_bf16_f32 v79, v222, v223
    ds_read_b64_tr_b16 v[100:101], v30 offset:4832
    ds_read_b64_tr_b16 v[102:103], v30 offset:5984
    s_waitcnt lgkmcnt(10)
    v_mfma_f32_32x32x16_bf16 v[224:239], v[104:107], v[56:59], v[224:239]
    v_lshlrev_b32 v208, 16, v72
    v_and_b32 v209, 0xffff0000, v72
    v_lshlrev_b32 v210, 16, v73
    v_and_b32 v211, 0xffff0000, v73
    v_lshlrev_b32 v212, 16, v74
    v_and_b32 v213, 0xffff0000, v74
    v_lshlrev_b32 v214, 16, v75
    v_and_b32 v215, 0xffff0000, v75
    ds_read_b64_tr_b16 v[104:105], v30 offset:9440
    ds_read_b64_tr_b16 v[106:107], v30 offset:10592
    s_waitcnt lgkmcnt(10)
    v_mfma_f32_32x32x16_bf16 v[224:239], v[108:111], v[60:63], v[224:239]
    v_lshlrev_b32 v216, 16, v76
    v_and_b32 v217, 0xffff0000, v76
    v_lshlrev_b32 v218, 16, v77
    v_and_b32 v219, 0xffff0000, v77
    v_lshlrev_b32 v220, 16, v78
    v_and_b32 v221, 0xffff0000, v78
    v_lshlrev_b32 v222, 16, v79
    v_and_b32 v223, 0xffff0000, v79
    ds_read_b64_tr_b16 v[108:109], v30 offset:14048
    ds_read_b64_tr_b16 v[110:111], v30 offset:15200
    s_waitcnt lgkmcnt(10)
    v_mfma_f32_32x32x16_bf16 v[224:239], v[88:91], v[64:67], v[224:239]
    v_mul_f32 v72, s54, v208
    v_mul_f32 v73, s54, v209
    v_mul_f32 v74, s54, v210
    v_mul_f32 v75, s54, v211
    v_mul_f32 v76, s54, v212
    v_mul_f32 v77, s54, v213
    v_mul_f32 v78, s54, v214
    v_mul_f32 v79, s54, v215
    ds_read_b64_tr_b16 v[88:89], v32 offset:256
    ds_read_b64_tr_b16 v[90:91], v32 offset:1408
    s_waitcnt lgkmcnt(10)
    v_mfma_f32_32x32x16_bf16 v[224:239], v[92:95], v[68:71], v[224:239]
    v_exp_f32 v72, v72
    v_exp_f32 v73, v73
    v_exp_f32 v74, v74
    v_exp_f32 v75, v75
    v_exp_f32 v76, v76
    v_exp_f32 v77, v77
    v_exp_f32 v78, v78
    v_exp_f32 v79, v79
    ds_read_b64_tr_b16 v[92:93], v32 offset:4864
    ds_read_b64_tr_b16 v[94:95], v32 offset:6016
    s_waitcnt lgkmcnt(10)
    v_mfma_f32_32x32x16_bf16 v[224:239], v[96:99], v[12:15], v[224:239]
    v_add_f32 v72, 1.0, v72
    v_add_f32 v73, 1.0, v73
    v_add_f32 v74, 1.0, v74
    v_add_f32 v75, 1.0, v75
    v_add_f32 v76, 1.0, v76
    v_add_f32 v77, 1.0, v77
    v_add_f32 v78, 1.0, v78
    v_add_f32 v79, 1.0, v79
    ds_read_b64_tr_b16 v[96:97], v32 offset:9472
    ds_read_b64_tr_b16 v[98:99], v32 offset:10624
    s_waitcnt lgkmcnt(10)
    v_mfma_f32_32x32x16_bf16 v[224:239], v[100:103], v[16:19], v[224:239]
    v_rcp_f32 v72, v72
    v_rcp_f32 v73, v73
    v_rcp_f32 v74, v74
    v_rcp_f32 v75, v75
    v_rcp_f32 v76, v76
    v_rcp_f32 v77, v77
    v_rcp_f32 v78, v78
    v_rcp_f32 v79, v79
    ds_read_b64_tr_b16 v[100:101], v32 offset:14080
    ds_read_b64_tr_b16 v[102:103], v32 offset:15232
    s_waitcnt lgkmcnt(10)
    v_mfma_f32_32x32x16_bf16 v[224:239], v[104:107], v[20:23], v[224:239]
    v_mul_f32 v208, v208, v72
    v_mul_f32 v209, v209, v73
    v_mul_f32 v210, v210, v74
    v_mul_f32 v211, v211, v75
    v_mul_f32 v212, v212, v76
    v_mul_f32 v213, v213, v77
    v_mul_f32 v214, v214, v78
    v_mul_f32 v215, v215, v79
    ds_read_b64_tr_b16 v[104:105], v33 offset:256
    ds_read_b64_tr_b16 v[106:107], v33 offset:1408
    s_waitcnt lgkmcnt(10)
    v_mfma_f32_32x32x16_bf16 v[224:239], v[108:111], v[24:27], v[224:239]
    v_cvt_pk_bf16_f32 v72, v208, v209
    v_cvt_pk_bf16_f32 v73, v210, v211
    v_cvt_pk_bf16_f32 v74, v212, v213
    v_cvt_pk_bf16_f32 v75, v214, v215
    v_lshlrev_b32 v208, 16, v72
    v_and_b32 v209, 0xffff0000, v72
    v_lshlrev_b32 v210, 16, v73
    v_and_b32 v211, 0xffff0000, v73
    ds_read_b64_tr_b16 v[108:109], v33 offset:4864
    ds_read_b64_tr_b16 v[110:111], v33 offset:6016
    s_waitcnt lgkmcnt(10)
    v_mfma_f32_32x32x16_bf16 v[240:255], v[88:91], v[40:43], v[240:255]
    v_lshlrev_b32 v212, 16, v74
    v_and_b32 v213, 0xffff0000, v74
    v_lshlrev_b32 v214, 16, v75
    v_and_b32 v215, 0xffff0000, v75
    v_mul_f32 v208, v208, v216
    v_mul_f32 v209, v209, v217
    v_mul_f32 v210, v210, v218
    v_mul_f32 v211, v211, v219
    ds_read_b64_tr_b16 v[88:89], v33 offset:9472
    ds_read_b64_tr_b16 v[90:91], v33 offset:10624
    s_waitcnt lgkmcnt(10)
    v_mfma_f32_32x32x16_bf16 v[240:255], v[92:95], v[44:47], v[240:255]
    v_mul_f32 v212, v212, v220
    v_mul_f32 v213, v213, v221
    v_mul_f32 v214, v214, v222
    v_mul_f32 v215, v215, v223
    v_cvt_pk_bf16_f32 v80, v208, v209
    v_cvt_pk_bf16_f32 v81, v210, v211
    v_cvt_pk_bf16_f32 v82, v212, v213
    v_cvt_pk_bf16_f32 v83, v214, v215
    ds_read_b64_tr_b16 v[92:93], v33 offset:14080
    ds_read_b64_tr_b16 v[94:95], v33 offset:15232
    s_waitcnt lgkmcnt(10)
    v_mfma_f32_32x32x16_bf16 v[240:255], v[96:99], v[48:51], v[240:255]
    buffer_store_dwordx4 v[80:83], v3, s[16:19], s22 offen offset:3072 sc1
    ds_read_b64_tr_b16 v[96:97], v30 offset:256
    ds_read_b64_tr_b16 v[98:99], v30 offset:1408
    s_waitcnt lgkmcnt(10)
    v_mfma_f32_32x32x16_bf16 v[240:255], v[100:103], v[52:55], v[240:255]
    v_cvt_pk_bf16_f32 v72, v224, v225
    v_cvt_pk_bf16_f32 v73, v226, v227
    v_cvt_pk_bf16_f32 v74, v228, v229
    v_cvt_pk_bf16_f32 v75, v230, v231
    v_cvt_pk_bf16_f32 v76, v232, v233
    v_cvt_pk_bf16_f32 v77, v234, v235
    v_cvt_pk_bf16_f32 v78, v236, v237
    v_cvt_pk_bf16_f32 v79, v238, v239
    ds_read_b64_tr_b16 v[100:101], v30 offset:4864
    ds_read_b64_tr_b16 v[102:103], v30 offset:6016
    s_waitcnt lgkmcnt(10)
    v_mfma_f32_32x32x16_bf16 v[240:255], v[104:107], v[56:59], v[240:255]
    v_lshlrev_b32 v224, 16, v72
    v_and_b32 v225, 0xffff0000, v72
    v_lshlrev_b32 v226, 16, v73
    v_and_b32 v227, 0xffff0000, v73
    v_lshlrev_b32 v228, 16, v74
    v_and_b32 v229, 0xffff0000, v74
    v_lshlrev_b32 v230, 16, v75
    v_and_b32 v231, 0xffff0000, v75
    ds_read_b64_tr_b16 v[104:105], v30 offset:9472
    ds_read_b64_tr_b16 v[106:107], v30 offset:10624
    s_waitcnt lgkmcnt(10)
    v_mfma_f32_32x32x16_bf16 v[240:255], v[108:111], v[60:63], v[240:255]
    v_lshlrev_b32 v232, 16, v76
    v_and_b32 v233, 0xffff0000, v76
    v_lshlrev_b32 v234, 16, v77
    v_and_b32 v235, 0xffff0000, v77
    v_lshlrev_b32 v236, 16, v78
    v_and_b32 v237, 0xffff0000, v78
    v_lshlrev_b32 v238, 16, v79
    v_and_b32 v239, 0xffff0000, v79
    ds_read_b64_tr_b16 v[108:109], v30 offset:14080
    ds_read_b64_tr_b16 v[110:111], v30 offset:15232
    s_waitcnt lgkmcnt(10)
    v_mfma_f32_32x32x16_bf16 v[240:255], v[88:91], v[64:67], v[240:255]
    v_mul_f32 v72, s54, v224
    v_mul_f32 v73, s54, v225
    v_mul_f32 v74, s54, v226
    v_mul_f32 v75, s54, v227
    v_mul_f32 v76, s54, v228
    v_mul_f32 v77, s54, v229
    v_mul_f32 v78, s54, v230
    v_mul_f32 v79, s54, v231
    s_waitcnt lgkmcnt(8)
    v_mfma_f32_32x32x16_bf16 v[240:255], v[92:95], v[68:71], v[240:255]
    v_exp_f32 v72, v72
    v_exp_f32 v73, v73
    v_exp_f32 v74, v74
    v_exp_f32 v75, v75
    v_exp_f32 v76, v76
    v_exp_f32 v77, v77
    v_exp_f32 v78, v78
    v_exp_f32 v79, v79
    s_waitcnt lgkmcnt(6)
    v_mfma_f32_32x32x16_bf16 v[240:255], v[96:99], v[12:15], v[240:255]
    v_add_f32 v72, 1.0, v72
    v_add_f32 v73, 1.0, v73
    v_add_f32 v74, 1.0, v74
    v_add_f32 v75, 1.0, v75
    v_add_f32 v76, 1.0, v76
    v_add_f32 v77, 1.0, v77
    v_add_f32 v78, 1.0, v78
    v_add_f32 v79, 1.0, v79
    s_waitcnt lgkmcnt(4)
    v_mfma_f32_32x32x16_bf16 v[240:255], v[100:103], v[16:19], v[240:255]
    v_rcp_f32 v72, v72
    v_rcp_f32 v73, v73
    v_rcp_f32 v74, v74
    v_rcp_f32 v75, v75
    v_rcp_f32 v76, v76
    v_rcp_f32 v77, v77
    v_rcp_f32 v78, v78
    v_rcp_f32 v79, v79
    s_waitcnt lgkmcnt(2)
    v_mfma_f32_32x32x16_bf16 v[240:255], v[104:107], v[20:23], v[240:255]
    v_mul_f32 v224, v224, v72
    v_mul_f32 v225, v225, v73
    v_mul_f32 v226, v226, v74
    v_mul_f32 v227, v227, v75
    v_mul_f32 v228, v228, v76
    v_mul_f32 v229, v229, v77
    v_mul_f32 v230, v230, v78
    v_mul_f32 v231, v231, v79
    s_waitcnt lgkmcnt(0)
    v_mfma_f32_32x32x16_bf16 v[240:255], v[108:111], v[24:27], v[240:255]
    v_cvt_pk_bf16_f32 v72, v224, v225
    v_cvt_pk_bf16_f32 v73, v226, v227
    v_cvt_pk_bf16_f32 v74, v228, v229
    v_cvt_pk_bf16_f32 v75, v230, v231
    v_lshlrev_b32 v224, 16, v72
    v_and_b32 v225, 0xffff0000, v72
    v_lshlrev_b32 v226, 16, v73
    v_and_b32 v227, 0xffff0000, v73
    v_lshlrev_b32 v228, 16, v74
    v_and_b32 v229, 0xffff0000, v74
    v_lshlrev_b32 v230, 16, v75
    v_and_b32 v231, 0xffff0000, v75
    v_mul_f32 v224, v224, v232
    v_mul_f32 v225, v225, v233
    v_mul_f32 v226, v226, v234
    v_mul_f32 v227, v227, v235
    v_mul_f32 v228, v228, v236
    v_mul_f32 v229, v229, v237
    v_mul_f32 v230, v230, v238
    v_mul_f32 v231, v231, v239
    v_cvt_pk_bf16_f32 v84, v224, v225
    v_cvt_pk_bf16_f32 v85, v226, v227
    v_cvt_pk_bf16_f32 v86, v228, v229
    v_cvt_pk_bf16_f32 v87, v230, v231
    buffer_store_dwordx4 v[84:87], v3, s[16:19], s22 offen offset:3584 sc1
    s_nop 7
    s_nop 3
    v_cvt_pk_bf16_f32 v72, v240, v241
    v_cvt_pk_bf16_f32 v73, v242, v243
    v_cvt_pk_bf16_f32 v74, v244, v245
    v_cvt_pk_bf16_f32 v75, v246, v247
    v_cvt_pk_bf16_f32 v76, v248, v249
    v_cvt_pk_bf16_f32 v77, v250, v251
    v_cvt_pk_bf16_f32 v78, v252, v253
    v_cvt_pk_bf16_f32 v79, v254, v255
    v_lshlrev_b32 v240, 16, v72
    v_and_b32 v241, 0xffff0000, v72
    v_lshlrev_b32 v242, 16, v73
    v_and_b32 v243, 0xffff0000, v73
    v_lshlrev_b32 v244, 16, v74
    v_and_b32 v245, 0xffff0000, v74
    v_lshlrev_b32 v246, 16, v75
    v_and_b32 v247, 0xffff0000, v75
    v_lshlrev_b32 v248, 16, v76
    v_and_b32 v249, 0xffff0000, v76
    v_lshlrev_b32 v250, 16, v77
    v_and_b32 v251, 0xffff0000, v77
    v_lshlrev_b32 v252, 16, v78
    v_and_b32 v253, 0xffff0000, v78
    v_lshlrev_b32 v254, 16, v79
    v_and_b32 v255, 0xffff0000, v79
    v_mul_f32 v72, s54, v240
    v_mul_f32 v73, s54, v241
    v_mul_f32 v74, s54, v242
    v_mul_f32 v75, s54, v243
    v_mul_f32 v76, s54, v244
    v_mul_f32 v77, s54, v245
    v_mul_f32 v78, s54, v246
    v_mul_f32 v79, s54, v247
    v_exp_f32 v72, v72
    v_exp_f32 v73, v73
    v_exp_f32 v74, v74
    v_exp_f32 v75, v75
    v_exp_f32 v76, v76
    v_exp_f32 v77, v77
    v_exp_f32 v78, v78
    v_exp_f32 v79, v79
    v_add_f32 v72, 1.0, v72
    v_add_f32 v73, 1.0, v73
    v_add_f32 v74, 1.0, v74
    v_add_f32 v75, 1.0, v75
    v_add_f32 v76, 1.0, v76
    v_add_f32 v77, 1.0, v77
    v_add_f32 v78, 1.0, v78
    v_add_f32 v79, 1.0, v79
    v_rcp_f32 v72, v72
    v_rcp_f32 v73, v73
    v_rcp_f32 v74, v74
    v_rcp_f32 v75, v75
    v_rcp_f32 v76, v76
    v_rcp_f32 v77, v77
    v_rcp_f32 v78, v78
    v_rcp_f32 v79, v79
    v_mul_f32 v240, v240, v72
    v_mul_f32 v241, v241, v73
    v_mul_f32 v242, v242, v74
    v_mul_f32 v243, v243, v75
    v_mul_f32 v244, v244, v76
    v_mul_f32 v245, v245, v77
    v_mul_f32 v246, v246, v78
    v_mul_f32 v247, v247, v79
    v_cvt_pk_bf16_f32 v72, v240, v241
    v_cvt_pk_bf16_f32 v73, v242, v243
    v_cvt_pk_bf16_f32 v74, v244, v245
    v_cvt_pk_bf16_f32 v75, v246, v247
    v_lshlrev_b32 v240, 16, v72
    v_and_b32 v241, 0xffff0000, v72
    v_lshlrev_b32 v242, 16, v73
    v_and_b32 v243, 0xffff0000, v73
    v_lshlrev_b32 v244, 16, v74
    v_and_b32 v245, 0xffff0000, v74
    v_lshlrev_b32 v246, 16, v75
    v_and_b32 v247, 0xffff0000, v75
    v_mul_f32 v240, v240, v248
    v_mul_f32 v241, v241, v249
    v_mul_f32 v242, v242, v250
    v_mul_f32 v243, v243, v251
    v_mul_f32 v244, v244, v252
    v_mul_f32 v245, v245, v253
    v_mul_f32 v246, v246, v254
    v_mul_f32 v247, v247, v255
    v_cvt_pk_bf16_f32 v80, v240, v241
    v_cvt_pk_bf16_f32 v81, v242, v243
    v_cvt_pk_bf16_f32 v82, v244, v245
    v_cvt_pk_bf16_f32 v83, v246, v247
    buffer_store_dwordx4 v[80:83], v3, s[16:19], s23 offen sc1
    s_load_dwordx4 s[4:7], s[0:1], 96
    s_load_dwordx2 s[24:25], s[0:1], 120
    s_load_dwordx2 s[46:47], s[0:1], 96
    s_load_dwordx2 s[54:55], s[0:1], 0
    s_load_dwordx2 s[40:41], s[0:1], 64
    v_lshrrev_b32 v2, 6, v0
    v_and_b32 v1, 63, v0
    s_mov_b32 s36, 0xe38f
    v_readfirstlane_b32 s3, v2
    s_and_b32 s26, s2, 7
    s_lshr_b32 s27, s2, 3
    s_mov_b32 s37, 1152

    v_add_u32 v3, 0, v1
    v_mul_lo_u32 v4, v3, s36
    v_lshrrev_b32 v4, 20, v4
    v_mul_u32_u24 v5, 18, v4
    v_sub_u32 v5, v3, v5
    v_mul_lo_u32 v4, v4, s37
    v_lshl_add_u32 v4, v5, 4, v4
    v_subrev_u32 v34, 0, v4

    v_add_u32 v3, 32, v1
    v_mul_lo_u32 v4, v3, s36
    v_lshrrev_b32 v4, 20, v4
    v_mul_u32_u24 v5, 18, v4
    v_sub_u32 v5, v3, v5
    v_mul_lo_u32 v4, v4, s37
    v_lshl_add_u32 v4, v5, 4, v4
    v_subrev_u32 v35, 512, v4

    v_add_u32 v3, 96, v1
    v_mul_lo_u32 v4, v3, s36
    v_lshrrev_b32 v4, 20, v4
    v_mul_u32_u24 v5, 18, v4
    v_sub_u32 v5, v3, v5
    v_mul_lo_u32 v4, v4, s37
    v_lshl_add_u32 v4, v5, 4, v4
    v_subrev_u32 v36, 1536, v4

    v_add_u32 v3, 160, v1
    v_mul_lo_u32 v4, v3, s36
    v_lshrrev_b32 v4, 20, v4
    v_mul_u32_u24 v5, 18, v4
    v_sub_u32 v5, v3, v5
    v_mul_lo_u32 v4, v4, s37
    v_lshl_add_u32 v4, v5, 4, v4
    v_subrev_u32 v37, 2560, v4

    v_add_u32 v3, 224, v1
    v_mul_lo_u32 v4, v3, s36
    v_lshrrev_b32 v4, 20, v4
    v_mul_u32_u24 v5, 18, v4
    v_sub_u32 v5, v3, v5
    v_mul_lo_u32 v4, v4, s37
    v_lshl_add_u32 v4, v5, 4, v4
    v_subrev_u32 v38, 3584, v4

    v_lshlrev_b32 v39, 4, v1
    s_lshr_b32 s32, s26, 1
    s_and_b32 s29, s26, 1
    s_lshl_b32 s29, s29, 3
    s_lshr_b32 s30, s27, 2
    s_add_u32 s29, s29, s30
    s_and_b32 s28, s27, 3
    s_lshl_b32 s42, s28, 1
    s_add_u32 s42, s42, s30
    s_cmp_ge_u32 s42, 9
    s_cselect_b32 s43, 9, 0
    s_sub_u32 s42, s42, s43
    s_mul_i32 s30, s32, 1152
    s_lshl_b32 s31, s3, 4
    s_add_u32 s30, s30, s31
    s_mul_i32 s30, s30, 1152
    s_mul_i32 s31, s28, 288
    s_add_u32 s20, s30, s31
    s_and_b32 s33, s3, 3
    s_lshr_b32 s34, s3, 2
    s_lshl_b32 s30, s29, 3
    s_lshl_b32 s31, s33, 1
    s_add_u32 s30, s30, s31
    s_mul_i32 s31, s30, 144
    s_mul_i32 s35, s32, 36
    s_add_u32 s31, s31, s35
    s_add_u32 s31, s31, s34
    s_lshl_b32 s22, s31, 10
    s_add_u32 s23, s22, 147456
    s_mul_i32 s21, s3, 4608
    v_lshrrev_b32 v3, 5, v1
    v_lshlrev_b32 v3, 4, v3
    v_bfe_u32 v4, v1, 2, 3
    v_add_u32 v3, v3, v4
    v_mul_u32_u24 v3, 288, v3
    v_and_b32 v4, 3, v1
    v_lshl_add_u32 v3, v4, 3, v3
    s_mul_i32 s38, s34, 9216
    v_add_u32 v30, s38, v3

    v_add_u32 v31, 36864, v30
    v_add_u32 v32, 36864, v31
    v_add_u32 v33, 36864, v32
    s_mul_i32 s43, s42, 147456
    s_add_u32 s20, s20, s43
    s_mul_i32 s43, s42, 4096
    s_add_u32 s22, s22, s43
    s_add_u32 s23, s23, s43
    s_mov_b32 s52, 147456
    s_mov_b32 s53, 4096
    s_mov_b32 s44, s42
    s_mov_b32 s45, s42
    s_waitcnt lgkmcnt(0)

    s_mov_b32 s8, s4
    s_mov_b32 s9, s5
    s_mov_b32 s10, 0x510000
    s_mov_b32 s11, 0x20000
    s_add_u32 s12, s24, 0xb40000
    s_addc_u32 s13, s25, 0
    s_mov_b32 s14, 0x1200000
    s_mov_b32 s15, 0x20000
    s_add_u32 s16, s24, 0x1d40000
    s_addc_u32 s17, s25, 0
    s_mov_b32 s18, 0x1200000
    s_mov_b32 s19, 0x20000
    s_add_u32 s48, s24, 0x2f40000
    s_addc_u32 s49, s25, 0
    s_mov_b32 s50, 0x20000
    s_mov_b32 s51, 0x20000
    s_lshr_b32 s54, s27, 3
    s_lshl_b32 s54, s54, 3
    s_add_u32 s54, s54, s26
    s_lshl_b32 s54, s54, 7
    s_add_u32 s54, s54, 16384
    v_mov_b32 v6, 0
    v_mov_b32 v7, 1
    s_waitcnt vmcnt(0)
    s_barrier
    s_mov_b64 exec, 1
    s_cmp_lg_u32 s3, 0
    s_cbranch_scc1 G2F_noat

    buffer_atomic_add v7, v6, s[48:51], s54 offen sc1

G2F_noat:
    s_mov_b64 exec, -1
    s_add_u32 s39, s21, 0
    s_mov_b32 m0, s39
    s_mov_b64 exec, 0xffffffff
    buffer_load_dwordx4 v34, s[8:11], s20 offen lds
    s_mov_b64 exec, -1
    buffer_load_dwordx4 v35, s[8:11], s20 offen offset:512 lds
    buffer_load_dwordx4 v36, s[8:11], s20 offen offset:1536 lds
    buffer_load_dwordx4 v37, s[8:11], s20 offen offset:2560 lds
    buffer_load_dwordx4 v38, s[8:11], s20 offen offset:3584 lds
    s_add_u32 s44, s44, 1
    s_cmp_eq_u32 s44, 9
    s_cselect_b32 s43, 0xffee0000, s52
    s_add_u32 s20, s20, s43
    s_add_u32 s39, s21, 36864
    s_mov_b32 m0, s39
    s_mov_b64 exec, 0xffffffff
    buffer_load_dwordx4 v34, s[8:11], s20 offen lds
    s_mov_b64 exec, -1
    buffer_load_dwordx4 v35, s[8:11], s20 offen offset:512 lds
    buffer_load_dwordx4 v36, s[8:11], s20 offen offset:1536 lds
    buffer_load_dwordx4 v37, s[8:11], s20 offen offset:2560 lds
    buffer_load_dwordx4 v38, s[8:11], s20 offen offset:3584 lds
    s_add_u32 s44, s44, 1
    s_cmp_eq_u32 s44, 9
    s_cselect_b32 s43, 0xffee0000, s52
    s_add_u32 s20, s20, s43
    s_add_u32 s39, s21, 73728
    s_mov_b32 m0, s39
    s_mov_b64 exec, 0xffffffff
    buffer_load_dwordx4 v34, s[8:11], s20 offen lds
    s_mov_b64 exec, -1
    buffer_load_dwordx4 v35, s[8:11], s20 offen offset:512 lds
    buffer_load_dwordx4 v36, s[8:11], s20 offen offset:1536 lds
    buffer_load_dwordx4 v37, s[8:11], s20 offen offset:2560 lds
    buffer_load_dwordx4 v38, s[8:11], s20 offen offset:3584 lds
    s_add_u32 s44, s44, 1
    s_cmp_eq_u32 s44, 9
    s_cselect_b32 s43, 0xffee0000, s52
    s_add_u32 s20, s20, s43
    s_cmp_lg_u32 s3, 0
    s_cbranch_scc1 G2F_go
    s_mov_b64 exec, 1
    s_mov_b32 s39, 0

G2F_poll:
    s_sleep 2
    buffer_load_dword v7, v6, s[48:51], s54 offen sc1
    s_waitcnt vmcnt(0)
    v_readfirstlane_b32 s55, v7
    s_add_u32 s39, s39, 1
    s_lshr_b32 s56, s39, 17
    s_add_u32 s55, s55, s56
    s_cmp_lt_u32 s55, 8
    s_cbranch_scc1 G2F_poll
    s_mov_b64 exec, -1

G2F_go:
    s_waitcnt vmcnt(0)
    s_barrier
    buffer_load_dwordx4 v[40:43], v39, s[12:15], s22 offen offset:0 sc1
    buffer_load_dwordx4 v[44:47], v39, s[12:15], s23 offen offset:0 sc1
    buffer_load_dwordx4 v[48:51], v39, s[12:15], s22 offen offset:2048 sc1
    buffer_load_dwordx4 v[52:55], v39, s[12:15], s23 offen offset:2048 sc1
    s_add_u32 s45, s45, 1
    s_cmp_eq_u32 s45, 9
    s_cselect_b32 s43, 0xffff8000, s53
    s_add_u32 s22, s22, s43
    s_add_u32 s23, s23, s43
    buffer_load_dwordx4 v[56:59], v39, s[12:15], s22 offen offset:0 sc1
    buffer_load_dwordx4 v[60:63], v39, s[12:15], s23 offen offset:0 sc1
    buffer_load_dwordx4 v[64:67], v39, s[12:15], s22 offen offset:2048 sc1
    buffer_load_dwordx4 v[68:71], v39, s[12:15], s23 offen offset:2048 sc1
    s_add_u32 s45, s45, 1
    s_cmp_eq_u32 s45, 9
    s_cselect_b32 s43, 0xffff8000, s53
    s_add_u32 s22, s22, s43
    s_add_u32 s23, s23, s43
    buffer_load_dwordx4 v[72:75], v39, s[12:15], s22 offen offset:0 sc1
    buffer_load_dwordx4 v[76:79], v39, s[12:15], s23 offen offset:0 sc1
    buffer_load_dwordx4 v[80:83], v39, s[12:15], s22 offen offset:2048 sc1
    buffer_load_dwordx4 v[84:87], v39, s[12:15], s23 offen offset:2048 sc1
    s_add_u32 s45, s45, 1
    s_cmp_eq_u32 s45, 9
    s_cselect_b32 s43, 0xffff8000, s53
    s_add_u32 s22, s22, s43
    s_add_u32 s23, s23, s43
    v_mov_b32 v128, 0
    v_mov_b32 v129, 0
    v_mov_b32 v130, 0
    v_mov_b32 v131, 0
    v_mov_b32 v132, 0
    v_mov_b32 v133, 0
    v_mov_b32 v134, 0
    v_mov_b32 v135, 0
    v_mov_b32 v136, 0
    v_mov_b32 v137, 0
    v_mov_b32 v138, 0
    v_mov_b32 v139, 0
    v_mov_b32 v140, 0
    v_mov_b32 v141, 0
    v_mov_b32 v142, 0
    v_mov_b32 v143, 0
    v_mov_b32 v144, 0
    v_mov_b32 v145, 0
    v_mov_b32 v146, 0
    v_mov_b32 v147, 0
    v_mov_b32 v148, 0
    v_mov_b32 v149, 0
    v_mov_b32 v150, 0
    v_mov_b32 v151, 0
    v_mov_b32 v152, 0
    v_mov_b32 v153, 0
    v_mov_b32 v154, 0
    v_mov_b32 v155, 0
    v_mov_b32 v156, 0
    v_mov_b32 v157, 0
    v_mov_b32 v158, 0
    v_mov_b32 v159, 0
    v_mov_b32 v160, 0
    v_mov_b32 v161, 0
    v_mov_b32 v162, 0
    v_mov_b32 v163, 0
    v_mov_b32 v164, 0
    v_mov_b32 v165, 0
    v_mov_b32 v166, 0
    v_mov_b32 v167, 0
    v_mov_b32 v168, 0
    v_mov_b32 v169, 0
    v_mov_b32 v170, 0
    v_mov_b32 v171, 0
    v_mov_b32 v172, 0
    v_mov_b32 v173, 0
    v_mov_b32 v174, 0
    v_mov_b32 v175, 0
    v_mov_b32 v176, 0
    v_mov_b32 v177, 0
    v_mov_b32 v178, 0
    v_mov_b32 v179, 0
    v_mov_b32 v180, 0
    v_mov_b32 v181, 0
    v_mov_b32 v182, 0
    v_mov_b32 v183, 0
    v_mov_b32 v184, 0
    v_mov_b32 v185, 0
    v_mov_b32 v186, 0
    v_mov_b32 v187, 0
    v_mov_b32 v188, 0
    v_mov_b32 v189, 0
    v_mov_b32 v190, 0
    v_mov_b32 v191, 0
    v_mov_b32 v192, 0
    v_mov_b32 v193, 0
    v_mov_b32 v194, 0
    v_mov_b32 v195, 0
    v_mov_b32 v196, 0
    v_mov_b32 v197, 0
    v_mov_b32 v198, 0
    v_mov_b32 v199, 0
    s_waitcnt vmcnt(8)
    s_barrier
    ds_read_b64_tr_b16 v[104:105], v30 offset:0
    ds_read_b64_tr_b16 v[106:107], v30 offset:2304
    ds_read_b64_tr_b16 v[108:109], v30 offset:32
    ds_read_b64_tr_b16 v[110:111], v30 offset:2336
    ds_read_b64_tr_b16 v[112:113], v30 offset:64
    ds_read_b64_tr_b16 v[114:115], v30 offset:2368
    ds_read_b64_tr_b16 v[116:117], v30 offset:96
    ds_read_b64_tr_b16 v[118:119], v30 offset:2400
    ds_read_b64_tr_b16 v[120:121], v30 offset:128
    ds_read_b64_tr_b16 v[122:123], v30 offset:2432
    ds_read_b64_tr_b16 v[124:125], v30 offset:160
    ds_read_b64_tr_b16 v[126:127], v30 offset:2464
    s_waitcnt lgkmcnt(10)
    v_mfma_f32_16x16x32_bf16 v[128:131], v[104:107], v[40:43], v[128:131]
    v_mfma_f32_16x16x32_bf16 v[132:135], v[104:107], v[44:47], v[132:135]
    s_add_u32 s39, s21, 110592
    s_mov_b32 m0, s39
    s_mov_b64 exec, 0xffffffff
    buffer_load_dwordx4 v34, s[8:11], s20 offen lds
    s_mov_b64 exec, -1
    ds_read_b64_tr_b16 v[104:105], v30 offset:192
    ds_read_b64_tr_b16 v[106:107], v30 offset:2496
    s_waitcnt lgkmcnt(10)
    v_mfma_f32_16x16x32_bf16 v[136:139], v[108:111], v[40:43], v[136:139]
    v_mfma_f32_16x16x32_bf16 v[140:143], v[108:111], v[44:47], v[140:143]
    ds_read_b64_tr_b16 v[108:109], v30 offset:224
    ds_read_b64_tr_b16 v[110:111], v30 offset:2528
    s_waitcnt lgkmcnt(10)
    v_mfma_f32_16x16x32_bf16 v[144:147], v[112:115], v[40:43], v[144:147]
    v_mfma_f32_16x16x32_bf16 v[148:151], v[112:115], v[44:47], v[148:151]
    buffer_load_dwordx4 v35, s[8:11], s20 offen offset:512 lds
    ds_read_b64_tr_b16 v[112:113], v30 offset:256
    ds_read_b64_tr_b16 v[114:115], v30 offset:2560
    s_waitcnt lgkmcnt(10)
    v_mfma_f32_16x16x32_bf16 v[152:155], v[116:119], v[40:43], v[152:155]
    v_mfma_f32_16x16x32_bf16 v[156:159], v[116:119], v[44:47], v[156:159]
    ds_read_b64_tr_b16 v[116:117], v30 offset:18432
    ds_read_b64_tr_b16 v[118:119], v30 offset:20736
    s_waitcnt lgkmcnt(10)
    v_mfma_f32_16x16x32_bf16 v[160:163], v[120:123], v[40:43], v[160:163]
    v_mfma_f32_16x16x32_bf16 v[164:167], v[120:123], v[44:47], v[164:167]
    buffer_load_dwordx4 v36, s[8:11], s20 offen offset:1536 lds
    ds_read_b64_tr_b16 v[120:121], v30 offset:18464
    ds_read_b64_tr_b16 v[122:123], v30 offset:20768
    s_waitcnt lgkmcnt(10)
    v_mfma_f32_16x16x32_bf16 v[168:171], v[124:127], v[40:43], v[168:171]
    v_mfma_f32_16x16x32_bf16 v[172:175], v[124:127], v[44:47], v[172:175]
    buffer_load_dwordx4 v37, s[8:11], s20 offen offset:2560 lds
    ds_read_b64_tr_b16 v[124:125], v30 offset:18496
    ds_read_b64_tr_b16 v[126:127], v30 offset:20800
    s_waitcnt lgkmcnt(10)
    v_mfma_f32_16x16x32_bf16 v[176:179], v[104:107], v[40:43], v[176:179]
    v_mfma_f32_16x16x32_bf16 v[180:183], v[104:107], v[44:47], v[180:183]
    ds_read_b64_tr_b16 v[104:105], v30 offset:18528
    ds_read_b64_tr_b16 v[106:107], v30 offset:20832
    s_waitcnt lgkmcnt(10)
    v_mfma_f32_16x16x32_bf16 v[184:187], v[108:111], v[40:43], v[184:187]
    v_mfma_f32_16x16x32_bf16 v[188:191], v[108:111], v[44:47], v[188:191]
    buffer_load_dwordx4 v38, s[8:11], s20 offen offset:3584 lds
    s_add_u32 s44, s44, 1
    s_cmp_eq_u32 s44, 9
    s_cselect_b32 s43, 0xffee0000, s52
    s_add_u32 s20, s20, s43
    ds_read_b64_tr_b16 v[108:109], v30 offset:18560
    ds_read_b64_tr_b16 v[110:111], v30 offset:20864
    s_waitcnt lgkmcnt(10)
    v_mfma_f32_16x16x32_bf16 v[192:195], v[112:115], v[40:43], v[192:195]
    v_mfma_f32_16x16x32_bf16 v[196:199], v[112:115], v[44:47], v[196:199]
    ds_read_b64_tr_b16 v[112:113], v30 offset:18592
    ds_read_b64_tr_b16 v[114:115], v30 offset:20896
    s_waitcnt lgkmcnt(10)
    v_mfma_f32_16x16x32_bf16 v[128:131], v[116:119], v[48:51], v[128:131]
    v_mfma_f32_16x16x32_bf16 v[132:135], v[116:119], v[52:55], v[132:135]
    buffer_load_dwordx4 v[88:91], v39, s[12:15], s22 offen offset:0 sc1
    ds_read_b64_tr_b16 v[116:117], v30 offset:18624
    ds_read_b64_tr_b16 v[118:119], v30 offset:20928
    s_waitcnt lgkmcnt(10)
    v_mfma_f32_16x16x32_bf16 v[136:139], v[120:123], v[48:51], v[136:139]
    v_mfma_f32_16x16x32_bf16 v[140:143], v[120:123], v[52:55], v[140:143]
    ds_read_b64_tr_b16 v[120:121], v30 offset:18656
    ds_read_b64_tr_b16 v[122:123], v30 offset:20960
    s_waitcnt lgkmcnt(10)
    v_mfma_f32_16x16x32_bf16 v[144:147], v[124:127], v[48:51], v[144:147]
    v_mfma_f32_16x16x32_bf16 v[148:151], v[124:127], v[52:55], v[148:151]
    buffer_load_dwordx4 v[92:95], v39, s[12:15], s23 offen offset:0 sc1
    ds_read_b64_tr_b16 v[124:125], v30 offset:18688
    ds_read_b64_tr_b16 v[126:127], v30 offset:20992
    s_waitcnt lgkmcnt(10)
    v_mfma_f32_16x16x32_bf16 v[152:155], v[104:107], v[48:51], v[152:155]
    v_mfma_f32_16x16x32_bf16 v[156:159], v[104:107], v[52:55], v[156:159]
    buffer_load_dwordx4 v[96:99], v39, s[12:15], s22 offen offset:2048 sc1
    ds_read_b64_tr_b16 v[104:105], v31 offset:0
    ds_read_b64_tr_b16 v[106:107], v31 offset:2304
    s_waitcnt lgkmcnt(10)
    v_mfma_f32_16x16x32_bf16 v[160:163], v[108:111], v[48:51], v[160:163]
    v_mfma_f32_16x16x32_bf16 v[164:167], v[108:111], v[52:55], v[164:167]
    ds_read_b64_tr_b16 v[108:109], v31 offset:32
    ds_read_b64_tr_b16 v[110:111], v31 offset:2336
    s_waitcnt lgkmcnt(10)
    v_mfma_f32_16x16x32_bf16 v[168:171], v[112:115], v[48:51], v[168:171]
    v_mfma_f32_16x16x32_bf16 v[172:175], v[112:115], v[52:55], v[172:175]
    buffer_load_dwordx4 v[100:103], v39, s[12:15], s23 offen offset:2048 sc1
    s_add_u32 s45, s45, 1
    s_cmp_eq_u32 s45, 9
    s_cselect_b32 s43, 0xffff8000, s53
    s_add_u32 s22, s22, s43
    s_add_u32 s23, s23, s43
    ds_read_b64_tr_b16 v[112:113], v31 offset:64
    ds_read_b64_tr_b16 v[114:115], v31 offset:2368
    s_waitcnt lgkmcnt(10)
    v_mfma_f32_16x16x32_bf16 v[176:179], v[116:119], v[48:51], v[176:179]
    v_mfma_f32_16x16x32_bf16 v[180:183], v[116:119], v[52:55], v[180:183]
    ds_read_b64_tr_b16 v[116:117], v31 offset:96
    ds_read_b64_tr_b16 v[118:119], v31 offset:2400
    s_waitcnt lgkmcnt(10)
    v_mfma_f32_16x16x32_bf16 v[184:187], v[120:123], v[48:51], v[184:187]
    v_mfma_f32_16x16x32_bf16 v[188:191], v[120:123], v[52:55], v[188:191]
    ds_read_b64_tr_b16 v[120:121], v31 offset:128
    ds_read_b64_tr_b16 v[122:123], v31 offset:2432
    s_waitcnt lgkmcnt(10)
    v_mfma_f32_16x16x32_bf16 v[192:195], v[124:127], v[48:51], v[192:195]
    v_mfma_f32_16x16x32_bf16 v[196:199], v[124:127], v[52:55], v[196:199]
    s_waitcnt vmcnt(13)
    s_barrier
    ds_read_b64_tr_b16 v[124:125], v31 offset:160
    ds_read_b64_tr_b16 v[126:127], v31 offset:2464
    s_waitcnt lgkmcnt(10)
    v_mfma_f32_16x16x32_bf16 v[128:131], v[104:107], v[56:59], v[128:131]
    v_mfma_f32_16x16x32_bf16 v[132:135], v[104:107], v[60:63], v[132:135]
    s_add_u32 s39, s21, 0
    s_mov_b32 m0, s39
    s_mov_b64 exec, 0xffffffff
    buffer_load_dwordx4 v34, s[8:11], s20 offen lds
    s_mov_b64 exec, -1
    ds_read_b64_tr_b16 v[104:105], v31 offset:192
    ds_read_b64_tr_b16 v[106:107], v31 offset:2496
    s_waitcnt lgkmcnt(10)
    v_mfma_f32_16x16x32_bf16 v[136:139], v[108:111], v[56:59], v[136:139]
    v_mfma_f32_16x16x32_bf16 v[140:143], v[108:111], v[60:63], v[140:143]
    ds_read_b64_tr_b16 v[108:109], v31 offset:224
    ds_read_b64_tr_b16 v[110:111], v31 offset:2528
    s_waitcnt lgkmcnt(10)
    v_mfma_f32_16x16x32_bf16 v[144:147], v[112:115], v[56:59], v[144:147]
    v_mfma_f32_16x16x32_bf16 v[148:151], v[112:115], v[60:63], v[148:151]
    buffer_load_dwordx4 v35, s[8:11], s20 offen offset:512 lds
    ds_read_b64_tr_b16 v[112:113], v31 offset:256
    ds_read_b64_tr_b16 v[114:115], v31 offset:2560
    s_waitcnt lgkmcnt(10)
    v_mfma_f32_16x16x32_bf16 v[152:155], v[116:119], v[56:59], v[152:155]
    v_mfma_f32_16x16x32_bf16 v[156:159], v[116:119], v[60:63], v[156:159]
    ds_read_b64_tr_b16 v[116:117], v31 offset:18432
    ds_read_b64_tr_b16 v[118:119], v31 offset:20736
    s_waitcnt lgkmcnt(10)
    v_mfma_f32_16x16x32_bf16 v[160:163], v[120:123], v[56:59], v[160:163]
    v_mfma_f32_16x16x32_bf16 v[164:167], v[120:123], v[60:63], v[164:167]
    buffer_load_dwordx4 v36, s[8:11], s20 offen offset:1536 lds
    ds_read_b64_tr_b16 v[120:121], v31 offset:18464
    ds_read_b64_tr_b16 v[122:123], v31 offset:20768
    s_waitcnt lgkmcnt(10)
    v_mfma_f32_16x16x32_bf16 v[168:171], v[124:127], v[56:59], v[168:171]
    v_mfma_f32_16x16x32_bf16 v[172:175], v[124:127], v[60:63], v[172:175]
    buffer_load_dwordx4 v37, s[8:11], s20 offen offset:2560 lds
    ds_read_b64_tr_b16 v[124:125], v31 offset:18496
    ds_read_b64_tr_b16 v[126:127], v31 offset:20800
    s_waitcnt lgkmcnt(10)
    v_mfma_f32_16x16x32_bf16 v[176:179], v[104:107], v[56:59], v[176:179]
    v_mfma_f32_16x16x32_bf16 v[180:183], v[104:107], v[60:63], v[180:183]
    ds_read_b64_tr_b16 v[104:105], v31 offset:18528
    ds_read_b64_tr_b16 v[106:107], v31 offset:20832
    s_waitcnt lgkmcnt(10)
    v_mfma_f32_16x16x32_bf16 v[184:187], v[108:111], v[56:59], v[184:187]
    v_mfma_f32_16x16x32_bf16 v[188:191], v[108:111], v[60:63], v[188:191]
    buffer_load_dwordx4 v38, s[8:11], s20 offen offset:3584 lds
    s_add_u32 s44, s44, 1
    s_cmp_eq_u32 s44, 9
    s_cselect_b32 s43, 0xffee0000, s52
    s_add_u32 s20, s20, s43
    ds_read_b64_tr_b16 v[108:109], v31 offset:18560
    ds_read_b64_tr_b16 v[110:111], v31 offset:20864
    s_waitcnt lgkmcnt(10)
    v_mfma_f32_16x16x32_bf16 v[192:195], v[112:115], v[56:59], v[192:195]
    v_mfma_f32_16x16x32_bf16 v[196:199], v[112:115], v[60:63], v[196:199]
    ds_read_b64_tr_b16 v[112:113], v31 offset:18592
    ds_read_b64_tr_b16 v[114:115], v31 offset:20896
    s_waitcnt lgkmcnt(10)
    v_mfma_f32_16x16x32_bf16 v[128:131], v[116:119], v[64:67], v[128:131]
    v_mfma_f32_16x16x32_bf16 v[132:135], v[116:119], v[68:71], v[132:135]
    buffer_load_dwordx4 v[40:43], v39, s[12:15], s22 offen offset:0 sc1
    ds_read_b64_tr_b16 v[116:117], v31 offset:18624
    ds_read_b64_tr_b16 v[118:119], v31 offset:20928
    s_waitcnt lgkmcnt(10)
    v_mfma_f32_16x16x32_bf16 v[136:139], v[120:123], v[64:67], v[136:139]
    v_mfma_f32_16x16x32_bf16 v[140:143], v[120:123], v[68:71], v[140:143]
    ds_read_b64_tr_b16 v[120:121], v31 offset:18656
    ds_read_b64_tr_b16 v[122:123], v31 offset:20960
    s_waitcnt lgkmcnt(10)
    v_mfma_f32_16x16x32_bf16 v[144:147], v[124:127], v[64:67], v[144:147]
    v_mfma_f32_16x16x32_bf16 v[148:151], v[124:127], v[68:71], v[148:151]
    buffer_load_dwordx4 v[44:47], v39, s[12:15], s23 offen offset:0 sc1
    ds_read_b64_tr_b16 v[124:125], v31 offset:18688
    ds_read_b64_tr_b16 v[126:127], v31 offset:20992
    s_waitcnt lgkmcnt(10)
    v_mfma_f32_16x16x32_bf16 v[152:155], v[104:107], v[64:67], v[152:155]
    v_mfma_f32_16x16x32_bf16 v[156:159], v[104:107], v[68:71], v[156:159]
    buffer_load_dwordx4 v[48:51], v39, s[12:15], s22 offen offset:2048 sc1
    ds_read_b64_tr_b16 v[104:105], v32 offset:0
    ds_read_b64_tr_b16 v[106:107], v32 offset:2304
    s_waitcnt lgkmcnt(10)
    v_mfma_f32_16x16x32_bf16 v[160:163], v[108:111], v[64:67], v[160:163]
    v_mfma_f32_16x16x32_bf16 v[164:167], v[108:111], v[68:71], v[164:167]
    ds_read_b64_tr_b16 v[108:109], v32 offset:32
    ds_read_b64_tr_b16 v[110:111], v32 offset:2336
    s_waitcnt lgkmcnt(10)
    v_mfma_f32_16x16x32_bf16 v[168:171], v[112:115], v[64:67], v[168:171]
    v_mfma_f32_16x16x32_bf16 v[172:175], v[112:115], v[68:71], v[172:175]
    buffer_load_dwordx4 v[52:55], v39, s[12:15], s23 offen offset:2048 sc1
    s_add_u32 s45, s45, 1
    s_cmp_eq_u32 s45, 9
    s_cselect_b32 s43, 0xffff8000, s53
    s_add_u32 s22, s22, s43
    s_add_u32 s23, s23, s43
    ds_read_b64_tr_b16 v[112:113], v32 offset:64
    ds_read_b64_tr_b16 v[114:115], v32 offset:2368
    s_waitcnt lgkmcnt(10)
    v_mfma_f32_16x16x32_bf16 v[176:179], v[116:119], v[64:67], v[176:179]
    v_mfma_f32_16x16x32_bf16 v[180:183], v[116:119], v[68:71], v[180:183]
    ds_read_b64_tr_b16 v[116:117], v32 offset:96
    ds_read_b64_tr_b16 v[118:119], v32 offset:2400
    s_waitcnt lgkmcnt(10)
    v_mfma_f32_16x16x32_bf16 v[184:187], v[120:123], v[64:67], v[184:187]
    v_mfma_f32_16x16x32_bf16 v[188:191], v[120:123], v[68:71], v[188:191]
    ds_read_b64_tr_b16 v[120:121], v32 offset:128
    ds_read_b64_tr_b16 v[122:123], v32 offset:2432
    s_waitcnt lgkmcnt(10)
    v_mfma_f32_16x16x32_bf16 v[192:195], v[124:127], v[64:67], v[192:195]
    v_mfma_f32_16x16x32_bf16 v[196:199], v[124:127], v[68:71], v[196:199]
    s_waitcnt vmcnt(13)
    s_barrier
    ds_read_b64_tr_b16 v[124:125], v32 offset:160
    ds_read_b64_tr_b16 v[126:127], v32 offset:2464
    s_waitcnt lgkmcnt(10)
    v_mfma_f32_16x16x32_bf16 v[128:131], v[104:107], v[72:75], v[128:131]
    v_mfma_f32_16x16x32_bf16 v[132:135], v[104:107], v[76:79], v[132:135]
    s_add_u32 s39, s21, 36864
    s_mov_b32 m0, s39
    s_mov_b64 exec, 0xffffffff
    buffer_load_dwordx4 v34, s[8:11], s20 offen lds
    s_mov_b64 exec, -1
    ds_read_b64_tr_b16 v[104:105], v32 offset:192
    ds_read_b64_tr_b16 v[106:107], v32 offset:2496
    s_waitcnt lgkmcnt(10)
    v_mfma_f32_16x16x32_bf16 v[136:139], v[108:111], v[72:75], v[136:139]
    v_mfma_f32_16x16x32_bf16 v[140:143], v[108:111], v[76:79], v[140:143]
    ds_read_b64_tr_b16 v[108:109], v32 offset:224
    ds_read_b64_tr_b16 v[110:111], v32 offset:2528
    s_waitcnt lgkmcnt(10)
    v_mfma_f32_16x16x32_bf16 v[144:147], v[112:115], v[72:75], v[144:147]
    v_mfma_f32_16x16x32_bf16 v[148:151], v[112:115], v[76:79], v[148:151]
    buffer_load_dwordx4 v35, s[8:11], s20 offen offset:512 lds
    ds_read_b64_tr_b16 v[112:113], v32 offset:256
    ds_read_b64_tr_b16 v[114:115], v32 offset:2560
    s_waitcnt lgkmcnt(10)
    v_mfma_f32_16x16x32_bf16 v[152:155], v[116:119], v[72:75], v[152:155]
    v_mfma_f32_16x16x32_bf16 v[156:159], v[116:119], v[76:79], v[156:159]
    ds_read_b64_tr_b16 v[116:117], v32 offset:18432
    ds_read_b64_tr_b16 v[118:119], v32 offset:20736
    s_waitcnt lgkmcnt(10)
    v_mfma_f32_16x16x32_bf16 v[160:163], v[120:123], v[72:75], v[160:163]
    v_mfma_f32_16x16x32_bf16 v[164:167], v[120:123], v[76:79], v[164:167]
    buffer_load_dwordx4 v36, s[8:11], s20 offen offset:1536 lds
    ds_read_b64_tr_b16 v[120:121], v32 offset:18464
    ds_read_b64_tr_b16 v[122:123], v32 offset:20768
    s_waitcnt lgkmcnt(10)
    v_mfma_f32_16x16x32_bf16 v[168:171], v[124:127], v[72:75], v[168:171]
    v_mfma_f32_16x16x32_bf16 v[172:175], v[124:127], v[76:79], v[172:175]
    buffer_load_dwordx4 v37, s[8:11], s20 offen offset:2560 lds
    ds_read_b64_tr_b16 v[124:125], v32 offset:18496
    ds_read_b64_tr_b16 v[126:127], v32 offset:20800
    s_waitcnt lgkmcnt(10)
    v_mfma_f32_16x16x32_bf16 v[176:179], v[104:107], v[72:75], v[176:179]
    v_mfma_f32_16x16x32_bf16 v[180:183], v[104:107], v[76:79], v[180:183]
    ds_read_b64_tr_b16 v[104:105], v32 offset:18528
    ds_read_b64_tr_b16 v[106:107], v32 offset:20832
    s_waitcnt lgkmcnt(10)
    v_mfma_f32_16x16x32_bf16 v[184:187], v[108:111], v[72:75], v[184:187]
    v_mfma_f32_16x16x32_bf16 v[188:191], v[108:111], v[76:79], v[188:191]
    buffer_load_dwordx4 v38, s[8:11], s20 offen offset:3584 lds
    s_add_u32 s44, s44, 1
    s_cmp_eq_u32 s44, 9
    s_cselect_b32 s43, 0xffee0000, s52
    s_add_u32 s20, s20, s43
    ds_read_b64_tr_b16 v[108:109], v32 offset:18560
    ds_read_b64_tr_b16 v[110:111], v32 offset:20864
    s_waitcnt lgkmcnt(10)
    v_mfma_f32_16x16x32_bf16 v[192:195], v[112:115], v[72:75], v[192:195]
    v_mfma_f32_16x16x32_bf16 v[196:199], v[112:115], v[76:79], v[196:199]
    ds_read_b64_tr_b16 v[112:113], v32 offset:18592
    ds_read_b64_tr_b16 v[114:115], v32 offset:20896
    s_waitcnt lgkmcnt(10)
    v_mfma_f32_16x16x32_bf16 v[128:131], v[116:119], v[80:83], v[128:131]
    v_mfma_f32_16x16x32_bf16 v[132:135], v[116:119], v[84:87], v[132:135]
    buffer_load_dwordx4 v[56:59], v39, s[12:15], s22 offen offset:0 sc1
    ds_read_b64_tr_b16 v[116:117], v32 offset:18624
    ds_read_b64_tr_b16 v[118:119], v32 offset:20928
    s_waitcnt lgkmcnt(10)
    v_mfma_f32_16x16x32_bf16 v[136:139], v[120:123], v[80:83], v[136:139]
    v_mfma_f32_16x16x32_bf16 v[140:143], v[120:123], v[84:87], v[140:143]
    ds_read_b64_tr_b16 v[120:121], v32 offset:18656
    ds_read_b64_tr_b16 v[122:123], v32 offset:20960
    s_waitcnt lgkmcnt(10)
    v_mfma_f32_16x16x32_bf16 v[144:147], v[124:127], v[80:83], v[144:147]
    v_mfma_f32_16x16x32_bf16 v[148:151], v[124:127], v[84:87], v[148:151]
    buffer_load_dwordx4 v[60:63], v39, s[12:15], s23 offen offset:0 sc1
    ds_read_b64_tr_b16 v[124:125], v32 offset:18688
    ds_read_b64_tr_b16 v[126:127], v32 offset:20992
    s_waitcnt lgkmcnt(10)
    v_mfma_f32_16x16x32_bf16 v[152:155], v[104:107], v[80:83], v[152:155]
    v_mfma_f32_16x16x32_bf16 v[156:159], v[104:107], v[84:87], v[156:159]
    buffer_load_dwordx4 v[64:67], v39, s[12:15], s22 offen offset:2048 sc1
    ds_read_b64_tr_b16 v[104:105], v33 offset:0
    ds_read_b64_tr_b16 v[106:107], v33 offset:2304
    s_waitcnt lgkmcnt(10)
    v_mfma_f32_16x16x32_bf16 v[160:163], v[108:111], v[80:83], v[160:163]
    v_mfma_f32_16x16x32_bf16 v[164:167], v[108:111], v[84:87], v[164:167]
    ds_read_b64_tr_b16 v[108:109], v33 offset:32
    ds_read_b64_tr_b16 v[110:111], v33 offset:2336
    s_waitcnt lgkmcnt(10)
    v_mfma_f32_16x16x32_bf16 v[168:171], v[112:115], v[80:83], v[168:171]
    v_mfma_f32_16x16x32_bf16 v[172:175], v[112:115], v[84:87], v[172:175]
    buffer_load_dwordx4 v[68:71], v39, s[12:15], s23 offen offset:2048 sc1
    s_add_u32 s45, s45, 1
    s_cmp_eq_u32 s45, 9
    s_cselect_b32 s43, 0xffff8000, s53
    s_add_u32 s22, s22, s43
    s_add_u32 s23, s23, s43
    ds_read_b64_tr_b16 v[112:113], v33 offset:64
    ds_read_b64_tr_b16 v[114:115], v33 offset:2368
    s_waitcnt lgkmcnt(10)
    v_mfma_f32_16x16x32_bf16 v[176:179], v[116:119], v[80:83], v[176:179]
    v_mfma_f32_16x16x32_bf16 v[180:183], v[116:119], v[84:87], v[180:183]
    ds_read_b64_tr_b16 v[116:117], v33 offset:96
    ds_read_b64_tr_b16 v[118:119], v33 offset:2400
    s_waitcnt lgkmcnt(10)
    v_mfma_f32_16x16x32_bf16 v[184:187], v[120:123], v[80:83], v[184:187]
    v_mfma_f32_16x16x32_bf16 v[188:191], v[120:123], v[84:87], v[188:191]
    ds_read_b64_tr_b16 v[120:121], v33 offset:128
    ds_read_b64_tr_b16 v[122:123], v33 offset:2432
    s_waitcnt lgkmcnt(10)
    v_mfma_f32_16x16x32_bf16 v[192:195], v[124:127], v[80:83], v[192:195]
    v_mfma_f32_16x16x32_bf16 v[196:199], v[124:127], v[84:87], v[196:199]
    s_waitcnt vmcnt(13)
    s_barrier
    ds_read_b64_tr_b16 v[124:125], v33 offset:160
    ds_read_b64_tr_b16 v[126:127], v33 offset:2464
    s_waitcnt lgkmcnt(10)
    v_mfma_f32_16x16x32_bf16 v[128:131], v[104:107], v[88:91], v[128:131]
    v_mfma_f32_16x16x32_bf16 v[132:135], v[104:107], v[92:95], v[132:135]
    s_add_u32 s39, s21, 73728
    s_mov_b32 m0, s39
    s_mov_b64 exec, 0xffffffff
    buffer_load_dwordx4 v34, s[8:11], s20 offen lds
    s_mov_b64 exec, -1
    ds_read_b64_tr_b16 v[104:105], v33 offset:192
    ds_read_b64_tr_b16 v[106:107], v33 offset:2496
    s_waitcnt lgkmcnt(10)
    v_mfma_f32_16x16x32_bf16 v[136:139], v[108:111], v[88:91], v[136:139]
    v_mfma_f32_16x16x32_bf16 v[140:143], v[108:111], v[92:95], v[140:143]
    ds_read_b64_tr_b16 v[108:109], v33 offset:224
    ds_read_b64_tr_b16 v[110:111], v33 offset:2528
    s_waitcnt lgkmcnt(10)
    v_mfma_f32_16x16x32_bf16 v[144:147], v[112:115], v[88:91], v[144:147]
    v_mfma_f32_16x16x32_bf16 v[148:151], v[112:115], v[92:95], v[148:151]
    buffer_load_dwordx4 v35, s[8:11], s20 offen offset:512 lds
    ds_read_b64_tr_b16 v[112:113], v33 offset:256
    ds_read_b64_tr_b16 v[114:115], v33 offset:2560
    s_waitcnt lgkmcnt(10)
    v_mfma_f32_16x16x32_bf16 v[152:155], v[116:119], v[88:91], v[152:155]
    v_mfma_f32_16x16x32_bf16 v[156:159], v[116:119], v[92:95], v[156:159]
    ds_read_b64_tr_b16 v[116:117], v33 offset:18432
    ds_read_b64_tr_b16 v[118:119], v33 offset:20736
    s_waitcnt lgkmcnt(10)
    v_mfma_f32_16x16x32_bf16 v[160:163], v[120:123], v[88:91], v[160:163]
    v_mfma_f32_16x16x32_bf16 v[164:167], v[120:123], v[92:95], v[164:167]
    buffer_load_dwordx4 v36, s[8:11], s20 offen offset:1536 lds
    ds_read_b64_tr_b16 v[120:121], v33 offset:18464
    ds_read_b64_tr_b16 v[122:123], v33 offset:20768
    s_waitcnt lgkmcnt(10)
    v_mfma_f32_16x16x32_bf16 v[168:171], v[124:127], v[88:91], v[168:171]
    v_mfma_f32_16x16x32_bf16 v[172:175], v[124:127], v[92:95], v[172:175]
    buffer_load_dwordx4 v37, s[8:11], s20 offen offset:2560 lds
    ds_read_b64_tr_b16 v[124:125], v33 offset:18496
    ds_read_b64_tr_b16 v[126:127], v33 offset:20800
    s_waitcnt lgkmcnt(10)
    v_mfma_f32_16x16x32_bf16 v[176:179], v[104:107], v[88:91], v[176:179]
    v_mfma_f32_16x16x32_bf16 v[180:183], v[104:107], v[92:95], v[180:183]
    ds_read_b64_tr_b16 v[104:105], v33 offset:18528
    ds_read_b64_tr_b16 v[106:107], v33 offset:20832
    s_waitcnt lgkmcnt(10)
    v_mfma_f32_16x16x32_bf16 v[184:187], v[108:111], v[88:91], v[184:187]
    v_mfma_f32_16x16x32_bf16 v[188:191], v[108:111], v[92:95], v[188:191]
    buffer_load_dwordx4 v38, s[8:11], s20 offen offset:3584 lds
    s_add_u32 s44, s44, 1
    s_cmp_eq_u32 s44, 9
    s_cselect_b32 s43, 0xffee0000, s52
    s_add_u32 s20, s20, s43
    ds_read_b64_tr_b16 v[108:109], v33 offset:18560
    ds_read_b64_tr_b16 v[110:111], v33 offset:20864
    s_waitcnt lgkmcnt(10)
    v_mfma_f32_16x16x32_bf16 v[192:195], v[112:115], v[88:91], v[192:195]
    v_mfma_f32_16x16x32_bf16 v[196:199], v[112:115], v[92:95], v[196:199]
    ds_read_b64_tr_b16 v[112:113], v33 offset:18592
    ds_read_b64_tr_b16 v[114:115], v33 offset:20896
    s_waitcnt lgkmcnt(10)
    v_mfma_f32_16x16x32_bf16 v[128:131], v[116:119], v[96:99], v[128:131]
    v_mfma_f32_16x16x32_bf16 v[132:135], v[116:119], v[100:103], v[132:135]
    buffer_load_dwordx4 v[72:75], v39, s[12:15], s22 offen offset:0 sc1
    ds_read_b64_tr_b16 v[116:117], v33 offset:18624
    ds_read_b64_tr_b16 v[118:119], v33 offset:20928
    s_waitcnt lgkmcnt(10)
    v_mfma_f32_16x16x32_bf16 v[136:139], v[120:123], v[96:99], v[136:139]
    v_mfma_f32_16x16x32_bf16 v[140:143], v[120:123], v[100:103], v[140:143]
    ds_read_b64_tr_b16 v[120:121], v33 offset:18656
    ds_read_b64_tr_b16 v[122:123], v33 offset:20960
    s_waitcnt lgkmcnt(10)
    v_mfma_f32_16x16x32_bf16 v[144:147], v[124:127], v[96:99], v[144:147]
    v_mfma_f32_16x16x32_bf16 v[148:151], v[124:127], v[100:103], v[148:151]
    buffer_load_dwordx4 v[76:79], v39, s[12:15], s23 offen offset:0 sc1
    ds_read_b64_tr_b16 v[124:125], v33 offset:18688
    ds_read_b64_tr_b16 v[126:127], v33 offset:20992
    s_waitcnt lgkmcnt(10)
    v_mfma_f32_16x16x32_bf16 v[152:155], v[104:107], v[96:99], v[152:155]
    v_mfma_f32_16x16x32_bf16 v[156:159], v[104:107], v[100:103], v[156:159]
    buffer_load_dwordx4 v[80:83], v39, s[12:15], s22 offen offset:2048 sc1
    ds_read_b64_tr_b16 v[104:105], v30 offset:0
    ds_read_b64_tr_b16 v[106:107], v30 offset:2304
    s_waitcnt lgkmcnt(10)
    v_mfma_f32_16x16x32_bf16 v[160:163], v[108:111], v[96:99], v[160:163]
    v_mfma_f32_16x16x32_bf16 v[164:167], v[108:111], v[100:103], v[164:167]
    ds_read_b64_tr_b16 v[108:109], v30 offset:32
    ds_read_b64_tr_b16 v[110:111], v30 offset:2336
    s_waitcnt lgkmcnt(10)
    v_mfma_f32_16x16x32_bf16 v[168:171], v[112:115], v[96:99], v[168:171]
    v_mfma_f32_16x16x32_bf16 v[172:175], v[112:115], v[100:103], v[172:175]
    buffer_load_dwordx4 v[84:87], v39, s[12:15], s23 offen offset:2048 sc1
    s_add_u32 s45, s45, 1
    s_cmp_eq_u32 s45, 9
    s_cselect_b32 s43, 0xffff8000, s53
    s_add_u32 s22, s22, s43
    s_add_u32 s23, s23, s43
    ds_read_b64_tr_b16 v[112:113], v30 offset:64
    ds_read_b64_tr_b16 v[114:115], v30 offset:2368
    s_waitcnt lgkmcnt(10)
    v_mfma_f32_16x16x32_bf16 v[176:179], v[116:119], v[96:99], v[176:179]
    v_mfma_f32_16x16x32_bf16 v[180:183], v[116:119], v[100:103], v[180:183]
    ds_read_b64_tr_b16 v[116:117], v30 offset:96
    ds_read_b64_tr_b16 v[118:119], v30 offset:2400
    s_waitcnt lgkmcnt(10)
    v_mfma_f32_16x16x32_bf16 v[184:187], v[120:123], v[96:99], v[184:187]
    v_mfma_f32_16x16x32_bf16 v[188:191], v[120:123], v[100:103], v[188:191]
    ds_read_b64_tr_b16 v[120:121], v30 offset:128
    ds_read_b64_tr_b16 v[122:123], v30 offset:2432
    s_waitcnt lgkmcnt(10)
    v_mfma_f32_16x16x32_bf16 v[192:195], v[124:127], v[96:99], v[192:195]
    v_mfma_f32_16x16x32_bf16 v[196:199], v[124:127], v[100:103], v[196:199]
    s_waitcnt vmcnt(13)
    s_barrier
    ds_read_b64_tr_b16 v[124:125], v30 offset:160
    ds_read_b64_tr_b16 v[126:127], v30 offset:2464
    s_waitcnt lgkmcnt(10)
    v_mfma_f32_16x16x32_bf16 v[128:131], v[104:107], v[40:43], v[128:131]
    v_mfma_f32_16x16x32_bf16 v[132:135], v[104:107], v[44:47], v[132:135]
    s_add_u32 s39, s21, 110592
    s_mov_b32 m0, s39
    s_mov_b64 exec, 0xffffffff
    buffer_load_dwordx4 v34, s[8:11], s20 offen lds
    s_mov_b64 exec, -1
    ds_read_b64_tr_b16 v[104:105], v30 offset:192
    ds_read_b64_tr_b16 v[106:107], v30 offset:2496
    s_waitcnt lgkmcnt(10)
    v_mfma_f32_16x16x32_bf16 v[136:139], v[108:111], v[40:43], v[136:139]
    v_mfma_f32_16x16x32_bf16 v[140:143], v[108:111], v[44:47], v[140:143]
    ds_read_b64_tr_b16 v[108:109], v30 offset:224
    ds_read_b64_tr_b16 v[110:111], v30 offset:2528
    s_waitcnt lgkmcnt(10)
    v_mfma_f32_16x16x32_bf16 v[144:147], v[112:115], v[40:43], v[144:147]
    v_mfma_f32_16x16x32_bf16 v[148:151], v[112:115], v[44:47], v[148:151]
    buffer_load_dwordx4 v35, s[8:11], s20 offen offset:512 lds
    ds_read_b64_tr_b16 v[112:113], v30 offset:256
    ds_read_b64_tr_b16 v[114:115], v30 offset:2560
    s_waitcnt lgkmcnt(10)
    v_mfma_f32_16x16x32_bf16 v[152:155], v[116:119], v[40:43], v[152:155]
    v_mfma_f32_16x16x32_bf16 v[156:159], v[116:119], v[44:47], v[156:159]
    ds_read_b64_tr_b16 v[116:117], v30 offset:18432
    ds_read_b64_tr_b16 v[118:119], v30 offset:20736
    s_waitcnt lgkmcnt(10)
    v_mfma_f32_16x16x32_bf16 v[160:163], v[120:123], v[40:43], v[160:163]
    v_mfma_f32_16x16x32_bf16 v[164:167], v[120:123], v[44:47], v[164:167]
    buffer_load_dwordx4 v36, s[8:11], s20 offen offset:1536 lds
    ds_read_b64_tr_b16 v[120:121], v30 offset:18464
    ds_read_b64_tr_b16 v[122:123], v30 offset:20768
    s_waitcnt lgkmcnt(10)
    v_mfma_f32_16x16x32_bf16 v[168:171], v[124:127], v[40:43], v[168:171]
    v_mfma_f32_16x16x32_bf16 v[172:175], v[124:127], v[44:47], v[172:175]
    buffer_load_dwordx4 v37, s[8:11], s20 offen offset:2560 lds
    ds_read_b64_tr_b16 v[124:125], v30 offset:18496
    ds_read_b64_tr_b16 v[126:127], v30 offset:20800
    s_waitcnt lgkmcnt(10)
    v_mfma_f32_16x16x32_bf16 v[176:179], v[104:107], v[40:43], v[176:179]
    v_mfma_f32_16x16x32_bf16 v[180:183], v[104:107], v[44:47], v[180:183]
    ds_read_b64_tr_b16 v[104:105], v30 offset:18528
    ds_read_b64_tr_b16 v[106:107], v30 offset:20832
    s_waitcnt lgkmcnt(10)
    v_mfma_f32_16x16x32_bf16 v[184:187], v[108:111], v[40:43], v[184:187]
    v_mfma_f32_16x16x32_bf16 v[188:191], v[108:111], v[44:47], v[188:191]
    buffer_load_dwordx4 v38, s[8:11], s20 offen offset:3584 lds
    s_add_u32 s44, s44, 1
    s_cmp_eq_u32 s44, 9
    s_cselect_b32 s43, 0xffee0000, s52
    s_add_u32 s20, s20, s43
    ds_read_b64_tr_b16 v[108:109], v30 offset:18560
    ds_read_b64_tr_b16 v[110:111], v30 offset:20864
    s_waitcnt lgkmcnt(10)
    v_mfma_f32_16x16x32_bf16 v[192:195], v[112:115], v[40:43], v[192:195]
    v_mfma_f32_16x16x32_bf16 v[196:199], v[112:115], v[44:47], v[196:199]
    ds_read_b64_tr_b16 v[112:113], v30 offset:18592
    ds_read_b64_tr_b16 v[114:115], v30 offset:20896
    s_waitcnt lgkmcnt(10)
    v_mfma_f32_16x16x32_bf16 v[128:131], v[116:119], v[48:51], v[128:131]
    v_mfma_f32_16x16x32_bf16 v[132:135], v[116:119], v[52:55], v[132:135]
    buffer_load_dwordx4 v[88:91], v39, s[12:15], s22 offen offset:0 sc1
    ds_read_b64_tr_b16 v[116:117], v30 offset:18624
    ds_read_b64_tr_b16 v[118:119], v30 offset:20928
    s_waitcnt lgkmcnt(10)
    v_mfma_f32_16x16x32_bf16 v[136:139], v[120:123], v[48:51], v[136:139]
    v_mfma_f32_16x16x32_bf16 v[140:143], v[120:123], v[52:55], v[140:143]
    ds_read_b64_tr_b16 v[120:121], v30 offset:18656
    ds_read_b64_tr_b16 v[122:123], v30 offset:20960
    s_waitcnt lgkmcnt(10)
    v_mfma_f32_16x16x32_bf16 v[144:147], v[124:127], v[48:51], v[144:147]
    v_mfma_f32_16x16x32_bf16 v[148:151], v[124:127], v[52:55], v[148:151]
    buffer_load_dwordx4 v[92:95], v39, s[12:15], s23 offen offset:0 sc1
    ds_read_b64_tr_b16 v[124:125], v30 offset:18688
    ds_read_b64_tr_b16 v[126:127], v30 offset:20992
    s_waitcnt lgkmcnt(10)
    v_mfma_f32_16x16x32_bf16 v[152:155], v[104:107], v[48:51], v[152:155]
    v_mfma_f32_16x16x32_bf16 v[156:159], v[104:107], v[52:55], v[156:159]
    buffer_load_dwordx4 v[96:99], v39, s[12:15], s22 offen offset:2048 sc1
    ds_read_b64_tr_b16 v[104:105], v31 offset:0
    ds_read_b64_tr_b16 v[106:107], v31 offset:2304
    s_waitcnt lgkmcnt(10)
    v_mfma_f32_16x16x32_bf16 v[160:163], v[108:111], v[48:51], v[160:163]
    v_mfma_f32_16x16x32_bf16 v[164:167], v[108:111], v[52:55], v[164:167]
    ds_read_b64_tr_b16 v[108:109], v31 offset:32
    ds_read_b64_tr_b16 v[110:111], v31 offset:2336
    s_waitcnt lgkmcnt(10)
    v_mfma_f32_16x16x32_bf16 v[168:171], v[112:115], v[48:51], v[168:171]
    v_mfma_f32_16x16x32_bf16 v[172:175], v[112:115], v[52:55], v[172:175]
    buffer_load_dwordx4 v[100:103], v39, s[12:15], s23 offen offset:2048 sc1
    s_add_u32 s45, s45, 1
    s_cmp_eq_u32 s45, 9
    s_cselect_b32 s43, 0xffff8000, s53
    s_add_u32 s22, s22, s43
    s_add_u32 s23, s23, s43
    ds_read_b64_tr_b16 v[112:113], v31 offset:64
    ds_read_b64_tr_b16 v[114:115], v31 offset:2368
    s_waitcnt lgkmcnt(10)
    v_mfma_f32_16x16x32_bf16 v[176:179], v[116:119], v[48:51], v[176:179]
    v_mfma_f32_16x16x32_bf16 v[180:183], v[116:119], v[52:55], v[180:183]
    ds_read_b64_tr_b16 v[116:117], v31 offset:96
    ds_read_b64_tr_b16 v[118:119], v31 offset:2400
    s_waitcnt lgkmcnt(10)
    v_mfma_f32_16x16x32_bf16 v[184:187], v[120:123], v[48:51], v[184:187]
    v_mfma_f32_16x16x32_bf16 v[188:191], v[120:123], v[52:55], v[188:191]
    ds_read_b64_tr_b16 v[120:121], v31 offset:128
    ds_read_b64_tr_b16 v[122:123], v31 offset:2432
    s_waitcnt lgkmcnt(10)
    v_mfma_f32_16x16x32_bf16 v[192:195], v[124:127], v[48:51], v[192:195]
    v_mfma_f32_16x16x32_bf16 v[196:199], v[124:127], v[52:55], v[196:199]
    s_waitcnt vmcnt(13)
    s_barrier
    ds_read_b64_tr_b16 v[124:125], v31 offset:160
    ds_read_b64_tr_b16 v[126:127], v31 offset:2464
    s_waitcnt lgkmcnt(10)
    v_mfma_f32_16x16x32_bf16 v[128:131], v[104:107], v[56:59], v[128:131]
    v_mfma_f32_16x16x32_bf16 v[132:135], v[104:107], v[60:63], v[132:135]
    s_add_u32 s39, s21, 0
    s_mov_b32 m0, s39
    s_mov_b64 exec, 0xffffffff
    buffer_load_dwordx4 v34, s[8:11], s20 offen lds
    s_mov_b64 exec, -1
    ds_read_b64_tr_b16 v[104:105], v31 offset:192
    ds_read_b64_tr_b16 v[106:107], v31 offset:2496
    s_waitcnt lgkmcnt(10)
    v_mfma_f32_16x16x32_bf16 v[136:139], v[108:111], v[56:59], v[136:139]
    v_mfma_f32_16x16x32_bf16 v[140:143], v[108:111], v[60:63], v[140:143]
    ds_read_b64_tr_b16 v[108:109], v31 offset:224
    ds_read_b64_tr_b16 v[110:111], v31 offset:2528
    s_waitcnt lgkmcnt(10)
    v_mfma_f32_16x16x32_bf16 v[144:147], v[112:115], v[56:59], v[144:147]
    v_mfma_f32_16x16x32_bf16 v[148:151], v[112:115], v[60:63], v[148:151]
    buffer_load_dwordx4 v35, s[8:11], s20 offen offset:512 lds
    ds_read_b64_tr_b16 v[112:113], v31 offset:256
    ds_read_b64_tr_b16 v[114:115], v31 offset:2560
    s_waitcnt lgkmcnt(10)
    v_mfma_f32_16x16x32_bf16 v[152:155], v[116:119], v[56:59], v[152:155]
    v_mfma_f32_16x16x32_bf16 v[156:159], v[116:119], v[60:63], v[156:159]
    ds_read_b64_tr_b16 v[116:117], v31 offset:18432
    ds_read_b64_tr_b16 v[118:119], v31 offset:20736
    s_waitcnt lgkmcnt(10)
    v_mfma_f32_16x16x32_bf16 v[160:163], v[120:123], v[56:59], v[160:163]
    v_mfma_f32_16x16x32_bf16 v[164:167], v[120:123], v[60:63], v[164:167]
    buffer_load_dwordx4 v36, s[8:11], s20 offen offset:1536 lds
    ds_read_b64_tr_b16 v[120:121], v31 offset:18464
    ds_read_b64_tr_b16 v[122:123], v31 offset:20768
    s_waitcnt lgkmcnt(10)
    v_mfma_f32_16x16x32_bf16 v[168:171], v[124:127], v[56:59], v[168:171]
    v_mfma_f32_16x16x32_bf16 v[172:175], v[124:127], v[60:63], v[172:175]
    buffer_load_dwordx4 v37, s[8:11], s20 offen offset:2560 lds
    ds_read_b64_tr_b16 v[124:125], v31 offset:18496
    ds_read_b64_tr_b16 v[126:127], v31 offset:20800
    s_waitcnt lgkmcnt(10)
    v_mfma_f32_16x16x32_bf16 v[176:179], v[104:107], v[56:59], v[176:179]
    v_mfma_f32_16x16x32_bf16 v[180:183], v[104:107], v[60:63], v[180:183]
    ds_read_b64_tr_b16 v[104:105], v31 offset:18528
    ds_read_b64_tr_b16 v[106:107], v31 offset:20832
    s_waitcnt lgkmcnt(10)
    v_mfma_f32_16x16x32_bf16 v[184:187], v[108:111], v[56:59], v[184:187]
    v_mfma_f32_16x16x32_bf16 v[188:191], v[108:111], v[60:63], v[188:191]
    buffer_load_dwordx4 v38, s[8:11], s20 offen offset:3584 lds
    s_add_u32 s44, s44, 1
    s_cmp_eq_u32 s44, 9
    s_cselect_b32 s43, 0xffee0000, s52
    s_add_u32 s20, s20, s43
    ds_read_b64_tr_b16 v[108:109], v31 offset:18560
    ds_read_b64_tr_b16 v[110:111], v31 offset:20864
    s_waitcnt lgkmcnt(10)
    v_mfma_f32_16x16x32_bf16 v[192:195], v[112:115], v[56:59], v[192:195]
    v_mfma_f32_16x16x32_bf16 v[196:199], v[112:115], v[60:63], v[196:199]
    ds_read_b64_tr_b16 v[112:113], v31 offset:18592
    ds_read_b64_tr_b16 v[114:115], v31 offset:20896
    s_waitcnt lgkmcnt(10)
    v_mfma_f32_16x16x32_bf16 v[128:131], v[116:119], v[64:67], v[128:131]
    v_mfma_f32_16x16x32_bf16 v[132:135], v[116:119], v[68:71], v[132:135]
    buffer_load_dwordx4 v[40:43], v39, s[12:15], s22 offen offset:0 sc1
    ds_read_b64_tr_b16 v[116:117], v31 offset:18624
    ds_read_b64_tr_b16 v[118:119], v31 offset:20928
    s_waitcnt lgkmcnt(10)
    v_mfma_f32_16x16x32_bf16 v[136:139], v[120:123], v[64:67], v[136:139]
    v_mfma_f32_16x16x32_bf16 v[140:143], v[120:123], v[68:71], v[140:143]
    ds_read_b64_tr_b16 v[120:121], v31 offset:18656
    ds_read_b64_tr_b16 v[122:123], v31 offset:20960
    s_waitcnt lgkmcnt(10)
    v_mfma_f32_16x16x32_bf16 v[144:147], v[124:127], v[64:67], v[144:147]
    v_mfma_f32_16x16x32_bf16 v[148:151], v[124:127], v[68:71], v[148:151]
    buffer_load_dwordx4 v[44:47], v39, s[12:15], s23 offen offset:0 sc1
    ds_read_b64_tr_b16 v[124:125], v31 offset:18688
    ds_read_b64_tr_b16 v[126:127], v31 offset:20992
    s_waitcnt lgkmcnt(10)
    v_mfma_f32_16x16x32_bf16 v[152:155], v[104:107], v[64:67], v[152:155]
    v_mfma_f32_16x16x32_bf16 v[156:159], v[104:107], v[68:71], v[156:159]
    buffer_load_dwordx4 v[48:51], v39, s[12:15], s22 offen offset:2048 sc1
    ds_read_b64_tr_b16 v[104:105], v32 offset:0
    ds_read_b64_tr_b16 v[106:107], v32 offset:2304
    s_waitcnt lgkmcnt(10)
    v_mfma_f32_16x16x32_bf16 v[160:163], v[108:111], v[64:67], v[160:163]
    v_mfma_f32_16x16x32_bf16 v[164:167], v[108:111], v[68:71], v[164:167]
    ds_read_b64_tr_b16 v[108:109], v32 offset:32
    ds_read_b64_tr_b16 v[110:111], v32 offset:2336
    s_waitcnt lgkmcnt(10)
    v_mfma_f32_16x16x32_bf16 v[168:171], v[112:115], v[64:67], v[168:171]
    v_mfma_f32_16x16x32_bf16 v[172:175], v[112:115], v[68:71], v[172:175]
    buffer_load_dwordx4 v[52:55], v39, s[12:15], s23 offen offset:2048 sc1
    s_add_u32 s45, s45, 1
    s_cmp_eq_u32 s45, 9
    s_cselect_b32 s43, 0xffff8000, s53
    s_add_u32 s22, s22, s43
    s_add_u32 s23, s23, s43
    ds_read_b64_tr_b16 v[112:113], v32 offset:64
    ds_read_b64_tr_b16 v[114:115], v32 offset:2368
    s_waitcnt lgkmcnt(10)
    v_mfma_f32_16x16x32_bf16 v[176:179], v[116:119], v[64:67], v[176:179]
    v_mfma_f32_16x16x32_bf16 v[180:183], v[116:119], v[68:71], v[180:183]
    ds_read_b64_tr_b16 v[116:117], v32 offset:96
    ds_read_b64_tr_b16 v[118:119], v32 offset:2400
    s_waitcnt lgkmcnt(10)
    v_mfma_f32_16x16x32_bf16 v[184:187], v[120:123], v[64:67], v[184:187]
    v_mfma_f32_16x16x32_bf16 v[188:191], v[120:123], v[68:71], v[188:191]
    ds_read_b64_tr_b16 v[120:121], v32 offset:128
    ds_read_b64_tr_b16 v[122:123], v32 offset:2432
    s_waitcnt lgkmcnt(10)
    v_mfma_f32_16x16x32_bf16 v[192:195], v[124:127], v[64:67], v[192:195]
    v_mfma_f32_16x16x32_bf16 v[196:199], v[124:127], v[68:71], v[196:199]
    s_waitcnt vmcnt(13)
    s_barrier
    ds_read_b64_tr_b16 v[124:125], v32 offset:160
    ds_read_b64_tr_b16 v[126:127], v32 offset:2464
    s_waitcnt lgkmcnt(10)
    v_mfma_f32_16x16x32_bf16 v[128:131], v[104:107], v[72:75], v[128:131]
    v_mfma_f32_16x16x32_bf16 v[132:135], v[104:107], v[76:79], v[132:135]
    ds_read_b64_tr_b16 v[104:105], v32 offset:192
    ds_read_b64_tr_b16 v[106:107], v32 offset:2496
    s_waitcnt lgkmcnt(10)
    v_mfma_f32_16x16x32_bf16 v[136:139], v[108:111], v[72:75], v[136:139]
    v_mfma_f32_16x16x32_bf16 v[140:143], v[108:111], v[76:79], v[140:143]
    ds_read_b64_tr_b16 v[108:109], v32 offset:224
    ds_read_b64_tr_b16 v[110:111], v32 offset:2528
    s_waitcnt lgkmcnt(10)
    v_mfma_f32_16x16x32_bf16 v[144:147], v[112:115], v[72:75], v[144:147]
    v_mfma_f32_16x16x32_bf16 v[148:151], v[112:115], v[76:79], v[148:151]
    ds_read_b64_tr_b16 v[112:113], v32 offset:256
    ds_read_b64_tr_b16 v[114:115], v32 offset:2560
    s_waitcnt lgkmcnt(10)
    v_mfma_f32_16x16x32_bf16 v[152:155], v[116:119], v[72:75], v[152:155]
    v_mfma_f32_16x16x32_bf16 v[156:159], v[116:119], v[76:79], v[156:159]
    ds_read_b64_tr_b16 v[116:117], v32 offset:18432
    ds_read_b64_tr_b16 v[118:119], v32 offset:20736
    s_waitcnt lgkmcnt(10)
    v_mfma_f32_16x16x32_bf16 v[160:163], v[120:123], v[72:75], v[160:163]
    v_mfma_f32_16x16x32_bf16 v[164:167], v[120:123], v[76:79], v[164:167]
    ds_read_b64_tr_b16 v[120:121], v32 offset:18464
    ds_read_b64_tr_b16 v[122:123], v32 offset:20768
    s_waitcnt lgkmcnt(10)
    v_mfma_f32_16x16x32_bf16 v[168:171], v[124:127], v[72:75], v[168:171]
    v_mfma_f32_16x16x32_bf16 v[172:175], v[124:127], v[76:79], v[172:175]
    ds_read_b64_tr_b16 v[124:125], v32 offset:18496
    ds_read_b64_tr_b16 v[126:127], v32 offset:20800
    s_waitcnt lgkmcnt(10)
    v_mfma_f32_16x16x32_bf16 v[176:179], v[104:107], v[72:75], v[176:179]
    v_mfma_f32_16x16x32_bf16 v[180:183], v[104:107], v[76:79], v[180:183]
    ds_read_b64_tr_b16 v[104:105], v32 offset:18528
    ds_read_b64_tr_b16 v[106:107], v32 offset:20832
    s_waitcnt lgkmcnt(10)
    v_mfma_f32_16x16x32_bf16 v[184:187], v[108:111], v[72:75], v[184:187]
    v_mfma_f32_16x16x32_bf16 v[188:191], v[108:111], v[76:79], v[188:191]
    ds_read_b64_tr_b16 v[108:109], v32 offset:18560
    ds_read_b64_tr_b16 v[110:111], v32 offset:20864
    s_waitcnt lgkmcnt(10)
    v_mfma_f32_16x16x32_bf16 v[192:195], v[112:115], v[72:75], v[192:195]
    v_mfma_f32_16x16x32_bf16 v[196:199], v[112:115], v[76:79], v[196:199]
    ds_read_b64_tr_b16 v[112:113], v32 offset:18592
    ds_read_b64_tr_b16 v[114:115], v32 offset:20896
    s_waitcnt lgkmcnt(10)
    v_mfma_f32_16x16x32_bf16 v[128:131], v[116:119], v[80:83], v[128:131]
    v_mfma_f32_16x16x32_bf16 v[132:135], v[116:119], v[84:87], v[132:135]
    ds_read_b64_tr_b16 v[116:117], v32 offset:18624
    ds_read_b64_tr_b16 v[118:119], v32 offset:20928
    s_waitcnt lgkmcnt(10)
    v_mfma_f32_16x16x32_bf16 v[136:139], v[120:123], v[80:83], v[136:139]
    v_mfma_f32_16x16x32_bf16 v[140:143], v[120:123], v[84:87], v[140:143]
    ds_read_b64_tr_b16 v[120:121], v32 offset:18656
    ds_read_b64_tr_b16 v[122:123], v32 offset:20960
    s_waitcnt lgkmcnt(10)
    v_mfma_f32_16x16x32_bf16 v[144:147], v[124:127], v[80:83], v[144:147]
    v_mfma_f32_16x16x32_bf16 v[148:151], v[124:127], v[84:87], v[148:151]
    ds_read_b64_tr_b16 v[124:125], v32 offset:18688
    ds_read_b64_tr_b16 v[126:127], v32 offset:20992
    s_waitcnt lgkmcnt(10)
    v_mfma_f32_16x16x32_bf16 v[152:155], v[104:107], v[80:83], v[152:155]
    v_mfma_f32_16x16x32_bf16 v[156:159], v[104:107], v[84:87], v[156:159]
    ds_read_b64_tr_b16 v[104:105], v33 offset:0
    ds_read_b64_tr_b16 v[106:107], v33 offset:2304
    s_waitcnt lgkmcnt(10)
    v_mfma_f32_16x16x32_bf16 v[160:163], v[108:111], v[80:83], v[160:163]
    v_mfma_f32_16x16x32_bf16 v[164:167], v[108:111], v[84:87], v[164:167]
    ds_read_b64_tr_b16 v[108:109], v33 offset:32
    ds_read_b64_tr_b16 v[110:111], v33 offset:2336
    s_waitcnt lgkmcnt(10)
    v_mfma_f32_16x16x32_bf16 v[168:171], v[112:115], v[80:83], v[168:171]
    v_mfma_f32_16x16x32_bf16 v[172:175], v[112:115], v[84:87], v[172:175]
    ds_read_b64_tr_b16 v[112:113], v33 offset:64
    ds_read_b64_tr_b16 v[114:115], v33 offset:2368
    s_waitcnt lgkmcnt(10)
    v_mfma_f32_16x16x32_bf16 v[176:179], v[116:119], v[80:83], v[176:179]
    v_mfma_f32_16x16x32_bf16 v[180:183], v[116:119], v[84:87], v[180:183]
    ds_read_b64_tr_b16 v[116:117], v33 offset:96
    ds_read_b64_tr_b16 v[118:119], v33 offset:2400
    s_waitcnt lgkmcnt(10)
    v_mfma_f32_16x16x32_bf16 v[184:187], v[120:123], v[80:83], v[184:187]
    v_mfma_f32_16x16x32_bf16 v[188:191], v[120:123], v[84:87], v[188:191]
    ds_read_b64_tr_b16 v[120:121], v33 offset:128
    ds_read_b64_tr_b16 v[122:123], v33 offset:2432
    s_waitcnt lgkmcnt(10)
    v_mfma_f32_16x16x32_bf16 v[192:195], v[124:127], v[80:83], v[192:195]
    v_mfma_f32_16x16x32_bf16 v[196:199], v[124:127], v[84:87], v[196:199]
    s_waitcnt vmcnt(4)
    s_barrier
    ds_read_b64_tr_b16 v[124:125], v33 offset:160
    ds_read_b64_tr_b16 v[126:127], v33 offset:2464
    s_waitcnt lgkmcnt(10)
    v_mfma_f32_16x16x32_bf16 v[128:131], v[104:107], v[88:91], v[128:131]
    v_mfma_f32_16x16x32_bf16 v[132:135], v[104:107], v[92:95], v[132:135]
    ds_read_b64_tr_b16 v[104:105], v33 offset:192
    ds_read_b64_tr_b16 v[106:107], v33 offset:2496
    s_waitcnt lgkmcnt(10)
    v_mfma_f32_16x16x32_bf16 v[136:139], v[108:111], v[88:91], v[136:139]
    v_mfma_f32_16x16x32_bf16 v[140:143], v[108:111], v[92:95], v[140:143]
    ds_read_b64_tr_b16 v[108:109], v33 offset:224
    ds_read_b64_tr_b16 v[110:111], v33 offset:2528
    s_waitcnt lgkmcnt(10)
    v_mfma_f32_16x16x32_bf16 v[144:147], v[112:115], v[88:91], v[144:147]
    v_mfma_f32_16x16x32_bf16 v[148:151], v[112:115], v[92:95], v[148:151]
    ds_read_b64_tr_b16 v[112:113], v33 offset:256
    ds_read_b64_tr_b16 v[114:115], v33 offset:2560
    s_waitcnt lgkmcnt(10)
    v_mfma_f32_16x16x32_bf16 v[152:155], v[116:119], v[88:91], v[152:155]
    v_mfma_f32_16x16x32_bf16 v[156:159], v[116:119], v[92:95], v[156:159]
    ds_read_b64_tr_b16 v[116:117], v33 offset:18432
    ds_read_b64_tr_b16 v[118:119], v33 offset:20736
    s_waitcnt lgkmcnt(10)
    v_mfma_f32_16x16x32_bf16 v[160:163], v[120:123], v[88:91], v[160:163]
    v_mfma_f32_16x16x32_bf16 v[164:167], v[120:123], v[92:95], v[164:167]
    ds_read_b64_tr_b16 v[120:121], v33 offset:18464
    ds_read_b64_tr_b16 v[122:123], v33 offset:20768
    s_waitcnt lgkmcnt(10)
    v_mfma_f32_16x16x32_bf16 v[168:171], v[124:127], v[88:91], v[168:171]
    v_mfma_f32_16x16x32_bf16 v[172:175], v[124:127], v[92:95], v[172:175]
    ds_read_b64_tr_b16 v[124:125], v33 offset:18496
    ds_read_b64_tr_b16 v[126:127], v33 offset:20800
    s_waitcnt lgkmcnt(10)
    v_mfma_f32_16x16x32_bf16 v[176:179], v[104:107], v[88:91], v[176:179]
    v_mfma_f32_16x16x32_bf16 v[180:183], v[104:107], v[92:95], v[180:183]
    ds_read_b64_tr_b16 v[104:105], v33 offset:18528
    ds_read_b64_tr_b16 v[106:107], v33 offset:20832
    s_waitcnt lgkmcnt(10)
    v_mfma_f32_16x16x32_bf16 v[184:187], v[108:111], v[88:91], v[184:187]
    v_mfma_f32_16x16x32_bf16 v[188:191], v[108:111], v[92:95], v[188:191]
    ds_read_b64_tr_b16 v[108:109], v33 offset:18560
    ds_read_b64_tr_b16 v[110:111], v33 offset:20864
    s_waitcnt lgkmcnt(10)
    v_mfma_f32_16x16x32_bf16 v[192:195], v[112:115], v[88:91], v[192:195]
    v_mfma_f32_16x16x32_bf16 v[196:199], v[112:115], v[92:95], v[196:199]
    ds_read_b64_tr_b16 v[112:113], v33 offset:18592
    ds_read_b64_tr_b16 v[114:115], v33 offset:20896
    s_waitcnt lgkmcnt(10)
    v_mfma_f32_16x16x32_bf16 v[128:131], v[116:119], v[96:99], v[128:131]
    v_mfma_f32_16x16x32_bf16 v[132:135], v[116:119], v[100:103], v[132:135]
    ds_read_b64_tr_b16 v[116:117], v33 offset:18624
    ds_read_b64_tr_b16 v[118:119], v33 offset:20928
    s_waitcnt lgkmcnt(10)
    v_mfma_f32_16x16x32_bf16 v[136:139], v[120:123], v[96:99], v[136:139]
    v_mfma_f32_16x16x32_bf16 v[140:143], v[120:123], v[100:103], v[140:143]
    ds_read_b64_tr_b16 v[120:121], v33 offset:18656
    ds_read_b64_tr_b16 v[122:123], v33 offset:20960
    s_waitcnt lgkmcnt(10)
    v_mfma_f32_16x16x32_bf16 v[144:147], v[124:127], v[96:99], v[144:147]
    v_mfma_f32_16x16x32_bf16 v[148:151], v[124:127], v[100:103], v[148:151]
    ds_read_b64_tr_b16 v[124:125], v33 offset:18688
    ds_read_b64_tr_b16 v[126:127], v33 offset:20992
    s_waitcnt lgkmcnt(10)
    v_mfma_f32_16x16x32_bf16 v[152:155], v[104:107], v[96:99], v[152:155]
    v_mfma_f32_16x16x32_bf16 v[156:159], v[104:107], v[100:103], v[156:159]
    ds_read_b64_tr_b16 v[104:105], v30 offset:0
    ds_read_b64_tr_b16 v[106:107], v30 offset:2304
    s_waitcnt lgkmcnt(10)
    v_mfma_f32_16x16x32_bf16 v[160:163], v[108:111], v[96:99], v[160:163]
    v_mfma_f32_16x16x32_bf16 v[164:167], v[108:111], v[100:103], v[164:167]
    ds_read_b64_tr_b16 v[108:109], v30 offset:32
    ds_read_b64_tr_b16 v[110:111], v30 offset:2336
    s_waitcnt lgkmcnt(10)
    v_mfma_f32_16x16x32_bf16 v[168:171], v[112:115], v[96:99], v[168:171]
    v_mfma_f32_16x16x32_bf16 v[172:175], v[112:115], v[100:103], v[172:175]
    ds_read_b64_tr_b16 v[112:113], v30 offset:64
    ds_read_b64_tr_b16 v[114:115], v30 offset:2368
    s_waitcnt lgkmcnt(10)
    v_mfma_f32_16x16x32_bf16 v[176:179], v[116:119], v[96:99], v[176:179]
    v_mfma_f32_16x16x32_bf16 v[180:183], v[116:119], v[100:103], v[180:183]
    ds_read_b64_tr_b16 v[116:117], v30 offset:96
    ds_read_b64_tr_b16 v[118:119], v30 offset:2400
    s_waitcnt lgkmcnt(10)
    v_mfma_f32_16x16x32_bf16 v[184:187], v[120:123], v[96:99], v[184:187]
    v_mfma_f32_16x16x32_bf16 v[188:191], v[120:123], v[100:103], v[188:191]
    ds_read_b64_tr_b16 v[120:121], v30 offset:128
    ds_read_b64_tr_b16 v[122:123], v30 offset:2432
    s_waitcnt lgkmcnt(10)
    v_mfma_f32_16x16x32_bf16 v[192:195], v[124:127], v[96:99], v[192:195]
    v_mfma_f32_16x16x32_bf16 v[196:199], v[124:127], v[100:103], v[196:199]
    s_waitcnt vmcnt(0)
    s_barrier
    ds_read_b64_tr_b16 v[124:125], v30 offset:160
    ds_read_b64_tr_b16 v[126:127], v30 offset:2464
    s_waitcnt lgkmcnt(10)
    v_mfma_f32_16x16x32_bf16 v[128:131], v[104:107], v[40:43], v[128:131]
    v_mfma_f32_16x16x32_bf16 v[132:135], v[104:107], v[44:47], v[132:135]
    ds_read_b64_tr_b16 v[104:105], v30 offset:192
    ds_read_b64_tr_b16 v[106:107], v30 offset:2496
    s_waitcnt lgkmcnt(10)
    v_mfma_f32_16x16x32_bf16 v[136:139], v[108:111], v[40:43], v[136:139]
    v_mfma_f32_16x16x32_bf16 v[140:143], v[108:111], v[44:47], v[140:143]
    ds_read_b64_tr_b16 v[108:109], v30 offset:224
    ds_read_b64_tr_b16 v[110:111], v30 offset:2528
    s_waitcnt lgkmcnt(10)
    v_mfma_f32_16x16x32_bf16 v[144:147], v[112:115], v[40:43], v[144:147]
    v_mfma_f32_16x16x32_bf16 v[148:151], v[112:115], v[44:47], v[148:151]
    ds_read_b64_tr_b16 v[112:113], v30 offset:256
    ds_read_b64_tr_b16 v[114:115], v30 offset:2560
    s_waitcnt lgkmcnt(10)
    v_mfma_f32_16x16x32_bf16 v[152:155], v[116:119], v[40:43], v[152:155]
    v_mfma_f32_16x16x32_bf16 v[156:159], v[116:119], v[44:47], v[156:159]
    ds_read_b64_tr_b16 v[116:117], v30 offset:18432
    ds_read_b64_tr_b16 v[118:119], v30 offset:20736
    s_waitcnt lgkmcnt(10)
    v_mfma_f32_16x16x32_bf16 v[160:163], v[120:123], v[40:43], v[160:163]
    v_mfma_f32_16x16x32_bf16 v[164:167], v[120:123], v[44:47], v[164:167]
    ds_read_b64_tr_b16 v[120:121], v30 offset:18464
    ds_read_b64_tr_b16 v[122:123], v30 offset:20768
    s_waitcnt lgkmcnt(10)
    v_mfma_f32_16x16x32_bf16 v[168:171], v[124:127], v[40:43], v[168:171]
    v_mfma_f32_16x16x32_bf16 v[172:175], v[124:127], v[44:47], v[172:175]
    ds_read_b64_tr_b16 v[124:125], v30 offset:18496
    ds_read_b64_tr_b16 v[126:127], v30 offset:20800
    s_waitcnt lgkmcnt(10)
    v_mfma_f32_16x16x32_bf16 v[176:179], v[104:107], v[40:43], v[176:179]
    v_mfma_f32_16x16x32_bf16 v[180:183], v[104:107], v[44:47], v[180:183]
    ds_read_b64_tr_b16 v[104:105], v30 offset:18528
    ds_read_b64_tr_b16 v[106:107], v30 offset:20832
    s_waitcnt lgkmcnt(10)
    v_mfma_f32_16x16x32_bf16 v[184:187], v[108:111], v[40:43], v[184:187]
    v_mfma_f32_16x16x32_bf16 v[188:191], v[108:111], v[44:47], v[188:191]
    ds_read_b64_tr_b16 v[108:109], v30 offset:18560
    ds_read_b64_tr_b16 v[110:111], v30 offset:20864
    s_waitcnt lgkmcnt(10)
    v_mfma_f32_16x16x32_bf16 v[192:195], v[112:115], v[40:43], v[192:195]
    v_mfma_f32_16x16x32_bf16 v[196:199], v[112:115], v[44:47], v[196:199]
    ds_read_b64_tr_b16 v[112:113], v30 offset:18592
    ds_read_b64_tr_b16 v[114:115], v30 offset:20896
    s_waitcnt lgkmcnt(10)
    v_mfma_f32_16x16x32_bf16 v[128:131], v[116:119], v[48:51], v[128:131]
    v_mfma_f32_16x16x32_bf16 v[132:135], v[116:119], v[52:55], v[132:135]
    ds_read_b64_tr_b16 v[116:117], v30 offset:18624
    ds_read_b64_tr_b16 v[118:119], v30 offset:20928
    s_waitcnt lgkmcnt(10)
    v_mfma_f32_16x16x32_bf16 v[136:139], v[120:123], v[48:51], v[136:139]
    v_mfma_f32_16x16x32_bf16 v[140:143], v[120:123], v[52:55], v[140:143]
    ds_read_b64_tr_b16 v[120:121], v30 offset:18656
    ds_read_b64_tr_b16 v[122:123], v30 offset:20960
    s_waitcnt lgkmcnt(10)
    v_mfma_f32_16x16x32_bf16 v[144:147], v[124:127], v[48:51], v[144:147]
    v_mfma_f32_16x16x32_bf16 v[148:151], v[124:127], v[52:55], v[148:151]
    ds_read_b64_tr_b16 v[124:125], v30 offset:18688
    ds_read_b64_tr_b16 v[126:127], v30 offset:20992
    s_waitcnt lgkmcnt(10)
    v_mfma_f32_16x16x32_bf16 v[152:155], v[104:107], v[48:51], v[152:155]
    v_mfma_f32_16x16x32_bf16 v[156:159], v[104:107], v[52:55], v[156:159]
    s_waitcnt lgkmcnt(8)
    v_mfma_f32_16x16x32_bf16 v[160:163], v[108:111], v[48:51], v[160:163]
    v_mfma_f32_16x16x32_bf16 v[164:167], v[108:111], v[52:55], v[164:167]
    s_waitcnt lgkmcnt(6)
    v_mfma_f32_16x16x32_bf16 v[168:171], v[112:115], v[48:51], v[168:171]
    v_mfma_f32_16x16x32_bf16 v[172:175], v[112:115], v[52:55], v[172:175]
    s_waitcnt lgkmcnt(4)
    v_mfma_f32_16x16x32_bf16 v[176:179], v[116:119], v[48:51], v[176:179]
    v_mfma_f32_16x16x32_bf16 v[180:183], v[116:119], v[52:55], v[180:183]
    s_waitcnt lgkmcnt(2)
    v_mfma_f32_16x16x32_bf16 v[184:187], v[120:123], v[48:51], v[184:187]
    v_mfma_f32_16x16x32_bf16 v[188:191], v[120:123], v[52:55], v[188:191]
    s_waitcnt lgkmcnt(0)
    v_mfma_f32_16x16x32_bf16 v[192:195], v[124:127], v[48:51], v[192:195]
    v_mfma_f32_16x16x32_bf16 v[196:199], v[124:127], v[52:55], v[196:199]
    s_mul_i32 s30, s3, 9216
    s_add_u32 s30, s30, 36864
    v_add_u32 v3, s30, v39
    s_xor_b32 s31, s3, 4
    s_mul_i32 s31, s31, 9216
    s_add_u32 s31, s31, 36864
    v_add_u32 v4, s31, v39
    s_lshl_b32 s31, s33, 1
    s_add_u32 s41, s31, s34
    s_lshl_b32 s30, s29, 3
    s_add_u32 s30, s30, s41
    s_mul_i32 s54, s30, 18432
    s_mul_i32 s31, s28, 288
    s_add_u32 s54, s54, s31
    s_mul_i32 s30, s30, 36
    s_mul_i32 s31, s28, 9
    s_add_u32 s30, s30, s31
    s_lshl_b32 s30, s30, 10
    s_mul_i32 s31, s32, 4718592
    s_add_u32 s22, s30, s31
    s_add_u32 s23, s22, 4096
    s_add_u32 s40, s22, 8192
    s_sub_u32 s41, s32, s41
    s_and_b32 s41, s41, 3
    s_lshl_b32 s55, s29, 2
    s_add_u32 s55, s55, s28
    s_lshl_b32 s55, s55, 7
    v_and_b32 v5, 15, v1
    v_mul_u32_u24 v5, 1152, v5
    v_lshrrev_b32 v6, 4, v1
    v_lshl_add_u32 v5, v6, 3, v5
    s_cmp_eq_u32 s34, 1
    s_cbranch_scc1 G2_kg1

    ds_write_b128 v3, v[132:135] offset:0
    ds_write_b128 v3, v[140:143] offset:1024
    ds_write_b128 v3, v[148:151] offset:2048
    ds_write_b128 v3, v[156:159] offset:3072
    ds_write_b128 v3, v[164:167] offset:4096
    ds_write_b128 v3, v[172:175] offset:5120
    ds_write_b128 v3, v[180:183] offset:6144
    ds_write_b128 v3, v[188:191] offset:7168
    ds_write_b128 v3, v[196:199] offset:8192
    s_waitcnt lgkmcnt(0)
    s_barrier
    ds_read_b128 v[40:43], v4 offset:0
    ds_read_b128 v[44:47], v4 offset:1024
    ds_read_b128 v[48:51], v4 offset:2048
    ds_read_b128 v[52:55], v4 offset:3072
    ds_read_b128 v[56:59], v4 offset:4096
    ds_read_b128 v[60:63], v4 offset:5120
    ds_read_b128 v[64:67], v4 offset:6144
    ds_read_b128 v[68:71], v4 offset:7168
    ds_read_b128 v[72:75], v4 offset:8192
    s_waitcnt lgkmcnt(8)
    v_add_f32 v40, v40, v128
    v_add_f32 v41, v41, v129
    v_add_f32 v42, v42, v130
    v_add_f32 v43, v43, v131
    s_waitcnt lgkmcnt(7)
    v_add_f32 v44, v44, v136
    v_add_f32 v45, v45, v137
    v_add_f32 v46, v46, v138
    v_add_f32 v47, v47, v139
    s_waitcnt lgkmcnt(6)
    v_add_f32 v48, v48, v144
    v_add_f32 v49, v49, v145
    v_add_f32 v50, v50, v146
    v_add_f32 v51, v51, v147
    s_waitcnt lgkmcnt(5)
    v_add_f32 v52, v52, v152
    v_add_f32 v53, v53, v153
    v_add_f32 v54, v54, v154
    v_add_f32 v55, v55, v155
    s_waitcnt lgkmcnt(4)
    v_add_f32 v56, v56, v160
    v_add_f32 v57, v57, v161
    v_add_f32 v58, v58, v162
    v_add_f32 v59, v59, v163
    s_waitcnt lgkmcnt(3)
    v_add_f32 v60, v60, v168
    v_add_f32 v61, v61, v169
    v_add_f32 v62, v62, v170
    v_add_f32 v63, v63, v171
    s_waitcnt lgkmcnt(2)
    v_add_f32 v64, v64, v176
    v_add_f32 v65, v65, v177
    v_add_f32 v66, v66, v178
    v_add_f32 v67, v67, v179
    s_waitcnt lgkmcnt(1)
    v_add_f32 v68, v68, v184
    v_add_f32 v69, v69, v185
    v_add_f32 v70, v70, v186
    v_add_f32 v71, v71, v187
    s_waitcnt lgkmcnt(0)
    v_add_f32 v72, v72, v192
    v_add_f32 v73, v73, v193
    v_add_f32 v74, v74, v194
    v_add_f32 v75, v75, v195
    s_branch G2_common
G2_kg1:
    ds_write_b128 v3, v[128:131] offset:0
    ds_write_b128 v3, v[136:139] offset:1024
    ds_write_b128 v3, v[144:147] offset:2048
    ds_write_b128 v3, v[152:155] offset:3072
    ds_write_b128 v3, v[160:163] offset:4096
    ds_write_b128 v3, v[168:171] offset:5120
    ds_write_b128 v3, v[176:179] offset:6144
    ds_write_b128 v3, v[184:187] offset:7168
    ds_write_b128 v3, v[192:195] offset:8192
    s_waitcnt lgkmcnt(0)
    s_barrier
    ds_read_b128 v[40:43], v4 offset:0
    ds_read_b128 v[44:47], v4 offset:1024
    ds_read_b128 v[48:51], v4 offset:2048
    ds_read_b128 v[52:55], v4 offset:3072
    ds_read_b128 v[56:59], v4 offset:4096
    ds_read_b128 v[60:63], v4 offset:5120
    ds_read_b128 v[64:67], v4 offset:6144
    ds_read_b128 v[68:71], v4 offset:7168
    ds_read_b128 v[72:75], v4 offset:8192
    s_waitcnt lgkmcnt(8)
    v_add_f32 v40, v40, v132
    v_add_f32 v41, v41, v133
    v_add_f32 v42, v42, v134
    v_add_f32 v43, v43, v135
    s_waitcnt lgkmcnt(7)
    v_add_f32 v44, v44, v140
    v_add_f32 v45, v45, v141
    v_add_f32 v46, v46, v142
    v_add_f32 v47, v47, v143
    s_waitcnt lgkmcnt(6)
    v_add_f32 v48, v48, v148
    v_add_f32 v49, v49, v149
    v_add_f32 v50, v50, v150
    v_add_f32 v51, v51, v151
    s_waitcnt lgkmcnt(5)
    v_add_f32 v52, v52, v156
    v_add_f32 v53, v53, v157
    v_add_f32 v54, v54, v158
    v_add_f32 v55, v55, v159
    s_waitcnt lgkmcnt(4)
    v_add_f32 v56, v56, v164
    v_add_f32 v57, v57, v165
    v_add_f32 v58, v58, v166
    v_add_f32 v59, v59, v167
    s_waitcnt lgkmcnt(3)
    v_add_f32 v60, v60, v172
    v_add_f32 v61, v61, v173
    v_add_f32 v62, v62, v174
    v_add_f32 v63, v63, v175
    s_waitcnt lgkmcnt(2)
    v_add_f32 v64, v64, v180
    v_add_f32 v65, v65, v181
    v_add_f32 v66, v66, v182
    v_add_f32 v67, v67, v183
    s_waitcnt lgkmcnt(1)
    v_add_f32 v68, v68, v188
    v_add_f32 v69, v69, v189
    v_add_f32 v70, v70, v190
    v_add_f32 v71, v71, v191
    s_waitcnt lgkmcnt(0)
    v_add_f32 v72, v72, v196
    v_add_f32 v73, v73, v197
    v_add_f32 v74, v74, v198
    v_add_f32 v75, v75, v199
G2_common:
    s_add_u32 s8, s24, 0x480000
    s_addc_u32 s9, s25, 0
    s_mov_b32 s10, 0x240000
    s_mov_b32 s11, 0x20000
    s_mov_b32 s12, s6
    s_mov_b32 s13, s7
    s_mov_b32 s14, 0x240000
    s_mov_b32 s15, 0x20000
    s_add_u32 s48, s24, 0x2f40000
    s_addc_u32 s49, s25, 0
    s_mov_b32 s50, 0x20000
    s_mov_b32 s51, 0x20000
    s_add_u32 s31, s32, 1
    s_and_b32 s31, s31, 3
    s_mul_i32 s31, s31, 4718592
    s_add_u32 s56, s30, s31

    s_add_u32 s31, s32, 2
    s_and_b32 s31, s31, 3
    s_mul_i32 s31, s31, 4718592
    s_add_u32 s57, s30, s31

    s_add_u32 s31, s32, 3
    s_and_b32 s31, s31, 3
    s_mul_i32 s31, s31, 4718592
    s_add_u32 s58, s30, s31

    s_cmp_eq_u32 s41, 1
    s_cbranch_scc1 G2_c1
    s_cmp_eq_u32 s41, 2
    s_cbranch_scc1 G2_c2
    s_cmp_eq_u32 s41, 3
    s_cbranch_scc1 G2_c3
    buffer_store_dwordx4 v[44:47], v39, s[16:19], s22 offen offset:1024 sc1
    buffer_store_dwordx4 v[48:51], v39, s[16:19], s22 offen offset:2048 sc1
    buffer_store_dwordx4 v[52:55], v39, s[16:19], s22 offen offset:3072 sc1
    buffer_store_dwordx4 v[60:63], v39, s[16:19], s23 offen offset:1024 sc1
    buffer_store_dwordx4 v[64:67], v39, s[16:19], s23 offen offset:2048 sc1
    buffer_store_dwordx4 v[68:71], v39, s[16:19], s23 offen offset:3072 sc1
    buffer_load_dword v80, v5, s[8:11], s54 offen offset:0 sc1
    buffer_load_dword v81, v5, s[8:11], s54 offen offset:4 sc1
    buffer_load_dword v82, v5, s[8:11], s54 offen offset:128 sc1
    buffer_load_dword v83, v5, s[8:11], s54 offen offset:132 sc1
    buffer_load_dword v84, v5, s[8:11], s54 offen offset:256 sc1
    buffer_load_dword v85, v5, s[8:11], s54 offen offset:260 sc1
    s_waitcnt vmcnt(0)

    s_barrier
    s_cmp_lg_u32 s3, 0
    s_cbranch_scc1 G2_w0
    v_mov_b32 v6, 0
    v_mov_b32 v7, 1
    s_mov_b64 exec, 1
    buffer_atomic_add v7, v6, s[48:51], s55 offen sc1
    s_mov_b32 s39, 0

G2_p0:
    s_sleep 2
    buffer_load_dword v7, v6, s[48:51], s55 offen sc1
    s_waitcnt vmcnt(0)
    v_readfirstlane_b32 s31, v7
    s_add_u32 s39, s39, 1
    s_lshr_b32 s59, s39, 18
    s_add_u32 s31, s31, s59
    s_cmp_lt_u32 s31, 4
    s_cbranch_scc1 G2_p0
    s_mov_b64 exec, -1

G2_w0:
    s_barrier
    buffer_load_dwordx4 v[88:91], v39, s[16:19], s56 offen offset:0 sc1
    buffer_load_dwordx4 v[92:95], v39, s[16:19], s57 offen offset:0 sc1
    buffer_load_dwordx4 v[96:99], v39, s[16:19], s58 offen offset:0 sc1
    s_add_u32 s56, s56, 4096
    s_add_u32 s57, s57, 4096
    s_add_u32 s58, s58, 4096
    buffer_load_dwordx4 v[100:103], v39, s[16:19], s56 offen offset:0 sc1
    buffer_load_dwordx4 v[104:107], v39, s[16:19], s57 offen offset:0 sc1
    buffer_load_dwordx4 v[108:111], v39, s[16:19], s58 offen offset:0 sc1
    s_add_u32 s56, s56, 4096
    s_add_u32 s57, s57, 4096
    s_add_u32 s58, s58, 4096
    buffer_load_dwordx4 v[112:115], v39, s[16:19], s56 offen offset:0 sc1
    buffer_load_dwordx4 v[116:119], v39, s[16:19], s57 offen offset:0 sc1
    buffer_load_dwordx4 v[120:123], v39, s[16:19], s58 offen offset:0 sc1
    s_waitcnt vmcnt(6)
    v_add_f32 v40, v40, v88
    v_add_f32 v41, v41, v89
    v_add_f32 v42, v42, v90
    v_add_f32 v43, v43, v91
    v_add_f32 v92, v92, v96
    v_add_f32 v93, v93, v97
    v_add_f32 v94, v94, v98
    v_add_f32 v95, v95, v99
    v_add_f32 v40, v40, v92
    v_add_f32 v41, v41, v93
    v_add_f32 v42, v42, v94
    v_add_f32 v43, v43, v95
    v_cvt_pk_bf16_f32 v88, v40, v41
    v_cvt_pk_bf16_f32 v89, v42, v43
    v_lshlrev_b32 v40, 16, v88
    v_and_b32 v41, 0xffff0000, v88
    v_lshlrev_b32 v92, 16, v80
    v_and_b32 v93, 0xffff0000, v80
    v_lshlrev_b32 v42, 16, v89
    v_and_b32 v43, 0xffff0000, v89
    v_lshlrev_b32 v94, 16, v81
    v_and_b32 v95, 0xffff0000, v81
    v_add_f32 v40, v40, v92
    v_add_f32 v41, v41, v93
    v_add_f32 v42, v42, v94
    v_add_f32 v43, v43, v95
    v_cvt_pk_bf16_f32 v88, v40, v41
    v_cvt_pk_bf16_f32 v89, v42, v43
    buffer_store_dwordx2 v[88:89], v5, s[12:15], s54 offen offset:0
    s_waitcnt vmcnt(4)
    v_add_f32 v56, v56, v100
    v_add_f32 v57, v57, v101
    v_add_f32 v58, v58, v102
    v_add_f32 v59, v59, v103
    v_add_f32 v104, v104, v108
    v_add_f32 v105, v105, v109
    v_add_f32 v106, v106, v110
    v_add_f32 v107, v107, v111
    v_add_f32 v56, v56, v104
    v_add_f32 v57, v57, v105
    v_add_f32 v58, v58, v106
    v_add_f32 v59, v59, v107
    v_cvt_pk_bf16_f32 v100, v56, v57
    v_cvt_pk_bf16_f32 v101, v58, v59
    v_lshlrev_b32 v56, 16, v100
    v_and_b32 v57, 0xffff0000, v100
    v_lshlrev_b32 v104, 16, v82
    v_and_b32 v105, 0xffff0000, v82
    v_lshlrev_b32 v58, 16, v101
    v_and_b32 v59, 0xffff0000, v101
    v_lshlrev_b32 v106, 16, v83
    v_and_b32 v107, 0xffff0000, v83
    v_add_f32 v56, v56, v104
    v_add_f32 v57, v57, v105
    v_add_f32 v58, v58, v106
    v_add_f32 v59, v59, v107
    v_cvt_pk_bf16_f32 v100, v56, v57
    v_cvt_pk_bf16_f32 v101, v58, v59
    buffer_store_dwordx2 v[100:101], v5, s[12:15], s54 offen offset:128
    s_waitcnt vmcnt(2)
    v_add_f32 v72, v72, v112
    v_add_f32 v73, v73, v113
    v_add_f32 v74, v74, v114
    v_add_f32 v75, v75, v115
    v_add_f32 v116, v116, v120
    v_add_f32 v117, v117, v121
    v_add_f32 v118, v118, v122
    v_add_f32 v119, v119, v123
    v_add_f32 v72, v72, v116
    v_add_f32 v73, v73, v117
    v_add_f32 v74, v74, v118
    v_add_f32 v75, v75, v119
    v_cvt_pk_bf16_f32 v112, v72, v73
    v_cvt_pk_bf16_f32 v113, v74, v75
    v_lshlrev_b32 v72, 16, v112
    v_and_b32 v73, 0xffff0000, v112
    v_lshlrev_b32 v116, 16, v84
    v_and_b32 v117, 0xffff0000, v84
    v_lshlrev_b32 v74, 16, v113
    v_and_b32 v75, 0xffff0000, v113
    v_lshlrev_b32 v118, 16, v85
    v_and_b32 v119, 0xffff0000, v85
    v_add_f32 v72, v72, v116
    v_add_f32 v73, v73, v117
    v_add_f32 v74, v74, v118
    v_add_f32 v75, v75, v119
    v_cvt_pk_bf16_f32 v112, v72, v73
    v_cvt_pk_bf16_f32 v113, v74, v75
    buffer_store_dwordx2 v[112:113], v5, s[12:15], s54 offen offset:256
    s_endpgm
G2_c1:
    buffer_store_dwordx4 v[40:43], v39, s[16:19], s22 offen offset:0 sc1
    buffer_store_dwordx4 v[48:51], v39, s[16:19], s22 offen offset:2048 sc1
    buffer_store_dwordx4 v[52:55], v39, s[16:19], s22 offen offset:3072 sc1
    buffer_store_dwordx4 v[56:59], v39, s[16:19], s23 offen offset:0 sc1
    buffer_store_dwordx4 v[64:67], v39, s[16:19], s23 offen offset:2048 sc1
    buffer_store_dwordx4 v[68:71], v39, s[16:19], s23 offen offset:3072 sc1
    buffer_store_dwordx4 v[72:75], v39, s[16:19], s40 offen offset:0 sc1
    buffer_load_dword v80, v5, s[8:11], s54 offen offset:32 sc1
    buffer_load_dword v81, v5, s[8:11], s54 offen offset:36 sc1
    buffer_load_dword v82, v5, s[8:11], s54 offen offset:160 sc1
    buffer_load_dword v83, v5, s[8:11], s54 offen offset:164 sc1
    s_waitcnt vmcnt(0)

    s_barrier
    s_cmp_lg_u32 s3, 0
    s_cbranch_scc1 G2_w1
    v_mov_b32 v6, 0
    v_mov_b32 v7, 1
    s_mov_b64 exec, 1
    buffer_atomic_add v7, v6, s[48:51], s55 offen sc1
    s_mov_b32 s39, 0

G2_p1:
    s_sleep 2
    buffer_load_dword v7, v6, s[48:51], s55 offen sc1
    s_waitcnt vmcnt(0)
    v_readfirstlane_b32 s31, v7
    s_add_u32 s39, s39, 1
    s_lshr_b32 s59, s39, 18
    s_add_u32 s31, s31, s59
    s_cmp_lt_u32 s31, 4
    s_cbranch_scc1 G2_p1
    s_mov_b64 exec, -1

G2_w1:
    s_barrier
    buffer_load_dwordx4 v[88:91], v39, s[16:19], s56 offen offset:1024 sc1
    buffer_load_dwordx4 v[92:95], v39, s[16:19], s57 offen offset:1024 sc1
    buffer_load_dwordx4 v[96:99], v39, s[16:19], s58 offen offset:1024 sc1
    s_add_u32 s56, s56, 4096
    s_add_u32 s57, s57, 4096
    s_add_u32 s58, s58, 4096
    buffer_load_dwordx4 v[100:103], v39, s[16:19], s56 offen offset:1024 sc1
    buffer_load_dwordx4 v[104:107], v39, s[16:19], s57 offen offset:1024 sc1
    buffer_load_dwordx4 v[108:111], v39, s[16:19], s58 offen offset:1024 sc1
    s_waitcnt vmcnt(3)
    v_add_f32 v44, v44, v88
    v_add_f32 v45, v45, v89
    v_add_f32 v46, v46, v90
    v_add_f32 v47, v47, v91
    v_add_f32 v92, v92, v96
    v_add_f32 v93, v93, v97
    v_add_f32 v94, v94, v98
    v_add_f32 v95, v95, v99
    v_add_f32 v44, v44, v92
    v_add_f32 v45, v45, v93
    v_add_f32 v46, v46, v94
    v_add_f32 v47, v47, v95
    v_cvt_pk_bf16_f32 v88, v44, v45
    v_cvt_pk_bf16_f32 v89, v46, v47
    v_lshlrev_b32 v44, 16, v88
    v_and_b32 v45, 0xffff0000, v88
    v_lshlrev_b32 v92, 16, v80
    v_and_b32 v93, 0xffff0000, v80
    v_lshlrev_b32 v46, 16, v89
    v_and_b32 v47, 0xffff0000, v89
    v_lshlrev_b32 v94, 16, v81
    v_and_b32 v95, 0xffff0000, v81
    v_add_f32 v44, v44, v92
    v_add_f32 v45, v45, v93
    v_add_f32 v46, v46, v94
    v_add_f32 v47, v47, v95
    v_cvt_pk_bf16_f32 v88, v44, v45
    v_cvt_pk_bf16_f32 v89, v46, v47
    buffer_store_dwordx2 v[88:89], v5, s[12:15], s54 offen offset:32
    s_waitcnt vmcnt(1)
    v_add_f32 v60, v60, v100
    v_add_f32 v61, v61, v101
    v_add_f32 v62, v62, v102
    v_add_f32 v63, v63, v103
    v_add_f32 v104, v104, v108
    v_add_f32 v105, v105, v109
    v_add_f32 v106, v106, v110
    v_add_f32 v107, v107, v111
    v_add_f32 v60, v60, v104
    v_add_f32 v61, v61, v105
    v_add_f32 v62, v62, v106
    v_add_f32 v63, v63, v107
    v_cvt_pk_bf16_f32 v100, v60, v61
    v_cvt_pk_bf16_f32 v101, v62, v63
    v_lshlrev_b32 v60, 16, v100
    v_and_b32 v61, 0xffff0000, v100
    v_lshlrev_b32 v104, 16, v82
    v_and_b32 v105, 0xffff0000, v82
    v_lshlrev_b32 v62, 16, v101
    v_and_b32 v63, 0xffff0000, v101
    v_lshlrev_b32 v106, 16, v83
    v_and_b32 v107, 0xffff0000, v83
    v_add_f32 v60, v60, v104
    v_add_f32 v61, v61, v105
    v_add_f32 v62, v62, v106
    v_add_f32 v63, v63, v107
    v_cvt_pk_bf16_f32 v100, v60, v61
    v_cvt_pk_bf16_f32 v101, v62, v63
    buffer_store_dwordx2 v[100:101], v5, s[12:15], s54 offen offset:160
    s_endpgm
G2_c2:
    buffer_store_dwordx4 v[40:43], v39, s[16:19], s22 offen offset:0 sc1
    buffer_store_dwordx4 v[44:47], v39, s[16:19], s22 offen offset:1024 sc1
    buffer_store_dwordx4 v[52:55], v39, s[16:19], s22 offen offset:3072 sc1
    buffer_store_dwordx4 v[56:59], v39, s[16:19], s23 offen offset:0 sc1
    buffer_store_dwordx4 v[60:63], v39, s[16:19], s23 offen offset:1024 sc1
    buffer_store_dwordx4 v[68:71], v39, s[16:19], s23 offen offset:3072 sc1
    buffer_store_dwordx4 v[72:75], v39, s[16:19], s40 offen offset:0 sc1
    buffer_load_dword v80, v5, s[8:11], s54 offen offset:64 sc1
    buffer_load_dword v81, v5, s[8:11], s54 offen offset:68 sc1
    buffer_load_dword v82, v5, s[8:11], s54 offen offset:192 sc1
    buffer_load_dword v83, v5, s[8:11], s54 offen offset:196 sc1
    s_waitcnt vmcnt(0)

    s_barrier
    s_cmp_lg_u32 s3, 0
    s_cbranch_scc1 G2_w2
    v_mov_b32 v6, 0
    v_mov_b32 v7, 1
    s_mov_b64 exec, 1
    buffer_atomic_add v7, v6, s[48:51], s55 offen sc1
    s_mov_b32 s39, 0

G2_p2:
    s_sleep 2
    buffer_load_dword v7, v6, s[48:51], s55 offen sc1
    s_waitcnt vmcnt(0)
    v_readfirstlane_b32 s31, v7
    s_add_u32 s39, s39, 1
    s_lshr_b32 s59, s39, 18
    s_add_u32 s31, s31, s59
    s_cmp_lt_u32 s31, 4
    s_cbranch_scc1 G2_p2
    s_mov_b64 exec, -1

G2_w2:
    s_barrier
    buffer_load_dwordx4 v[88:91], v39, s[16:19], s56 offen offset:2048 sc1
    buffer_load_dwordx4 v[92:95], v39, s[16:19], s57 offen offset:2048 sc1
    buffer_load_dwordx4 v[96:99], v39, s[16:19], s58 offen offset:2048 sc1
    s_add_u32 s56, s56, 4096
    s_add_u32 s57, s57, 4096
    s_add_u32 s58, s58, 4096
    buffer_load_dwordx4 v[100:103], v39, s[16:19], s56 offen offset:2048 sc1
    buffer_load_dwordx4 v[104:107], v39, s[16:19], s57 offen offset:2048 sc1
    buffer_load_dwordx4 v[108:111], v39, s[16:19], s58 offen offset:2048 sc1
    s_waitcnt vmcnt(3)
    v_add_f32 v48, v48, v88
    v_add_f32 v49, v49, v89
    v_add_f32 v50, v50, v90
    v_add_f32 v51, v51, v91
    v_add_f32 v92, v92, v96
    v_add_f32 v93, v93, v97
    v_add_f32 v94, v94, v98
    v_add_f32 v95, v95, v99
    v_add_f32 v48, v48, v92
    v_add_f32 v49, v49, v93
    v_add_f32 v50, v50, v94
    v_add_f32 v51, v51, v95
    v_cvt_pk_bf16_f32 v88, v48, v49
    v_cvt_pk_bf16_f32 v89, v50, v51
    v_lshlrev_b32 v48, 16, v88
    v_and_b32 v49, 0xffff0000, v88
    v_lshlrev_b32 v92, 16, v80
    v_and_b32 v93, 0xffff0000, v80
    v_lshlrev_b32 v50, 16, v89
    v_and_b32 v51, 0xffff0000, v89
    v_lshlrev_b32 v94, 16, v81
    v_and_b32 v95, 0xffff0000, v81
    v_add_f32 v48, v48, v92
    v_add_f32 v49, v49, v93
    v_add_f32 v50, v50, v94
    v_add_f32 v51, v51, v95
    v_cvt_pk_bf16_f32 v88, v48, v49
    v_cvt_pk_bf16_f32 v89, v50, v51
    buffer_store_dwordx2 v[88:89], v5, s[12:15], s54 offen offset:64
    s_waitcnt vmcnt(1)
    v_add_f32 v64, v64, v100
    v_add_f32 v65, v65, v101
    v_add_f32 v66, v66, v102
    v_add_f32 v67, v67, v103
    v_add_f32 v104, v104, v108
    v_add_f32 v105, v105, v109
    v_add_f32 v106, v106, v110
    v_add_f32 v107, v107, v111
    v_add_f32 v64, v64, v104
    v_add_f32 v65, v65, v105
    v_add_f32 v66, v66, v106
    v_add_f32 v67, v67, v107
    v_cvt_pk_bf16_f32 v100, v64, v65
    v_cvt_pk_bf16_f32 v101, v66, v67
    v_lshlrev_b32 v64, 16, v100
    v_and_b32 v65, 0xffff0000, v100
    v_lshlrev_b32 v104, 16, v82
    v_and_b32 v105, 0xffff0000, v82
    v_lshlrev_b32 v66, 16, v101
    v_and_b32 v67, 0xffff0000, v101
    v_lshlrev_b32 v106, 16, v83
    v_and_b32 v107, 0xffff0000, v83
    v_add_f32 v64, v64, v104
    v_add_f32 v65, v65, v105
    v_add_f32 v66, v66, v106
    v_add_f32 v67, v67, v107
    v_cvt_pk_bf16_f32 v100, v64, v65
    v_cvt_pk_bf16_f32 v101, v66, v67
    buffer_store_dwordx2 v[100:101], v5, s[12:15], s54 offen offset:192
    s_endpgm
G2_c3:
    buffer_store_dwordx4 v[40:43], v39, s[16:19], s22 offen offset:0 sc1
    buffer_store_dwordx4 v[44:47], v39, s[16:19], s22 offen offset:1024 sc1
    buffer_store_dwordx4 v[48:51], v39, s[16:19], s22 offen offset:2048 sc1
    buffer_store_dwordx4 v[56:59], v39, s[16:19], s23 offen offset:0 sc1
    buffer_store_dwordx4 v[60:63], v39, s[16:19], s23 offen offset:1024 sc1
    buffer_store_dwordx4 v[64:67], v39, s[16:19], s23 offen offset:2048 sc1
    buffer_store_dwordx4 v[72:75], v39, s[16:19], s40 offen offset:0 sc1
    buffer_load_dword v80, v5, s[8:11], s54 offen offset:96 sc1
    buffer_load_dword v81, v5, s[8:11], s54 offen offset:100 sc1
    buffer_load_dword v82, v5, s[8:11], s54 offen offset:224 sc1
    buffer_load_dword v83, v5, s[8:11], s54 offen offset:228 sc1
    s_waitcnt vmcnt(0)

    s_barrier
    s_cmp_lg_u32 s3, 0
    s_cbranch_scc1 G2_w3
    v_mov_b32 v6, 0
    v_mov_b32 v7, 1
    s_mov_b64 exec, 1
    buffer_atomic_add v7, v6, s[48:51], s55 offen sc1
    s_mov_b32 s39, 0

G2_p3:
    s_sleep 2
    buffer_load_dword v7, v6, s[48:51], s55 offen sc1
    s_waitcnt vmcnt(0)
    v_readfirstlane_b32 s31, v7
    s_add_u32 s39, s39, 1
    s_lshr_b32 s59, s39, 18
    s_add_u32 s31, s31, s59
    s_cmp_lt_u32 s31, 4
    s_cbranch_scc1 G2_p3
    s_mov_b64 exec, -1

G2_w3:
    s_barrier
    buffer_load_dwordx4 v[88:91], v39, s[16:19], s56 offen offset:3072 sc1
    buffer_load_dwordx4 v[92:95], v39, s[16:19], s57 offen offset:3072 sc1
    buffer_load_dwordx4 v[96:99], v39, s[16:19], s58 offen offset:3072 sc1
    s_add_u32 s56, s56, 4096
    s_add_u32 s57, s57, 4096
    s_add_u32 s58, s58, 4096
    buffer_load_dwordx4 v[100:103], v39, s[16:19], s56 offen offset:3072 sc1
    buffer_load_dwordx4 v[104:107], v39, s[16:19], s57 offen offset:3072 sc1
    buffer_load_dwordx4 v[108:111], v39, s[16:19], s58 offen offset:3072 sc1
    s_waitcnt vmcnt(3)
    v_add_f32 v52, v52, v88
    v_add_f32 v53, v53, v89
    v_add_f32 v54, v54, v90
    v_add_f32 v55, v55, v91
    v_add_f32 v92, v92, v96
    v_add_f32 v93, v93, v97
    v_add_f32 v94, v94, v98
    v_add_f32 v95, v95, v99
    v_add_f32 v52, v52, v92
    v_add_f32 v53, v53, v93
    v_add_f32 v54, v54, v94
    v_add_f32 v55, v55, v95
    v_cvt_pk_bf16_f32 v88, v52, v53
    v_cvt_pk_bf16_f32 v89, v54, v55
    v_lshlrev_b32 v52, 16, v88
    v_and_b32 v53, 0xffff0000, v88
    v_lshlrev_b32 v92, 16, v80
    v_and_b32 v93, 0xffff0000, v80
    v_lshlrev_b32 v54, 16, v89
    v_and_b32 v55, 0xffff0000, v89
    v_lshlrev_b32 v94, 16, v81
    v_and_b32 v95, 0xffff0000, v81
    v_add_f32 v52, v52, v92
    v_add_f32 v53, v53, v93
    v_add_f32 v54, v54, v94
    v_add_f32 v55, v55, v95
    v_cvt_pk_bf16_f32 v88, v52, v53
    v_cvt_pk_bf16_f32 v89, v54, v55
    buffer_store_dwordx2 v[88:89], v5, s[12:15], s54 offen offset:96
    s_waitcnt vmcnt(1)
    v_add_f32 v68, v68, v100
    v_add_f32 v69, v69, v101
    v_add_f32 v70, v70, v102
    v_add_f32 v71, v71, v103
    v_add_f32 v104, v104, v108
    v_add_f32 v105, v105, v109
    v_add_f32 v106, v106, v110
    v_add_f32 v107, v107, v111
    v_add_f32 v68, v68, v104
    v_add_f32 v69, v69, v105
    v_add_f32 v70, v70, v106
    v_add_f32 v71, v71, v107
    v_cvt_pk_bf16_f32 v100, v68, v69
    v_cvt_pk_bf16_f32 v101, v70, v71
    v_lshlrev_b32 v68, 16, v100
    v_and_b32 v69, 0xffff0000, v100
    v_lshlrev_b32 v104, 16, v82
    v_and_b32 v105, 0xffff0000, v82
    v_lshlrev_b32 v70, 16, v101
    v_and_b32 v71, 0xffff0000, v101
    v_lshlrev_b32 v106, 16, v83
    v_and_b32 v107, 0xffff0000, v83
    v_add_f32 v68, v68, v104
    v_add_f32 v69, v69, v105
    v_add_f32 v70, v70, v106
    v_add_f32 v71, v71, v107
    v_cvt_pk_bf16_f32 v100, v68, v69
    v_cvt_pk_bf16_f32 v101, v70, v71
    buffer_store_dwordx2 v[100:101], v5, s[12:15], s54 offen offset:224
    s_endpgm
G2_end:
    s_endpgm
gemm_code_end:
.section .rodata,"a"
.p2align 6
.amdhsa_kernel front_kernel
  .amdhsa_next_free_vgpr 160
  .amdhsa_next_free_sgpr 102
  .amdhsa_accum_offset 160
  .amdhsa_group_segment_fixed_size 0
  .amdhsa_kernarg_size 128
  .amdhsa_user_sgpr_count 2
  .amdhsa_user_sgpr_kernarg_segment_ptr 1
  .amdhsa_system_sgpr_workgroup_id_x 1
.end_amdhsa_kernel
.p2align 6
.amdhsa_kernel gemm1_kernel
  .amdhsa_next_free_vgpr 256
  .amdhsa_next_free_sgpr 102
  .amdhsa_accum_offset 256
  .amdhsa_group_segment_fixed_size 0
  .amdhsa_kernarg_size 128
  .amdhsa_user_sgpr_count 2
  .amdhsa_user_sgpr_kernarg_segment_ptr 1
  .amdhsa_system_sgpr_workgroup_id_x 1
.end_amdhsa_kernel
```
